```python
import torch

def _softmax(x, axis=-1):
    return torch.softmax(x, dim=axis)

def _gelu(x):
    return torch.nn.functional.gelu(x, approximate='tanh')

def _silu(x):
    return torch.nn.functional.silu(x)

def _sigmoid(x):
    return torch.sigmoid(x)

def _layernorm(x, axis=-1, eps=1e-05):
    m = x.mean(dim=axis, keepdim=True)
    v = x.var(dim=axis, keepdim=True, unbiased=False)
    return (x - m) / torch.sqrt(v + eps)

def _scatter_add(tgt, idx, src, axis=0):
    return tgt.clone().index_add_(axis, idx, src)

def _segment_sum(src, seg, n):
    out = torch.zeros((n,) + src.shape[1:], dtype=src.dtype)
    return out.index_add_(0, seg, src)

def _pad(x, pw):
    flat = tuple((v for pair in reversed(pw) for v in pair))
    return torch.nn.functional.pad(x, flat)
kernel_name = 'sequential_preLN__memory_aug_recurrent_mem_tr__dense_activation_squared_relu__prompt'

def setup_inputs():

    _w = lambda a: (lambda t: t.to(torch.bfloat16) if t.is_floating_point() else t)(torch.as_tensor(a))

    def _A_setup():
        B, S, Dm = (1, 2048, 448)
        H, Dh = (16, 256)
        M, seg = (8, 32)
        seg = min(seg, S)
        S = S // seg * seg
        return {'x': _w((lambda *s: torch.randn(*s, dtype=torch.bfloat16) * 0.05)(B, S, Dm)), 'mem0': _w((lambda *s: torch.randn(*s, dtype=torch.bfloat16) * 0.2)(B, M, Dm)), 'Wq': _w((lambda *s: torch.randn(*s, dtype=torch.bfloat16) * 1.6)(Dm, H, Dh) * Dm ** (-0.5)), 'Wk': _w((lambda *s: torch.randn(*s, dtype=torch.bfloat16) * 1.6)(Dm, H, Dh) * Dm ** (-0.5)), 'Wv': _w((lambda *s: torch.randn(*s, dtype=torch.bfloat16) * 0.2)(Dm, H, Dh) * Dm ** (-0.5)), 'Wo': _w((lambda *s: torch.randn(*s, dtype=torch.bfloat16) * 0.2)(H, Dh, Dm) * (H * Dh) ** (-0.5)), 'seg_len': seg}
    _A_in = _A_setup()

    def _B_setup():
        B, S, D, F = (1, 2048, 448, 1792)
        return {'x': _w((lambda *s: torch.randn(*s, dtype=torch.bfloat16) * 0.05)(B, S, D)), 'w1': _w((lambda *s: torch.randn(*s, dtype=torch.bfloat16) * 0.05)(D, F)), 'b1': _w((lambda *s: torch.randn(*s, dtype=torch.bfloat16) * 0.2)(F)), 'w2': _w((lambda *s: torch.randn(*s, dtype=torch.bfloat16) * 0.05)(F, D)), 'b2': _w((lambda *s: torch.randn(*s, dtype=torch.bfloat16) * 0.8)(D))}
    _B_in = _B_setup()
    return {'A_x': _A_in['x'], 'A_mem0': _A_in['mem0'], 'A_Wq': _A_in['Wq'], 'A_Wk': _A_in['Wk'], 'A_Wv': _A_in['Wv'], 'A_Wo': _A_in['Wo'], 'A_seg_len': _A_in['seg_len'], 'B_x': _B_in['x'], 'B_w1': _B_in['w1'], 'B_b1': _B_in['b1'], 'B_w2': _B_in['w2'], 'B_b2': _B_in['b2']}

def reference(A_x, A_mem0, A_Wq, A_Wk, A_Wv, A_Wo, A_seg_len, B_x, B_w1, B_b1, B_w2, B_b2):

    def _A_ref(x, mem0, Wq, Wk, Wv, Wo, seg_len):
        B, S, Dm = x.shape
        H, Dh = (Wq.shape[1], Wq.shape[2])
        M = mem0.shape[1]
        scale = Dh ** (-0.5)
        n_seg = S // seg_len
        L = M + seg_len
        idx = torch.arange(L)
        mask = (idx[:, None] < M) | (idx[:, None] >= idx[None, :])
        mem = mem0
        outs = []
        for s in range(n_seg):
            xs = x[:, s * seg_len:(s + 1) * seg_len, :].clone()
            h = torch.concatenate([mem, xs], axis=1)
            q = torch.einsum('btd,dhe->bhte', h, Wq)
            k = torch.einsum('btd,dhe->bhte', h, Wk)
            v = torch.einsum('btd,dhe->bhte', h, Wv)
            scores = torch.einsum('bhqe,bhke->bhqk', q, k) * scale
            scores = torch.where(mask[None, None], scores, -1000000000.0)
            p = _softmax(scores, axis=-1)
            o = torch.einsum('bhqk,bhke->bhqe', p, v)
            o = torch.einsum('bhte,hed->btd', o, Wo)
            mem = o[:, :M, :].clone()
            outs.append(o[:, M:, :])
        return torch.concatenate(outs, axis=1)

    def _B_ref(x, w1, b1, w2, b2):
        h = torch.einsum('bsd,df->bsf', x, w1) + b1
        zero = torch.zeros_like(h)
        r = torch.where(h > zero, h, zero)
        h = r * r
        out = torch.einsum('bsf,fd->bsd', h, w2) + b2
        return out
    x = A_x
    h = x + _A_ref(_layernorm(x, axis=-1), A_mem0, A_Wq, A_Wk, A_Wv, A_Wo, A_seg_len)
    h2 = h + _B_ref(_layernorm(h, axis=-1), B_w1, B_b1, B_w2, B_b2)
    return h2
```

```asm
; @launch kernel=k1_prep_kernel grid=(256,1,1) block=(256,1,1) lds=131072
; @launch kernel=k3_chain_kernel grid=(256,1,1) block=(256,1,1) lds=135936
.amdgcn_target "amdgcn-amd-amdhsa--gfx950"
.text
.globl k1_prep_kernel
.p2align 8
.type k1_prep_kernel,@function
k1_prep_kernel:
    s_cmp_ge_u32 s2, 256
    s_cbranch_scc1 K1_END
    s_load_dwordx2 s[8:9], s[0:1], 112
    s_load_dwordx2 s[40:41], s[0:1], 16
    s_load_dwordx2 s[42:43], s[0:1], 24
    s_load_dwordx2 s[44:45], s[0:1], 32
    s_load_dwordx2 s[46:47], s[0:1], 40
    s_load_dwordx2 s[48:49], s[0:1], 0
    s_load_dwordx2 s[50:51], s[0:1], 8
    v_and_b32 v1, 63, v0
    v_lshrrev_b32 v6, 6, v0
    v_lshlrev_b32 v5, 4, v1
    v_readfirstlane_b32 s20, v6
    s_waitcnt lgkmcnt(0)
    s_and_b32 s9, s9, 0xffff
    s_mov_b32 s10, 268435456
    s_mov_b32 s11, 0x00020000
    s_cmp_ge_u32 s2, 224
    s_cbranch_scc1 K1_MISC
    s_and_b32 s35, s2, 7
    s_lshr_b32 s36, s2, 3
    s_cmp_ge_u32 s36, 14
    s_cselect_b32 s23, 1, 0
    s_mul_i32 s37, s23, 14
    s_sub_u32 s36, s36, s37
    s_cmp_ge_u32 s36, 7
    s_cselect_b32 s37, 1, 0
    s_mul_i32 s38, s37, 7
    s_sub_u32 s22, s36, s38
    s_lshl_b32 s21, s35, 1
    s_add_u32 s21, s21, s37
    s_cmp_eq_u32 s23, 0
    s_cselect_b32 s12, s40, s44
    s_cselect_b32 s13, s41, s45
    s_cselect_b32 s16, s42, s46
    s_cselect_b32 s17, s43, s47
    s_and_b32 s13, s13, 0xffff
    s_mov_b32 s14, 3670016
    s_mov_b32 s15, 0x00020000
    s_and_b32 s17, s17, 0xffff
    s_mov_b32 s18, 3670016
    s_mov_b32 s19, 0x00020000
    v_and_b32 v6, 15, v1
    v_lshrrev_b32 v7, 4, v1
    v_lshrrev_b32 v8, 3, v1
    v_and_b32 v9, 7, v1
    v_bfe_u32 v10, v8, 1, 1
    v_xor_b32 v10, v10, v9
    v_lshlrev_b32 v10, 4, v10
    v_lshl_add_u32 v20, v8, 13, v10
    v_xor_b32 v21, 32, v20
    v_xor_b32 v22, 64, v20
    v_xor_b32 v23, 96, v20
    s_lshl_b32 s36, s21, 9
    s_lshl_b32 s37, s22, 19
    s_add_u32 s24, s36, s37
    v_lshrrev_b32 v10, 2, v6
    v_lshlrev_b32 v10, 10, v10
    v_and_b32 v11, 3, v6
    v_lshl_add_u32 v10, v11, 7, v10
    v_lshrrev_b32 v11, 1, v6
    v_xor_b32 v11, v11, v7
    v_lshl_add_u32 v24, v11, 4, v10
    v_xor_b32 v25, 64, v24
    v_add_u32 v24, 57344, v24
    v_add_u32 v25, 57344, v25
    v_add_u32 v26, 65536, v24
    v_add_u32 v27, 65536, v25
    s_mul_i32 s25, s20, 131072
    s_add_u32 s25, s25, s24
    s_lshl_b32 s26, s20, 11
    s_lshl_b32 s27, s20, 1
    s_and_b32 s27, s27, 3
    s_lshl_b32 s27, s27, 5
    v_xor_b32 v28, s27, v20
    s_add_u32 s27, s27, 32
    v_xor_b32 v29, s27, v20
    s_cmp_eq_u32 s23, 0
    s_cbranch_scc0 K1_MATB
    v_bfe_u32 v10, v8, 1, 2
    v_xor_b32 v10, v10, v9
    v_lshlrev_b32 v10, 4, v10
    v_lshl_add_u32 v30, v8, 13, v10
    v_xor_b32 v31, 64, v30
    s_mul_i32 s28, s20, 917504
    s_add_u32 s28, s28, s36
    s_mul_i32 s29, s20, 14336
    v_lshrrev_b32 v10, 3, v6
    v_lshlrev_b32 v10, 10, v10
    v_and_b32 v11, 7, v6
    v_lshl_add_u32 v10, v11, 7, v10
    v_lshrrev_b32 v11, 1, v6
    v_xor_b32 v11, v11, v7
    v_lshl_add_u32 v12, v11, 4, v10
    v_add_u32 v12, s29, v12
    v_xor_b32 v13, 64, v12
    v_add_u32 v14, 65536, v12
    v_add_u32 v15, 65536, v13
    s_add_u32 s30, s25, 0
    s_add_u32 m0, s26, 57344
    s_nop 0
    buffer_load_dwordx4 v28, s[12:15], s30 offen lds
    s_add_u32 s30, s25, 65536
    s_add_u32 m0, s26, 58368
    s_nop 0
    buffer_load_dwordx4 v29, s[12:15], s30 offen lds
    s_add_u32 s30, s28, 0
    s_add_u32 m0, s29, 0
    s_nop 0
    buffer_load_dwordx4 v30, s[16:19], s30 offen lds
    s_add_u32 s30, s28, 65536
    s_add_u32 m0, s29, 1024
    s_nop 0
    buffer_load_dwordx4 v31, s[16:19], s30 offen lds
    s_add_u32 s30, s28, 131072
    s_add_u32 m0, s29, 2048
    s_nop 0
    buffer_load_dwordx4 v30, s[16:19], s30 offen lds
    s_add_u32 s30, s28, 196608
    s_add_u32 m0, s29, 3072
    s_nop 0
    buffer_load_dwordx4 v31, s[16:19], s30 offen lds
    s_add_u32 s30, s28, 262144
    s_add_u32 m0, s29, 4096
    s_nop 0
    buffer_load_dwordx4 v30, s[16:19], s30 offen lds
    s_add_u32 s30, s28, 327680
    s_add_u32 m0, s29, 5120
    s_nop 0
    buffer_load_dwordx4 v31, s[16:19], s30 offen lds
    s_add_u32 s30, s28, 393216
    s_add_u32 m0, s29, 6144
    s_nop 0
    buffer_load_dwordx4 v30, s[16:19], s30 offen lds
    s_add_u32 s30, s28, 458752
    s_add_u32 m0, s29, 7168
    s_nop 0
    buffer_load_dwordx4 v31, s[16:19], s30 offen lds
    s_add_u32 s30, s28, 524288
    s_add_u32 m0, s29, 8192
    s_nop 0
    buffer_load_dwordx4 v30, s[16:19], s30 offen lds
    s_add_u32 s30, s28, 589824
    s_add_u32 m0, s29, 9216
    s_nop 0
    buffer_load_dwordx4 v31, s[16:19], s30 offen lds
    s_add_u32 s30, s28, 655360
    s_add_u32 m0, s29, 10240
    s_nop 0
    buffer_load_dwordx4 v30, s[16:19], s30 offen lds
    s_add_u32 s30, s28, 720896
    s_add_u32 m0, s29, 11264
    s_nop 0
    buffer_load_dwordx4 v31, s[16:19], s30 offen lds
    s_add_u32 s30, s28, 786432
    s_add_u32 m0, s29, 12288
    s_nop 0
    buffer_load_dwordx4 v30, s[16:19], s30 offen lds
    s_add_u32 s30, s28, 851968
    s_add_u32 m0, s29, 13312
    s_nop 0
    buffer_load_dwordx4 v31, s[16:19], s30 offen lds
    s_add_u32 s30, s25, 128
    s_add_u32 m0, s26, 122880
    s_nop 0
    buffer_load_dwordx4 v28, s[12:15], s30 offen lds
    s_add_u32 s30, s25, 65664
    s_add_u32 m0, s26, 123904
    s_nop 0
    buffer_load_dwordx4 v29, s[12:15], s30 offen lds
    s_add_u32 s30, s28, 128
    s_add_u32 m0, s29, 65536
    s_nop 0
    buffer_load_dwordx4 v30, s[16:19], s30 offen lds
    s_add_u32 s30, s28, 65664
    s_add_u32 m0, s29, 66560
    s_nop 0
    buffer_load_dwordx4 v31, s[16:19], s30 offen lds
    s_add_u32 s30, s28, 131200
    s_add_u32 m0, s29, 67584
    s_nop 0
    buffer_load_dwordx4 v30, s[16:19], s30 offen lds
    s_add_u32 s30, s28, 196736
    s_add_u32 m0, s29, 68608
    s_nop 0
    buffer_load_dwordx4 v31, s[16:19], s30 offen lds
    s_add_u32 s30, s28, 262272
    s_add_u32 m0, s29, 69632
    s_nop 0
    buffer_load_dwordx4 v30, s[16:19], s30 offen lds
    s_add_u32 s30, s28, 327808
    s_add_u32 m0, s29, 70656
    s_nop 0
    buffer_load_dwordx4 v31, s[16:19], s30 offen lds
    s_add_u32 s30, s28, 393344
    s_add_u32 m0, s29, 71680
    s_nop 0
    buffer_load_dwordx4 v30, s[16:19], s30 offen lds
    s_add_u32 s30, s28, 458880
    s_add_u32 m0, s29, 72704
    s_nop 0
    buffer_load_dwordx4 v31, s[16:19], s30 offen lds
    s_add_u32 s30, s28, 524416
    s_add_u32 m0, s29, 73728
    s_nop 0
    buffer_load_dwordx4 v30, s[16:19], s30 offen lds
    s_add_u32 s30, s28, 589952
    s_add_u32 m0, s29, 74752
    s_nop 0
    buffer_load_dwordx4 v31, s[16:19], s30 offen lds
    s_add_u32 s30, s28, 655488
    s_add_u32 m0, s29, 75776
    s_nop 0
    buffer_load_dwordx4 v30, s[16:19], s30 offen lds
    s_add_u32 s30, s28, 721024
    s_add_u32 m0, s29, 76800
    s_nop 0
    buffer_load_dwordx4 v31, s[16:19], s30 offen lds
    s_add_u32 s30, s28, 786560
    s_add_u32 m0, s29, 77824
    s_nop 0
    buffer_load_dwordx4 v30, s[16:19], s30 offen lds
    s_add_u32 s30, s28, 852096
    s_add_u32 m0, s29, 78848
    s_nop 0
    buffer_load_dwordx4 v31, s[16:19], s30 offen lds
    s_waitcnt vmcnt(16)
    s_barrier
    ds_read_b128 v[144:147], v24 offset:0
    ds_read_b128 v[148:151], v25 offset:0
    ds_read_b128 v[152:155], v24 offset:512
    ds_read_b128 v[156:159], v25 offset:512
    ds_read_b128 v[160:163], v24 offset:4096
    ds_read_b128 v[164:167], v25 offset:4096
    ds_read_b128 v[168:171], v24 offset:4608
    ds_read_b128 v[172:175], v25 offset:4608
    ds_read_b128 v[176:179], v12 offset:0
    ds_read_b128 v[180:183], v12 offset:2048
    ds_read_b128 v[184:187], v12 offset:4096
    s_waitcnt lgkmcnt(2)
    ds_read_b128 v[188:191], v12 offset:6144
    v_mfma_f32_16x16x32_bf16 v[32:35], v[144:147], v[176:179], 0
    v_mfma_f32_16x16x32_bf16 v[36:39], v[152:155], v[176:179], 0
    v_mfma_f32_16x16x32_bf16 v[40:43], v[160:163], v[176:179], 0
    v_mfma_f32_16x16x32_bf16 v[44:47], v[168:171], v[176:179], 0
    s_waitcnt lgkmcnt(2)
    ds_read_b128 v[176:179], v12 offset:8192
    v_mfma_f32_16x16x32_bf16 v[48:51], v[144:147], v[180:183], 0
    v_mfma_f32_16x16x32_bf16 v[52:55], v[152:155], v[180:183], 0
    v_mfma_f32_16x16x32_bf16 v[56:59], v[160:163], v[180:183], 0
    v_mfma_f32_16x16x32_bf16 v[60:63], v[168:171], v[180:183], 0
    s_waitcnt lgkmcnt(2)
    ds_read_b128 v[180:183], v12 offset:10240
    v_mfma_f32_16x16x32_bf16 v[64:67], v[144:147], v[184:187], 0
    v_mfma_f32_16x16x32_bf16 v[68:71], v[152:155], v[184:187], 0
    v_mfma_f32_16x16x32_bf16 v[72:75], v[160:163], v[184:187], 0
    v_mfma_f32_16x16x32_bf16 v[76:79], v[168:171], v[184:187], 0
    s_waitcnt lgkmcnt(2)
    ds_read_b128 v[184:187], v12 offset:12288
    v_mfma_f32_16x16x32_bf16 v[80:83], v[144:147], v[188:191], 0
    v_mfma_f32_16x16x32_bf16 v[84:87], v[152:155], v[188:191], 0
    v_mfma_f32_16x16x32_bf16 v[88:91], v[160:163], v[188:191], 0
    v_mfma_f32_16x16x32_bf16 v[92:95], v[168:171], v[188:191], 0
    s_waitcnt lgkmcnt(2)
    ds_read_b128 v[188:191], v13 offset:0
    v_mfma_f32_16x16x32_bf16 v[96:99], v[144:147], v[176:179], 0
    v_mfma_f32_16x16x32_bf16 v[100:103], v[152:155], v[176:179], 0
    v_mfma_f32_16x16x32_bf16 v[104:107], v[160:163], v[176:179], 0
    v_mfma_f32_16x16x32_bf16 v[108:111], v[168:171], v[176:179], 0
    s_waitcnt lgkmcnt(2)
    ds_read_b128 v[176:179], v13 offset:2048
    v_mfma_f32_16x16x32_bf16 v[112:115], v[144:147], v[180:183], 0
    v_mfma_f32_16x16x32_bf16 v[116:119], v[152:155], v[180:183], 0
    v_mfma_f32_16x16x32_bf16 v[120:123], v[160:163], v[180:183], 0
    v_mfma_f32_16x16x32_bf16 v[124:127], v[168:171], v[180:183], 0
    s_waitcnt lgkmcnt(2)
    ds_read_b128 v[180:183], v13 offset:4096
    v_mfma_f32_16x16x32_bf16 v[128:131], v[144:147], v[184:187], 0
    v_mfma_f32_16x16x32_bf16 v[132:135], v[152:155], v[184:187], 0
    v_mfma_f32_16x16x32_bf16 v[136:139], v[160:163], v[184:187], 0
    v_mfma_f32_16x16x32_bf16 v[140:143], v[168:171], v[184:187], 0
    s_waitcnt lgkmcnt(2)
    ds_read_b128 v[184:187], v13 offset:6144
    v_mfma_f32_16x16x32_bf16 v[32:35], v[148:151], v[188:191], v[32:35]
    v_mfma_f32_16x16x32_bf16 v[36:39], v[156:159], v[188:191], v[36:39]
    v_mfma_f32_16x16x32_bf16 v[40:43], v[164:167], v[188:191], v[40:43]
    v_mfma_f32_16x16x32_bf16 v[44:47], v[172:175], v[188:191], v[44:47]
    s_waitcnt lgkmcnt(2)
    ds_read_b128 v[188:191], v13 offset:8192
    v_mfma_f32_16x16x32_bf16 v[48:51], v[148:151], v[176:179], v[48:51]
    v_mfma_f32_16x16x32_bf16 v[52:55], v[156:159], v[176:179], v[52:55]
    v_mfma_f32_16x16x32_bf16 v[56:59], v[164:167], v[176:179], v[56:59]
    v_mfma_f32_16x16x32_bf16 v[60:63], v[172:175], v[176:179], v[60:63]
    s_waitcnt lgkmcnt(2)
    ds_read_b128 v[176:179], v13 offset:10240
    v_mfma_f32_16x16x32_bf16 v[64:67], v[148:151], v[180:183], v[64:67]
    v_mfma_f32_16x16x32_bf16 v[68:71], v[156:159], v[180:183], v[68:71]
    v_mfma_f32_16x16x32_bf16 v[72:75], v[164:167], v[180:183], v[72:75]
    v_mfma_f32_16x16x32_bf16 v[76:79], v[172:175], v[180:183], v[76:79]
    s_waitcnt lgkmcnt(2)
    ds_read_b128 v[180:183], v13 offset:12288
    v_mfma_f32_16x16x32_bf16 v[80:83], v[148:151], v[184:187], v[80:83]
    v_mfma_f32_16x16x32_bf16 v[84:87], v[156:159], v[184:187], v[84:87]
    v_mfma_f32_16x16x32_bf16 v[88:91], v[164:167], v[184:187], v[88:91]
    v_mfma_f32_16x16x32_bf16 v[92:95], v[172:175], v[184:187], v[92:95]
    s_waitcnt lgkmcnt(2)
    v_mfma_f32_16x16x32_bf16 v[96:99], v[148:151], v[188:191], v[96:99]
    v_mfma_f32_16x16x32_bf16 v[100:103], v[156:159], v[188:191], v[100:103]
    v_mfma_f32_16x16x32_bf16 v[104:107], v[164:167], v[188:191], v[104:107]
    v_mfma_f32_16x16x32_bf16 v[108:111], v[172:175], v[188:191], v[108:111]
    s_waitcnt lgkmcnt(1)
    v_mfma_f32_16x16x32_bf16 v[112:115], v[148:151], v[176:179], v[112:115]
    v_mfma_f32_16x16x32_bf16 v[116:119], v[156:159], v[176:179], v[116:119]
    v_mfma_f32_16x16x32_bf16 v[120:123], v[164:167], v[176:179], v[120:123]
    v_mfma_f32_16x16x32_bf16 v[124:127], v[172:175], v[176:179], v[124:127]
    s_waitcnt lgkmcnt(0)
    v_mfma_f32_16x16x32_bf16 v[128:131], v[148:151], v[180:183], v[128:131]
    v_mfma_f32_16x16x32_bf16 v[132:135], v[156:159], v[180:183], v[132:135]
    v_mfma_f32_16x16x32_bf16 v[136:139], v[164:167], v[180:183], v[136:139]
    v_mfma_f32_16x16x32_bf16 v[140:143], v[172:175], v[180:183], v[140:143]
    s_barrier
    s_add_u32 s30, s25, 256
    s_add_u32 m0, s26, 57344
    s_nop 0
    buffer_load_dwordx4 v28, s[12:15], s30 offen lds
    s_add_u32 s30, s25, 65792
    s_add_u32 m0, s26, 58368
    s_nop 0
    buffer_load_dwordx4 v29, s[12:15], s30 offen lds
    s_add_u32 s30, s28, 256
    s_add_u32 m0, s29, 0
    s_nop 0
    buffer_load_dwordx4 v30, s[16:19], s30 offen lds
    s_add_u32 s30, s28, 65792
    s_add_u32 m0, s29, 1024
    s_nop 0
    buffer_load_dwordx4 v31, s[16:19], s30 offen lds
    s_add_u32 s30, s28, 131328
    s_add_u32 m0, s29, 2048
    s_nop 0
    buffer_load_dwordx4 v30, s[16:19], s30 offen lds
    s_add_u32 s30, s28, 196864
    s_add_u32 m0, s29, 3072
    s_nop 0
    buffer_load_dwordx4 v31, s[16:19], s30 offen lds
    s_add_u32 s30, s28, 262400
    s_add_u32 m0, s29, 4096
    s_nop 0
    buffer_load_dwordx4 v30, s[16:19], s30 offen lds
    s_add_u32 s30, s28, 327936
    s_add_u32 m0, s29, 5120
    s_nop 0
    buffer_load_dwordx4 v31, s[16:19], s30 offen lds
    s_add_u32 s30, s28, 393472
    s_add_u32 m0, s29, 6144
    s_nop 0
    buffer_load_dwordx4 v30, s[16:19], s30 offen lds
    s_add_u32 s30, s28, 459008
    s_add_u32 m0, s29, 7168
    s_nop 0
    buffer_load_dwordx4 v31, s[16:19], s30 offen lds
    s_add_u32 s30, s28, 524544
    s_add_u32 m0, s29, 8192
    s_nop 0
    buffer_load_dwordx4 v30, s[16:19], s30 offen lds
    s_add_u32 s30, s28, 590080
    s_add_u32 m0, s29, 9216
    s_nop 0
    buffer_load_dwordx4 v31, s[16:19], s30 offen lds
    s_add_u32 s30, s28, 655616
    s_add_u32 m0, s29, 10240
    s_nop 0
    buffer_load_dwordx4 v30, s[16:19], s30 offen lds
    s_add_u32 s30, s28, 721152
    s_add_u32 m0, s29, 11264
    s_nop 0
    buffer_load_dwordx4 v31, s[16:19], s30 offen lds
    s_add_u32 s30, s28, 786688
    s_add_u32 m0, s29, 12288
    s_nop 0
    buffer_load_dwordx4 v30, s[16:19], s30 offen lds
    s_add_u32 s30, s28, 852224
    s_add_u32 m0, s29, 13312
    s_nop 0
    buffer_load_dwordx4 v31, s[16:19], s30 offen lds
    s_waitcnt vmcnt(16)
    s_barrier
    ds_read_b128 v[144:147], v26 offset:0
    ds_read_b128 v[148:151], v27 offset:0
    ds_read_b128 v[152:155], v26 offset:512
    ds_read_b128 v[156:159], v27 offset:512
    ds_read_b128 v[160:163], v26 offset:4096
    ds_read_b128 v[164:167], v27 offset:4096
    ds_read_b128 v[168:171], v26 offset:4608
    ds_read_b128 v[172:175], v27 offset:4608
    ds_read_b128 v[176:179], v14 offset:0
    ds_read_b128 v[180:183], v14 offset:2048
    ds_read_b128 v[184:187], v14 offset:4096
    s_waitcnt lgkmcnt(2)
    ds_read_b128 v[188:191], v14 offset:6144
    v_mfma_f32_16x16x32_bf16 v[32:35], v[144:147], v[176:179], v[32:35]
    v_mfma_f32_16x16x32_bf16 v[36:39], v[152:155], v[176:179], v[36:39]
    v_mfma_f32_16x16x32_bf16 v[40:43], v[160:163], v[176:179], v[40:43]
    v_mfma_f32_16x16x32_bf16 v[44:47], v[168:171], v[176:179], v[44:47]
    s_waitcnt lgkmcnt(2)
    ds_read_b128 v[176:179], v14 offset:8192
    v_mfma_f32_16x16x32_bf16 v[48:51], v[144:147], v[180:183], v[48:51]
    v_mfma_f32_16x16x32_bf16 v[52:55], v[152:155], v[180:183], v[52:55]
    v_mfma_f32_16x16x32_bf16 v[56:59], v[160:163], v[180:183], v[56:59]
    v_mfma_f32_16x16x32_bf16 v[60:63], v[168:171], v[180:183], v[60:63]
    s_waitcnt lgkmcnt(2)
    ds_read_b128 v[180:183], v14 offset:10240
    v_mfma_f32_16x16x32_bf16 v[64:67], v[144:147], v[184:187], v[64:67]
    v_mfma_f32_16x16x32_bf16 v[68:71], v[152:155], v[184:187], v[68:71]
    v_mfma_f32_16x16x32_bf16 v[72:75], v[160:163], v[184:187], v[72:75]
    v_mfma_f32_16x16x32_bf16 v[76:79], v[168:171], v[184:187], v[76:79]
    s_waitcnt lgkmcnt(2)
    ds_read_b128 v[184:187], v14 offset:12288
    v_mfma_f32_16x16x32_bf16 v[80:83], v[144:147], v[188:191], v[80:83]
    v_mfma_f32_16x16x32_bf16 v[84:87], v[152:155], v[188:191], v[84:87]
    v_mfma_f32_16x16x32_bf16 v[88:91], v[160:163], v[188:191], v[88:91]
    v_mfma_f32_16x16x32_bf16 v[92:95], v[168:171], v[188:191], v[92:95]
    s_waitcnt lgkmcnt(2)
    ds_read_b128 v[188:191], v15 offset:0
    v_mfma_f32_16x16x32_bf16 v[96:99], v[144:147], v[176:179], v[96:99]
    v_mfma_f32_16x16x32_bf16 v[100:103], v[152:155], v[176:179], v[100:103]
    v_mfma_f32_16x16x32_bf16 v[104:107], v[160:163], v[176:179], v[104:107]
    v_mfma_f32_16x16x32_bf16 v[108:111], v[168:171], v[176:179], v[108:111]
    s_waitcnt lgkmcnt(2)
    ds_read_b128 v[176:179], v15 offset:2048
    v_mfma_f32_16x16x32_bf16 v[112:115], v[144:147], v[180:183], v[112:115]
    v_mfma_f32_16x16x32_bf16 v[116:119], v[152:155], v[180:183], v[116:119]
    v_mfma_f32_16x16x32_bf16 v[120:123], v[160:163], v[180:183], v[120:123]
    v_mfma_f32_16x16x32_bf16 v[124:127], v[168:171], v[180:183], v[124:127]
    s_waitcnt lgkmcnt(2)
    ds_read_b128 v[180:183], v15 offset:4096
    v_mfma_f32_16x16x32_bf16 v[128:131], v[144:147], v[184:187], v[128:131]
    v_mfma_f32_16x16x32_bf16 v[132:135], v[152:155], v[184:187], v[132:135]
    v_mfma_f32_16x16x32_bf16 v[136:139], v[160:163], v[184:187], v[136:139]
    v_mfma_f32_16x16x32_bf16 v[140:143], v[168:171], v[184:187], v[140:143]
    s_waitcnt lgkmcnt(2)
    ds_read_b128 v[184:187], v15 offset:6144
    v_mfma_f32_16x16x32_bf16 v[32:35], v[148:151], v[188:191], v[32:35]
    v_mfma_f32_16x16x32_bf16 v[36:39], v[156:159], v[188:191], v[36:39]
    v_mfma_f32_16x16x32_bf16 v[40:43], v[164:167], v[188:191], v[40:43]
    v_mfma_f32_16x16x32_bf16 v[44:47], v[172:175], v[188:191], v[44:47]
    s_waitcnt lgkmcnt(2)
    ds_read_b128 v[188:191], v15 offset:8192
    v_mfma_f32_16x16x32_bf16 v[48:51], v[148:151], v[176:179], v[48:51]
    v_mfma_f32_16x16x32_bf16 v[52:55], v[156:159], v[176:179], v[52:55]
    v_mfma_f32_16x16x32_bf16 v[56:59], v[164:167], v[176:179], v[56:59]
    v_mfma_f32_16x16x32_bf16 v[60:63], v[172:175], v[176:179], v[60:63]
    s_waitcnt lgkmcnt(2)
    ds_read_b128 v[176:179], v15 offset:10240
    v_mfma_f32_16x16x32_bf16 v[64:67], v[148:151], v[180:183], v[64:67]
    v_mfma_f32_16x16x32_bf16 v[68:71], v[156:159], v[180:183], v[68:71]
    v_mfma_f32_16x16x32_bf16 v[72:75], v[164:167], v[180:183], v[72:75]
    v_mfma_f32_16x16x32_bf16 v[76:79], v[172:175], v[180:183], v[76:79]
    s_waitcnt lgkmcnt(2)
    ds_read_b128 v[180:183], v15 offset:12288
    v_mfma_f32_16x16x32_bf16 v[80:83], v[148:151], v[184:187], v[80:83]
    v_mfma_f32_16x16x32_bf16 v[84:87], v[156:159], v[184:187], v[84:87]
    v_mfma_f32_16x16x32_bf16 v[88:91], v[164:167], v[184:187], v[88:91]
    v_mfma_f32_16x16x32_bf16 v[92:95], v[172:175], v[184:187], v[92:95]
    s_waitcnt lgkmcnt(2)
    v_mfma_f32_16x16x32_bf16 v[96:99], v[148:151], v[188:191], v[96:99]
    v_mfma_f32_16x16x32_bf16 v[100:103], v[156:159], v[188:191], v[100:103]
    v_mfma_f32_16x16x32_bf16 v[104:107], v[164:167], v[188:191], v[104:107]
    v_mfma_f32_16x16x32_bf16 v[108:111], v[172:175], v[188:191], v[108:111]
    s_waitcnt lgkmcnt(1)
    v_mfma_f32_16x16x32_bf16 v[112:115], v[148:151], v[176:179], v[112:115]
    v_mfma_f32_16x16x32_bf16 v[116:119], v[156:159], v[176:179], v[116:119]
    v_mfma_f32_16x16x32_bf16 v[120:123], v[164:167], v[176:179], v[120:123]
    v_mfma_f32_16x16x32_bf16 v[124:127], v[172:175], v[176:179], v[124:127]
    s_waitcnt lgkmcnt(0)
    v_mfma_f32_16x16x32_bf16 v[128:131], v[148:151], v[180:183], v[128:131]
    v_mfma_f32_16x16x32_bf16 v[132:135], v[156:159], v[180:183], v[132:135]
    v_mfma_f32_16x16x32_bf16 v[136:139], v[164:167], v[180:183], v[136:139]
    v_mfma_f32_16x16x32_bf16 v[140:143], v[172:175], v[180:183], v[140:143]
    s_barrier
    s_add_u32 s30, s25, 384
    s_add_u32 m0, s26, 122880
    s_nop 0
    buffer_load_dwordx4 v28, s[12:15], s30 offen lds
    s_add_u32 s30, s25, 65920
    s_add_u32 m0, s26, 123904
    s_nop 0
    buffer_load_dwordx4 v29, s[12:15], s30 offen lds
    s_add_u32 s30, s28, 384
    s_add_u32 m0, s29, 65536
    s_nop 0
    buffer_load_dwordx4 v30, s[16:19], s30 offen lds
    s_add_u32 s30, s28, 65920
    s_add_u32 m0, s29, 66560
    s_nop 0
    buffer_load_dwordx4 v31, s[16:19], s30 offen lds
    s_add_u32 s30, s28, 131456
    s_add_u32 m0, s29, 67584
    s_nop 0
    buffer_load_dwordx4 v30, s[16:19], s30 offen lds
    s_add_u32 s30, s28, 196992
    s_add_u32 m0, s29, 68608
    s_nop 0
    buffer_load_dwordx4 v31, s[16:19], s30 offen lds
    s_add_u32 s30, s28, 262528
    s_add_u32 m0, s29, 69632
    s_nop 0
    buffer_load_dwordx4 v30, s[16:19], s30 offen lds
    s_add_u32 s30, s28, 328064
    s_add_u32 m0, s29, 70656
    s_nop 0
    buffer_load_dwordx4 v31, s[16:19], s30 offen lds
    s_add_u32 s30, s28, 393600
    s_add_u32 m0, s29, 71680
    s_nop 0
    buffer_load_dwordx4 v30, s[16:19], s30 offen lds
    s_add_u32 s30, s28, 459136
    s_add_u32 m0, s29, 72704
    s_nop 0
    buffer_load_dwordx4 v31, s[16:19], s30 offen lds
    s_add_u32 s30, s28, 524672
    s_add_u32 m0, s29, 73728
    s_nop 0
    buffer_load_dwordx4 v30, s[16:19], s30 offen lds
    s_add_u32 s30, s28, 590208
    s_add_u32 m0, s29, 74752
    s_nop 0
    buffer_load_dwordx4 v31, s[16:19], s30 offen lds
    s_add_u32 s30, s28, 655744
    s_add_u32 m0, s29, 75776
    s_nop 0
    buffer_load_dwordx4 v30, s[16:19], s30 offen lds
    s_add_u32 s30, s28, 721280
    s_add_u32 m0, s29, 76800
    s_nop 0
    buffer_load_dwordx4 v31, s[16:19], s30 offen lds
    s_add_u32 s30, s28, 786816
    s_add_u32 m0, s29, 77824
    s_nop 0
    buffer_load_dwordx4 v30, s[16:19], s30 offen lds
    s_add_u32 s30, s28, 852352
    s_add_u32 m0, s29, 78848
    s_nop 0
    buffer_load_dwordx4 v31, s[16:19], s30 offen lds
    s_waitcnt vmcnt(16)
    s_barrier
    ds_read_b128 v[144:147], v24 offset:0
    ds_read_b128 v[148:151], v25 offset:0
    ds_read_b128 v[152:155], v24 offset:512
    ds_read_b128 v[156:159], v25 offset:512
    ds_read_b128 v[160:163], v24 offset:4096
    ds_read_b128 v[164:167], v25 offset:4096
    ds_read_b128 v[168:171], v24 offset:4608
    ds_read_b128 v[172:175], v25 offset:4608
    ds_read_b128 v[176:179], v12 offset:0
    ds_read_b128 v[180:183], v12 offset:2048
    ds_read_b128 v[184:187], v12 offset:4096
    s_waitcnt lgkmcnt(2)
    ds_read_b128 v[188:191], v12 offset:6144
    v_mfma_f32_16x16x32_bf16 v[32:35], v[144:147], v[176:179], v[32:35]
    v_mfma_f32_16x16x32_bf16 v[36:39], v[152:155], v[176:179], v[36:39]
    v_mfma_f32_16x16x32_bf16 v[40:43], v[160:163], v[176:179], v[40:43]
    v_mfma_f32_16x16x32_bf16 v[44:47], v[168:171], v[176:179], v[44:47]
    s_waitcnt lgkmcnt(2)
    ds_read_b128 v[176:179], v12 offset:8192
    v_mfma_f32_16x16x32_bf16 v[48:51], v[144:147], v[180:183], v[48:51]
    v_mfma_f32_16x16x32_bf16 v[52:55], v[152:155], v[180:183], v[52:55]
    v_mfma_f32_16x16x32_bf16 v[56:59], v[160:163], v[180:183], v[56:59]
    v_mfma_f32_16x16x32_bf16 v[60:63], v[168:171], v[180:183], v[60:63]
    s_waitcnt lgkmcnt(2)
    ds_read_b128 v[180:183], v12 offset:10240
    v_mfma_f32_16x16x32_bf16 v[64:67], v[144:147], v[184:187], v[64:67]
    v_mfma_f32_16x16x32_bf16 v[68:71], v[152:155], v[184:187], v[68:71]
    v_mfma_f32_16x16x32_bf16 v[72:75], v[160:163], v[184:187], v[72:75]
    v_mfma_f32_16x16x32_bf16 v[76:79], v[168:171], v[184:187], v[76:79]
    s_waitcnt lgkmcnt(2)
    ds_read_b128 v[184:187], v12 offset:12288
    v_mfma_f32_16x16x32_bf16 v[80:83], v[144:147], v[188:191], v[80:83]
    v_mfma_f32_16x16x32_bf16 v[84:87], v[152:155], v[188:191], v[84:87]
    v_mfma_f32_16x16x32_bf16 v[88:91], v[160:163], v[188:191], v[88:91]
    v_mfma_f32_16x16x32_bf16 v[92:95], v[168:171], v[188:191], v[92:95]
    s_waitcnt lgkmcnt(2)
    ds_read_b128 v[188:191], v13 offset:0
    v_mfma_f32_16x16x32_bf16 v[96:99], v[144:147], v[176:179], v[96:99]
    v_mfma_f32_16x16x32_bf16 v[100:103], v[152:155], v[176:179], v[100:103]
    v_mfma_f32_16x16x32_bf16 v[104:107], v[160:163], v[176:179], v[104:107]
    v_mfma_f32_16x16x32_bf16 v[108:111], v[168:171], v[176:179], v[108:111]
    s_waitcnt lgkmcnt(2)
    ds_read_b128 v[176:179], v13 offset:2048
    v_mfma_f32_16x16x32_bf16 v[112:115], v[144:147], v[180:183], v[112:115]
    v_mfma_f32_16x16x32_bf16 v[116:119], v[152:155], v[180:183], v[116:119]
    v_mfma_f32_16x16x32_bf16 v[120:123], v[160:163], v[180:183], v[120:123]
    v_mfma_f32_16x16x32_bf16 v[124:127], v[168:171], v[180:183], v[124:127]
    s_waitcnt lgkmcnt(2)
    ds_read_b128 v[180:183], v13 offset:4096
    v_mfma_f32_16x16x32_bf16 v[128:131], v[144:147], v[184:187], v[128:131]
    v_mfma_f32_16x16x32_bf16 v[132:135], v[152:155], v[184:187], v[132:135]
    v_mfma_f32_16x16x32_bf16 v[136:139], v[160:163], v[184:187], v[136:139]
    v_mfma_f32_16x16x32_bf16 v[140:143], v[168:171], v[184:187], v[140:143]
    s_waitcnt lgkmcnt(2)
    ds_read_b128 v[184:187], v13 offset:6144
    v_mfma_f32_16x16x32_bf16 v[32:35], v[148:151], v[188:191], v[32:35]
    v_mfma_f32_16x16x32_bf16 v[36:39], v[156:159], v[188:191], v[36:39]
    v_mfma_f32_16x16x32_bf16 v[40:43], v[164:167], v[188:191], v[40:43]
    v_mfma_f32_16x16x32_bf16 v[44:47], v[172:175], v[188:191], v[44:47]
    s_waitcnt lgkmcnt(2)
    ds_read_b128 v[188:191], v13 offset:8192
    v_mfma_f32_16x16x32_bf16 v[48:51], v[148:151], v[176:179], v[48:51]
    v_mfma_f32_16x16x32_bf16 v[52:55], v[156:159], v[176:179], v[52:55]
    v_mfma_f32_16x16x32_bf16 v[56:59], v[164:167], v[176:179], v[56:59]
    v_mfma_f32_16x16x32_bf16 v[60:63], v[172:175], v[176:179], v[60:63]
    s_waitcnt lgkmcnt(2)
    ds_read_b128 v[176:179], v13 offset:10240
    v_mfma_f32_16x16x32_bf16 v[64:67], v[148:151], v[180:183], v[64:67]
    v_mfma_f32_16x16x32_bf16 v[68:71], v[156:159], v[180:183], v[68:71]
    v_mfma_f32_16x16x32_bf16 v[72:75], v[164:167], v[180:183], v[72:75]
    v_mfma_f32_16x16x32_bf16 v[76:79], v[172:175], v[180:183], v[76:79]
    s_waitcnt lgkmcnt(2)
    ds_read_b128 v[180:183], v13 offset:12288
    v_mfma_f32_16x16x32_bf16 v[80:83], v[148:151], v[184:187], v[80:83]
    v_mfma_f32_16x16x32_bf16 v[84:87], v[156:159], v[184:187], v[84:87]
    v_mfma_f32_16x16x32_bf16 v[88:91], v[164:167], v[184:187], v[88:91]
    v_mfma_f32_16x16x32_bf16 v[92:95], v[172:175], v[184:187], v[92:95]
    s_waitcnt lgkmcnt(2)
    v_mfma_f32_16x16x32_bf16 v[96:99], v[148:151], v[188:191], v[96:99]
    v_mfma_f32_16x16x32_bf16 v[100:103], v[156:159], v[188:191], v[100:103]
    v_mfma_f32_16x16x32_bf16 v[104:107], v[164:167], v[188:191], v[104:107]
    v_mfma_f32_16x16x32_bf16 v[108:111], v[172:175], v[188:191], v[108:111]
    s_waitcnt lgkmcnt(1)
    v_mfma_f32_16x16x32_bf16 v[112:115], v[148:151], v[176:179], v[112:115]
    v_mfma_f32_16x16x32_bf16 v[116:119], v[156:159], v[176:179], v[116:119]
    v_mfma_f32_16x16x32_bf16 v[120:123], v[164:167], v[176:179], v[120:123]
    v_mfma_f32_16x16x32_bf16 v[124:127], v[172:175], v[176:179], v[124:127]
    s_waitcnt lgkmcnt(0)
    v_mfma_f32_16x16x32_bf16 v[128:131], v[148:151], v[180:183], v[128:131]
    v_mfma_f32_16x16x32_bf16 v[132:135], v[156:159], v[180:183], v[132:135]
    v_mfma_f32_16x16x32_bf16 v[136:139], v[164:167], v[180:183], v[136:139]
    v_mfma_f32_16x16x32_bf16 v[140:143], v[172:175], v[180:183], v[140:143]
    s_waitcnt vmcnt(0)
    s_barrier
    ds_read_b128 v[144:147], v26 offset:0
    ds_read_b128 v[148:151], v27 offset:0
    ds_read_b128 v[152:155], v26 offset:512
    ds_read_b128 v[156:159], v27 offset:512
    ds_read_b128 v[160:163], v26 offset:4096
    ds_read_b128 v[164:167], v27 offset:4096
    ds_read_b128 v[168:171], v26 offset:4608
    ds_read_b128 v[172:175], v27 offset:4608
    ds_read_b128 v[176:179], v14 offset:0
    ds_read_b128 v[180:183], v14 offset:2048
    ds_read_b128 v[184:187], v14 offset:4096
    s_waitcnt lgkmcnt(2)
    ds_read_b128 v[188:191], v14 offset:6144
    v_mfma_f32_16x16x32_bf16 v[32:35], v[144:147], v[176:179], v[32:35]
    v_mfma_f32_16x16x32_bf16 v[36:39], v[152:155], v[176:179], v[36:39]
    v_mfma_f32_16x16x32_bf16 v[40:43], v[160:163], v[176:179], v[40:43]
    v_mfma_f32_16x16x32_bf16 v[44:47], v[168:171], v[176:179], v[44:47]
    s_waitcnt lgkmcnt(2)
    ds_read_b128 v[176:179], v14 offset:8192
    v_mfma_f32_16x16x32_bf16 v[48:51], v[144:147], v[180:183], v[48:51]
    v_mfma_f32_16x16x32_bf16 v[52:55], v[152:155], v[180:183], v[52:55]
    v_mfma_f32_16x16x32_bf16 v[56:59], v[160:163], v[180:183], v[56:59]
    v_mfma_f32_16x16x32_bf16 v[60:63], v[168:171], v[180:183], v[60:63]
    s_waitcnt lgkmcnt(2)
    ds_read_b128 v[180:183], v14 offset:10240
    v_mfma_f32_16x16x32_bf16 v[64:67], v[144:147], v[184:187], v[64:67]
    v_mfma_f32_16x16x32_bf16 v[68:71], v[152:155], v[184:187], v[68:71]
    v_mfma_f32_16x16x32_bf16 v[72:75], v[160:163], v[184:187], v[72:75]
    v_mfma_f32_16x16x32_bf16 v[76:79], v[168:171], v[184:187], v[76:79]
    s_waitcnt lgkmcnt(2)
    ds_read_b128 v[184:187], v14 offset:12288
    v_mfma_f32_16x16x32_bf16 v[80:83], v[144:147], v[188:191], v[80:83]
    v_mfma_f32_16x16x32_bf16 v[84:87], v[152:155], v[188:191], v[84:87]
    v_mfma_f32_16x16x32_bf16 v[88:91], v[160:163], v[188:191], v[88:91]
    v_mfma_f32_16x16x32_bf16 v[92:95], v[168:171], v[188:191], v[92:95]
    s_waitcnt lgkmcnt(2)
    ds_read_b128 v[188:191], v15 offset:0
    v_mfma_f32_16x16x32_bf16 v[96:99], v[144:147], v[176:179], v[96:99]
    v_mfma_f32_16x16x32_bf16 v[100:103], v[152:155], v[176:179], v[100:103]
    v_mfma_f32_16x16x32_bf16 v[104:107], v[160:163], v[176:179], v[104:107]
    v_mfma_f32_16x16x32_bf16 v[108:111], v[168:171], v[176:179], v[108:111]
    s_waitcnt lgkmcnt(2)
    ds_read_b128 v[176:179], v15 offset:2048
    v_mfma_f32_16x16x32_bf16 v[112:115], v[144:147], v[180:183], v[112:115]
    v_mfma_f32_16x16x32_bf16 v[116:119], v[152:155], v[180:183], v[116:119]
    v_mfma_f32_16x16x32_bf16 v[120:123], v[160:163], v[180:183], v[120:123]
    v_mfma_f32_16x16x32_bf16 v[124:127], v[168:171], v[180:183], v[124:127]
    s_waitcnt lgkmcnt(2)
    ds_read_b128 v[180:183], v15 offset:4096
    v_mfma_f32_16x16x32_bf16 v[128:131], v[144:147], v[184:187], v[128:131]
    v_mfma_f32_16x16x32_bf16 v[132:135], v[152:155], v[184:187], v[132:135]
    v_mfma_f32_16x16x32_bf16 v[136:139], v[160:163], v[184:187], v[136:139]
    v_mfma_f32_16x16x32_bf16 v[140:143], v[168:171], v[184:187], v[140:143]
    s_waitcnt lgkmcnt(2)
    ds_read_b128 v[184:187], v15 offset:6144
    v_mfma_f32_16x16x32_bf16 v[32:35], v[148:151], v[188:191], v[32:35]
    v_mfma_f32_16x16x32_bf16 v[36:39], v[156:159], v[188:191], v[36:39]
    v_mfma_f32_16x16x32_bf16 v[40:43], v[164:167], v[188:191], v[40:43]
    v_mfma_f32_16x16x32_bf16 v[44:47], v[172:175], v[188:191], v[44:47]
    s_waitcnt lgkmcnt(2)
    ds_read_b128 v[188:191], v15 offset:8192
    v_mfma_f32_16x16x32_bf16 v[48:51], v[148:151], v[176:179], v[48:51]
    v_mfma_f32_16x16x32_bf16 v[52:55], v[156:159], v[176:179], v[52:55]
    v_mfma_f32_16x16x32_bf16 v[56:59], v[164:167], v[176:179], v[56:59]
    v_mfma_f32_16x16x32_bf16 v[60:63], v[172:175], v[176:179], v[60:63]
    s_waitcnt lgkmcnt(2)
    ds_read_b128 v[176:179], v15 offset:10240
    v_mfma_f32_16x16x32_bf16 v[64:67], v[148:151], v[180:183], v[64:67]
    v_mfma_f32_16x16x32_bf16 v[68:71], v[156:159], v[180:183], v[68:71]
    v_mfma_f32_16x16x32_bf16 v[72:75], v[164:167], v[180:183], v[72:75]
    v_mfma_f32_16x16x32_bf16 v[76:79], v[172:175], v[180:183], v[76:79]
    s_waitcnt lgkmcnt(2)
    ds_read_b128 v[180:183], v15 offset:12288
    v_mfma_f32_16x16x32_bf16 v[80:83], v[148:151], v[184:187], v[80:83]
    v_mfma_f32_16x16x32_bf16 v[84:87], v[156:159], v[184:187], v[84:87]
    v_mfma_f32_16x16x32_bf16 v[88:91], v[164:167], v[184:187], v[88:91]
    v_mfma_f32_16x16x32_bf16 v[92:95], v[172:175], v[184:187], v[92:95]
    s_waitcnt lgkmcnt(2)
    v_mfma_f32_16x16x32_bf16 v[96:99], v[148:151], v[188:191], v[96:99]
    v_mfma_f32_16x16x32_bf16 v[100:103], v[156:159], v[188:191], v[100:103]
    v_mfma_f32_16x16x32_bf16 v[104:107], v[164:167], v[188:191], v[104:107]
    v_mfma_f32_16x16x32_bf16 v[108:111], v[172:175], v[188:191], v[108:111]
    s_waitcnt lgkmcnt(1)
    v_mfma_f32_16x16x32_bf16 v[112:115], v[148:151], v[176:179], v[112:115]
    v_mfma_f32_16x16x32_bf16 v[116:119], v[156:159], v[176:179], v[116:119]
    v_mfma_f32_16x16x32_bf16 v[120:123], v[164:167], v[176:179], v[120:123]
    v_mfma_f32_16x16x32_bf16 v[124:127], v[172:175], v[176:179], v[124:127]
    s_waitcnt lgkmcnt(0)
    v_mfma_f32_16x16x32_bf16 v[128:131], v[148:151], v[180:183], v[128:131]
    v_mfma_f32_16x16x32_bf16 v[132:135], v[156:159], v[180:183], v[132:135]
    v_mfma_f32_16x16x32_bf16 v[136:139], v[164:167], v[180:183], v[136:139]
    v_mfma_f32_16x16x32_bf16 v[140:143], v[172:175], v[180:183], v[140:143]
    s_mov_b32 s39, 0x3d800000
    s_branch K1_EPI
K1_MATB:
    v_lshrrev_b32 v10, 2, v6
    v_lshl_add_u32 v10, v7, 3, v10
    v_mul_u32_u24 v10, 896, v10
    v_and_b32 v11, 3, v6
    v_lshl_add_u32 v10, v11, 3, v10
    s_mul_i32 s37, s20, 224
    v_add_u32 v12, s37, v10
    v_add_u32 v14, 65536, v12
    s_mul_i32 s28, s21, 229376
    s_mul_i32 s29, s20, 14336
    s_add_u32 s28, s28, s29
    s_add_u32 s30, s25, 0
    s_add_u32 m0, s26, 57344
    s_nop 0
    buffer_load_dwordx4 v28, s[12:15], s30 offen lds
    s_add_u32 s30, s25, 65536
    s_add_u32 m0, s26, 58368
    s_nop 0
    buffer_load_dwordx4 v29, s[12:15], s30 offen lds
    s_add_u32 s30, s28, 0
    s_add_u32 m0, s29, 0
    s_nop 0
    buffer_load_dwordx4 v5, s[16:19], s30 offen lds
    s_add_u32 s30, s28, 1024
    s_add_u32 m0, s29, 1024
    s_nop 0
    buffer_load_dwordx4 v5, s[16:19], s30 offen lds
    s_add_u32 s30, s28, 2048
    s_add_u32 m0, s29, 2048
    s_nop 0
    buffer_load_dwordx4 v5, s[16:19], s30 offen lds
    s_add_u32 s30, s28, 3072
    s_add_u32 m0, s29, 3072
    s_nop 0
    buffer_load_dwordx4 v5, s[16:19], s30 offen lds
    s_add_u32 s30, s28, 4096
    s_add_u32 m0, s29, 4096
    s_nop 0
    buffer_load_dwordx4 v5, s[16:19], s30 offen lds
    s_add_u32 s30, s28, 5120
    s_add_u32 m0, s29, 5120
    s_nop 0
    buffer_load_dwordx4 v5, s[16:19], s30 offen lds
    s_add_u32 s30, s28, 6144
    s_add_u32 m0, s29, 6144
    s_nop 0
    buffer_load_dwordx4 v5, s[16:19], s30 offen lds
    s_add_u32 s30, s28, 7168
    s_add_u32 m0, s29, 7168
    s_nop 0
    buffer_load_dwordx4 v5, s[16:19], s30 offen lds
    s_add_u32 s30, s28, 8192
    s_add_u32 m0, s29, 8192
    s_nop 0
    buffer_load_dwordx4 v5, s[16:19], s30 offen lds
    s_add_u32 s30, s28, 9216
    s_add_u32 m0, s29, 9216
    s_nop 0
    buffer_load_dwordx4 v5, s[16:19], s30 offen lds
    s_add_u32 s30, s28, 10240
    s_add_u32 m0, s29, 10240
    s_nop 0
    buffer_load_dwordx4 v5, s[16:19], s30 offen lds
    s_add_u32 s30, s28, 11264
    s_add_u32 m0, s29, 11264
    s_nop 0
    buffer_load_dwordx4 v5, s[16:19], s30 offen lds
    s_add_u32 s30, s28, 12288
    s_add_u32 m0, s29, 12288
    s_nop 0
    buffer_load_dwordx4 v5, s[16:19], s30 offen lds
    s_add_u32 s30, s28, 13312
    s_add_u32 m0, s29, 13312
    s_nop 0
    buffer_load_dwordx4 v5, s[16:19], s30 offen lds
    s_add_u32 s30, s25, 128
    s_add_u32 m0, s26, 122880
    s_nop 0
    buffer_load_dwordx4 v28, s[12:15], s30 offen lds
    s_add_u32 s30, s25, 65664
    s_add_u32 m0, s26, 123904
    s_nop 0
    buffer_load_dwordx4 v29, s[12:15], s30 offen lds
    s_add_u32 s30, s28, 57344
    s_add_u32 m0, s29, 65536
    s_nop 0
    buffer_load_dwordx4 v5, s[16:19], s30 offen lds
    s_add_u32 s30, s28, 58368
    s_add_u32 m0, s29, 66560
    s_nop 0
    buffer_load_dwordx4 v5, s[16:19], s30 offen lds
    s_add_u32 s30, s28, 59392
    s_add_u32 m0, s29, 67584
    s_nop 0
    buffer_load_dwordx4 v5, s[16:19], s30 offen lds
    s_add_u32 s30, s28, 60416
    s_add_u32 m0, s29, 68608
    s_nop 0
    buffer_load_dwordx4 v5, s[16:19], s30 offen lds
    s_add_u32 s30, s28, 61440
    s_add_u32 m0, s29, 69632
    s_nop 0
    buffer_load_dwordx4 v5, s[16:19], s30 offen lds
    s_add_u32 s30, s28, 62464
    s_add_u32 m0, s29, 70656
    s_nop 0
    buffer_load_dwordx4 v5, s[16:19], s30 offen lds
    s_add_u32 s30, s28, 63488
    s_add_u32 m0, s29, 71680
    s_nop 0
    buffer_load_dwordx4 v5, s[16:19], s30 offen lds
    s_add_u32 s30, s28, 64512
    s_add_u32 m0, s29, 72704
    s_nop 0
    buffer_load_dwordx4 v5, s[16:19], s30 offen lds
    s_add_u32 s30, s28, 65536
    s_add_u32 m0, s29, 73728
    s_nop 0
    buffer_load_dwordx4 v5, s[16:19], s30 offen lds
    s_add_u32 s30, s28, 66560
    s_add_u32 m0, s29, 74752
    s_nop 0
    buffer_load_dwordx4 v5, s[16:19], s30 offen lds
    s_add_u32 s30, s28, 67584
    s_add_u32 m0, s29, 75776
    s_nop 0
    buffer_load_dwordx4 v5, s[16:19], s30 offen lds
    s_add_u32 s30, s28, 68608
    s_add_u32 m0, s29, 76800
    s_nop 0
    buffer_load_dwordx4 v5, s[16:19], s30 offen lds
    s_add_u32 s30, s28, 69632
    s_add_u32 m0, s29, 77824
    s_nop 0
    buffer_load_dwordx4 v5, s[16:19], s30 offen lds
    s_add_u32 s30, s28, 70656
    s_add_u32 m0, s29, 78848
    s_nop 0
    buffer_load_dwordx4 v5, s[16:19], s30 offen lds
    s_waitcnt vmcnt(16)
    s_barrier
    ds_read_b128 v[144:147], v24 offset:0
    ds_read_b128 v[148:151], v25 offset:0
    ds_read_b128 v[152:155], v24 offset:512
    ds_read_b128 v[156:159], v25 offset:512
    ds_read_b128 v[160:163], v24 offset:4096
    ds_read_b128 v[164:167], v25 offset:4096
    ds_read_b128 v[168:171], v24 offset:4608
    ds_read_b128 v[172:175], v25 offset:4608
    ds_read_b64_tr_b16 v[176:177], v12 offset:0
    ds_read_b64_tr_b16 v[178:179], v12 offset:3584
    ds_read_b64_tr_b16 v[180:181], v12 offset:32
    ds_read_b64_tr_b16 v[182:183], v12 offset:3616
    ds_read_b64_tr_b16 v[184:185], v12 offset:64
    ds_read_b64_tr_b16 v[186:187], v12 offset:3648
    s_waitcnt lgkmcnt(4)
    ds_read_b64_tr_b16 v[188:189], v12 offset:96
    ds_read_b64_tr_b16 v[190:191], v12 offset:3680
    v_mfma_f32_16x16x32_bf16 v[32:35], v[144:147], v[176:179], 0
    v_mfma_f32_16x16x32_bf16 v[36:39], v[152:155], v[176:179], 0
    v_mfma_f32_16x16x32_bf16 v[40:43], v[160:163], v[176:179], 0
    v_mfma_f32_16x16x32_bf16 v[44:47], v[168:171], v[176:179], 0
    s_waitcnt lgkmcnt(4)
    ds_read_b64_tr_b16 v[176:177], v12 offset:128
    ds_read_b64_tr_b16 v[178:179], v12 offset:3712
    v_mfma_f32_16x16x32_bf16 v[48:51], v[144:147], v[180:183], 0
    v_mfma_f32_16x16x32_bf16 v[52:55], v[152:155], v[180:183], 0
    v_mfma_f32_16x16x32_bf16 v[56:59], v[160:163], v[180:183], 0
    v_mfma_f32_16x16x32_bf16 v[60:63], v[168:171], v[180:183], 0
    s_waitcnt lgkmcnt(4)
    ds_read_b64_tr_b16 v[180:181], v12 offset:160
    ds_read_b64_tr_b16 v[182:183], v12 offset:3744
    v_mfma_f32_16x16x32_bf16 v[64:67], v[144:147], v[184:187], 0
    v_mfma_f32_16x16x32_bf16 v[68:71], v[152:155], v[184:187], 0
    v_mfma_f32_16x16x32_bf16 v[72:75], v[160:163], v[184:187], 0
    v_mfma_f32_16x16x32_bf16 v[76:79], v[168:171], v[184:187], 0
    s_waitcnt lgkmcnt(4)
    ds_read_b64_tr_b16 v[184:185], v12 offset:192
    ds_read_b64_tr_b16 v[186:187], v12 offset:3776
    v_mfma_f32_16x16x32_bf16 v[80:83], v[144:147], v[188:191], 0
    v_mfma_f32_16x16x32_bf16 v[84:87], v[152:155], v[188:191], 0
    v_mfma_f32_16x16x32_bf16 v[88:91], v[160:163], v[188:191], 0
    v_mfma_f32_16x16x32_bf16 v[92:95], v[168:171], v[188:191], 0
    s_waitcnt lgkmcnt(4)
    ds_read_b64_tr_b16 v[188:189], v12 offset:28672
    ds_read_b64_tr_b16 v[190:191], v12 offset:32256
    v_mfma_f32_16x16x32_bf16 v[96:99], v[144:147], v[176:179], 0
    v_mfma_f32_16x16x32_bf16 v[100:103], v[152:155], v[176:179], 0
    v_mfma_f32_16x16x32_bf16 v[104:107], v[160:163], v[176:179], 0
    v_mfma_f32_16x16x32_bf16 v[108:111], v[168:171], v[176:179], 0
    s_waitcnt lgkmcnt(4)
    ds_read_b64_tr_b16 v[176:177], v12 offset:28704
    ds_read_b64_tr_b16 v[178:179], v12 offset:32288
    v_mfma_f32_16x16x32_bf16 v[112:115], v[144:147], v[180:183], 0
    v_mfma_f32_16x16x32_bf16 v[116:119], v[152:155], v[180:183], 0
    v_mfma_f32_16x16x32_bf16 v[120:123], v[160:163], v[180:183], 0
    v_mfma_f32_16x16x32_bf16 v[124:127], v[168:171], v[180:183], 0
    s_waitcnt lgkmcnt(4)
    ds_read_b64_tr_b16 v[180:181], v12 offset:28736
    ds_read_b64_tr_b16 v[182:183], v12 offset:32320
    v_mfma_f32_16x16x32_bf16 v[128:131], v[144:147], v[184:187], 0
    v_mfma_f32_16x16x32_bf16 v[132:135], v[152:155], v[184:187], 0
    v_mfma_f32_16x16x32_bf16 v[136:139], v[160:163], v[184:187], 0
    v_mfma_f32_16x16x32_bf16 v[140:143], v[168:171], v[184:187], 0
    s_waitcnt lgkmcnt(4)
    ds_read_b64_tr_b16 v[184:185], v12 offset:28768
    ds_read_b64_tr_b16 v[186:187], v12 offset:32352
    v_mfma_f32_16x16x32_bf16 v[32:35], v[148:151], v[188:191], v[32:35]
    v_mfma_f32_16x16x32_bf16 v[36:39], v[156:159], v[188:191], v[36:39]
    v_mfma_f32_16x16x32_bf16 v[40:43], v[164:167], v[188:191], v[40:43]
    v_mfma_f32_16x16x32_bf16 v[44:47], v[172:175], v[188:191], v[44:47]
    s_waitcnt lgkmcnt(4)
    ds_read_b64_tr_b16 v[188:189], v12 offset:28800
    ds_read_b64_tr_b16 v[190:191], v12 offset:32384
    v_mfma_f32_16x16x32_bf16 v[48:51], v[148:151], v[176:179], v[48:51]
    v_mfma_f32_16x16x32_bf16 v[52:55], v[156:159], v[176:179], v[52:55]
    v_mfma_f32_16x16x32_bf16 v[56:59], v[164:167], v[176:179], v[56:59]
    v_mfma_f32_16x16x32_bf16 v[60:63], v[172:175], v[176:179], v[60:63]
    s_waitcnt lgkmcnt(4)
    ds_read_b64_tr_b16 v[176:177], v12 offset:28832
    ds_read_b64_tr_b16 v[178:179], v12 offset:32416
    v_mfma_f32_16x16x32_bf16 v[64:67], v[148:151], v[180:183], v[64:67]
    v_mfma_f32_16x16x32_bf16 v[68:71], v[156:159], v[180:183], v[68:71]
    v_mfma_f32_16x16x32_bf16 v[72:75], v[164:167], v[180:183], v[72:75]
    v_mfma_f32_16x16x32_bf16 v[76:79], v[172:175], v[180:183], v[76:79]
    s_waitcnt lgkmcnt(4)
    ds_read_b64_tr_b16 v[180:181], v12 offset:28864
    ds_read_b64_tr_b16 v[182:183], v12 offset:32448
    v_mfma_f32_16x16x32_bf16 v[80:83], v[148:151], v[184:187], v[80:83]
    v_mfma_f32_16x16x32_bf16 v[84:87], v[156:159], v[184:187], v[84:87]
    v_mfma_f32_16x16x32_bf16 v[88:91], v[164:167], v[184:187], v[88:91]
    v_mfma_f32_16x16x32_bf16 v[92:95], v[172:175], v[184:187], v[92:95]
    s_waitcnt lgkmcnt(4)
    v_mfma_f32_16x16x32_bf16 v[96:99], v[148:151], v[188:191], v[96:99]
    v_mfma_f32_16x16x32_bf16 v[100:103], v[156:159], v[188:191], v[100:103]
    v_mfma_f32_16x16x32_bf16 v[104:107], v[164:167], v[188:191], v[104:107]
    v_mfma_f32_16x16x32_bf16 v[108:111], v[172:175], v[188:191], v[108:111]
    s_waitcnt lgkmcnt(2)
    v_mfma_f32_16x16x32_bf16 v[112:115], v[148:151], v[176:179], v[112:115]
    v_mfma_f32_16x16x32_bf16 v[116:119], v[156:159], v[176:179], v[116:119]
    v_mfma_f32_16x16x32_bf16 v[120:123], v[164:167], v[176:179], v[120:123]
    v_mfma_f32_16x16x32_bf16 v[124:127], v[172:175], v[176:179], v[124:127]
    s_waitcnt lgkmcnt(0)
    v_mfma_f32_16x16x32_bf16 v[128:131], v[148:151], v[180:183], v[128:131]
    v_mfma_f32_16x16x32_bf16 v[132:135], v[156:159], v[180:183], v[132:135]
    v_mfma_f32_16x16x32_bf16 v[136:139], v[164:167], v[180:183], v[136:139]
    v_mfma_f32_16x16x32_bf16 v[140:143], v[172:175], v[180:183], v[140:143]
    s_barrier
    s_add_u32 s30, s25, 256
    s_add_u32 m0, s26, 57344
    s_nop 0
    buffer_load_dwordx4 v28, s[12:15], s30 offen lds
    s_add_u32 s30, s25, 65792
    s_add_u32 m0, s26, 58368
    s_nop 0
    buffer_load_dwordx4 v29, s[12:15], s30 offen lds
    s_add_u32 s30, s28, 114688
    s_add_u32 m0, s29, 0
    s_nop 0
    buffer_load_dwordx4 v5, s[16:19], s30 offen lds
    s_add_u32 s30, s28, 115712
    s_add_u32 m0, s29, 1024
    s_nop 0
    buffer_load_dwordx4 v5, s[16:19], s30 offen lds
    s_add_u32 s30, s28, 116736
    s_add_u32 m0, s29, 2048
    s_nop 0
    buffer_load_dwordx4 v5, s[16:19], s30 offen lds
    s_add_u32 s30, s28, 117760
    s_add_u32 m0, s29, 3072
    s_nop 0
    buffer_load_dwordx4 v5, s[16:19], s30 offen lds
    s_add_u32 s30, s28, 118784
    s_add_u32 m0, s29, 4096
    s_nop 0
    buffer_load_dwordx4 v5, s[16:19], s30 offen lds
    s_add_u32 s30, s28, 119808
    s_add_u32 m0, s29, 5120
    s_nop 0
    buffer_load_dwordx4 v5, s[16:19], s30 offen lds
    s_add_u32 s30, s28, 120832
    s_add_u32 m0, s29, 6144
    s_nop 0
    buffer_load_dwordx4 v5, s[16:19], s30 offen lds
    s_add_u32 s30, s28, 121856
    s_add_u32 m0, s29, 7168
    s_nop 0
    buffer_load_dwordx4 v5, s[16:19], s30 offen lds
    s_add_u32 s30, s28, 122880
    s_add_u32 m0, s29, 8192
    s_nop 0
    buffer_load_dwordx4 v5, s[16:19], s30 offen lds
    s_add_u32 s30, s28, 123904
    s_add_u32 m0, s29, 9216
    s_nop 0
    buffer_load_dwordx4 v5, s[16:19], s30 offen lds
    s_add_u32 s30, s28, 124928
    s_add_u32 m0, s29, 10240
    s_nop 0
    buffer_load_dwordx4 v5, s[16:19], s30 offen lds
    s_add_u32 s30, s28, 125952
    s_add_u32 m0, s29, 11264
    s_nop 0
    buffer_load_dwordx4 v5, s[16:19], s30 offen lds
    s_add_u32 s30, s28, 126976
    s_add_u32 m0, s29, 12288
    s_nop 0
    buffer_load_dwordx4 v5, s[16:19], s30 offen lds
    s_add_u32 s30, s28, 128000
    s_add_u32 m0, s29, 13312
    s_nop 0
    buffer_load_dwordx4 v5, s[16:19], s30 offen lds
    s_waitcnt vmcnt(16)
    s_barrier
    ds_read_b128 v[144:147], v26 offset:0
    ds_read_b128 v[148:151], v27 offset:0
    ds_read_b128 v[152:155], v26 offset:512
    ds_read_b128 v[156:159], v27 offset:512
    ds_read_b128 v[160:163], v26 offset:4096
    ds_read_b128 v[164:167], v27 offset:4096
    ds_read_b128 v[168:171], v26 offset:4608
    ds_read_b128 v[172:175], v27 offset:4608
    ds_read_b64_tr_b16 v[176:177], v14 offset:0
    ds_read_b64_tr_b16 v[178:179], v14 offset:3584
    ds_read_b64_tr_b16 v[180:181], v14 offset:32
    ds_read_b64_tr_b16 v[182:183], v14 offset:3616
    ds_read_b64_tr_b16 v[184:185], v14 offset:64
    ds_read_b64_tr_b16 v[186:187], v14 offset:3648
    s_waitcnt lgkmcnt(4)
    ds_read_b64_tr_b16 v[188:189], v14 offset:96
    ds_read_b64_tr_b16 v[190:191], v14 offset:3680
    v_mfma_f32_16x16x32_bf16 v[32:35], v[144:147], v[176:179], v[32:35]
    v_mfma_f32_16x16x32_bf16 v[36:39], v[152:155], v[176:179], v[36:39]
    v_mfma_f32_16x16x32_bf16 v[40:43], v[160:163], v[176:179], v[40:43]
    v_mfma_f32_16x16x32_bf16 v[44:47], v[168:171], v[176:179], v[44:47]
    s_waitcnt lgkmcnt(4)
    ds_read_b64_tr_b16 v[176:177], v14 offset:128
    ds_read_b64_tr_b16 v[178:179], v14 offset:3712
    v_mfma_f32_16x16x32_bf16 v[48:51], v[144:147], v[180:183], v[48:51]
    v_mfma_f32_16x16x32_bf16 v[52:55], v[152:155], v[180:183], v[52:55]
    v_mfma_f32_16x16x32_bf16 v[56:59], v[160:163], v[180:183], v[56:59]
    v_mfma_f32_16x16x32_bf16 v[60:63], v[168:171], v[180:183], v[60:63]
    s_waitcnt lgkmcnt(4)
    ds_read_b64_tr_b16 v[180:181], v14 offset:160
    ds_read_b64_tr_b16 v[182:183], v14 offset:3744
    v_mfma_f32_16x16x32_bf16 v[64:67], v[144:147], v[184:187], v[64:67]
    v_mfma_f32_16x16x32_bf16 v[68:71], v[152:155], v[184:187], v[68:71]
    v_mfma_f32_16x16x32_bf16 v[72:75], v[160:163], v[184:187], v[72:75]
    v_mfma_f32_16x16x32_bf16 v[76:79], v[168:171], v[184:187], v[76:79]
    s_waitcnt lgkmcnt(4)
    ds_read_b64_tr_b16 v[184:185], v14 offset:192
    ds_read_b64_tr_b16 v[186:187], v14 offset:3776
    v_mfma_f32_16x16x32_bf16 v[80:83], v[144:147], v[188:191], v[80:83]
    v_mfma_f32_16x16x32_bf16 v[84:87], v[152:155], v[188:191], v[84:87]
    v_mfma_f32_16x16x32_bf16 v[88:91], v[160:163], v[188:191], v[88:91]
    v_mfma_f32_16x16x32_bf16 v[92:95], v[168:171], v[188:191], v[92:95]
    s_waitcnt lgkmcnt(4)
    ds_read_b64_tr_b16 v[188:189], v14 offset:28672
    ds_read_b64_tr_b16 v[190:191], v14 offset:32256
    v_mfma_f32_16x16x32_bf16 v[96:99], v[144:147], v[176:179], v[96:99]
    v_mfma_f32_16x16x32_bf16 v[100:103], v[152:155], v[176:179], v[100:103]
    v_mfma_f32_16x16x32_bf16 v[104:107], v[160:163], v[176:179], v[104:107]
    v_mfma_f32_16x16x32_bf16 v[108:111], v[168:171], v[176:179], v[108:111]
    s_waitcnt lgkmcnt(4)
    ds_read_b64_tr_b16 v[176:177], v14 offset:28704
    ds_read_b64_tr_b16 v[178:179], v14 offset:32288
    v_mfma_f32_16x16x32_bf16 v[112:115], v[144:147], v[180:183], v[112:115]
    v_mfma_f32_16x16x32_bf16 v[116:119], v[152:155], v[180:183], v[116:119]
    v_mfma_f32_16x16x32_bf16 v[120:123], v[160:163], v[180:183], v[120:123]
    v_mfma_f32_16x16x32_bf16 v[124:127], v[168:171], v[180:183], v[124:127]
    s_waitcnt lgkmcnt(4)
    ds_read_b64_tr_b16 v[180:181], v14 offset:28736
    ds_read_b64_tr_b16 v[182:183], v14 offset:32320
    v_mfma_f32_16x16x32_bf16 v[128:131], v[144:147], v[184:187], v[128:131]
    v_mfma_f32_16x16x32_bf16 v[132:135], v[152:155], v[184:187], v[132:135]
    v_mfma_f32_16x16x32_bf16 v[136:139], v[160:163], v[184:187], v[136:139]
    v_mfma_f32_16x16x32_bf16 v[140:143], v[168:171], v[184:187], v[140:143]
    s_waitcnt lgkmcnt(4)
    ds_read_b64_tr_b16 v[184:185], v14 offset:28768
    ds_read_b64_tr_b16 v[186:187], v14 offset:32352
    v_mfma_f32_16x16x32_bf16 v[32:35], v[148:151], v[188:191], v[32:35]
    v_mfma_f32_16x16x32_bf16 v[36:39], v[156:159], v[188:191], v[36:39]
    v_mfma_f32_16x16x32_bf16 v[40:43], v[164:167], v[188:191], v[40:43]
    v_mfma_f32_16x16x32_bf16 v[44:47], v[172:175], v[188:191], v[44:47]
    s_waitcnt lgkmcnt(4)
    ds_read_b64_tr_b16 v[188:189], v14 offset:28800
    ds_read_b64_tr_b16 v[190:191], v14 offset:32384
    v_mfma_f32_16x16x32_bf16 v[48:51], v[148:151], v[176:179], v[48:51]
    v_mfma_f32_16x16x32_bf16 v[52:55], v[156:159], v[176:179], v[52:55]
    v_mfma_f32_16x16x32_bf16 v[56:59], v[164:167], v[176:179], v[56:59]
    v_mfma_f32_16x16x32_bf16 v[60:63], v[172:175], v[176:179], v[60:63]
    s_waitcnt lgkmcnt(4)
    ds_read_b64_tr_b16 v[176:177], v14 offset:28832
    ds_read_b64_tr_b16 v[178:179], v14 offset:32416
    v_mfma_f32_16x16x32_bf16 v[64:67], v[148:151], v[180:183], v[64:67]
    v_mfma_f32_16x16x32_bf16 v[68:71], v[156:159], v[180:183], v[68:71]
    v_mfma_f32_16x16x32_bf16 v[72:75], v[164:167], v[180:183], v[72:75]
    v_mfma_f32_16x16x32_bf16 v[76:79], v[172:175], v[180:183], v[76:79]
    s_waitcnt lgkmcnt(4)
    ds_read_b64_tr_b16 v[180:181], v14 offset:28864
    ds_read_b64_tr_b16 v[182:183], v14 offset:32448
    v_mfma_f32_16x16x32_bf16 v[80:83], v[148:151], v[184:187], v[80:83]
    v_mfma_f32_16x16x32_bf16 v[84:87], v[156:159], v[184:187], v[84:87]
    v_mfma_f32_16x16x32_bf16 v[88:91], v[164:167], v[184:187], v[88:91]
    v_mfma_f32_16x16x32_bf16 v[92:95], v[172:175], v[184:187], v[92:95]
    s_waitcnt lgkmcnt(4)
    v_mfma_f32_16x16x32_bf16 v[96:99], v[148:151], v[188:191], v[96:99]
    v_mfma_f32_16x16x32_bf16 v[100:103], v[156:159], v[188:191], v[100:103]
    v_mfma_f32_16x16x32_bf16 v[104:107], v[164:167], v[188:191], v[104:107]
    v_mfma_f32_16x16x32_bf16 v[108:111], v[172:175], v[188:191], v[108:111]
    s_waitcnt lgkmcnt(2)
    v_mfma_f32_16x16x32_bf16 v[112:115], v[148:151], v[176:179], v[112:115]
    v_mfma_f32_16x16x32_bf16 v[116:119], v[156:159], v[176:179], v[116:119]
    v_mfma_f32_16x16x32_bf16 v[120:123], v[164:167], v[176:179], v[120:123]
    v_mfma_f32_16x16x32_bf16 v[124:127], v[172:175], v[176:179], v[124:127]
    s_waitcnt lgkmcnt(0)
    v_mfma_f32_16x16x32_bf16 v[128:131], v[148:151], v[180:183], v[128:131]
    v_mfma_f32_16x16x32_bf16 v[132:135], v[156:159], v[180:183], v[132:135]
    v_mfma_f32_16x16x32_bf16 v[136:139], v[164:167], v[180:183], v[136:139]
    v_mfma_f32_16x16x32_bf16 v[140:143], v[172:175], v[180:183], v[140:143]
    s_barrier
    s_add_u32 s30, s25, 384
    s_add_u32 m0, s26, 122880
    s_nop 0
    buffer_load_dwordx4 v28, s[12:15], s30 offen lds
    s_add_u32 s30, s25, 65920
    s_add_u32 m0, s26, 123904
    s_nop 0
    buffer_load_dwordx4 v29, s[12:15], s30 offen lds
    s_add_u32 s30, s28, 172032
    s_add_u32 m0, s29, 65536
    s_nop 0
    buffer_load_dwordx4 v5, s[16:19], s30 offen lds
    s_add_u32 s30, s28, 173056
    s_add_u32 m0, s29, 66560
    s_nop 0
    buffer_load_dwordx4 v5, s[16:19], s30 offen lds
    s_add_u32 s30, s28, 174080
    s_add_u32 m0, s29, 67584
    s_nop 0
    buffer_load_dwordx4 v5, s[16:19], s30 offen lds
    s_add_u32 s30, s28, 175104
    s_add_u32 m0, s29, 68608
    s_nop 0
    buffer_load_dwordx4 v5, s[16:19], s30 offen lds
    s_add_u32 s30, s28, 176128
    s_add_u32 m0, s29, 69632
    s_nop 0
    buffer_load_dwordx4 v5, s[16:19], s30 offen lds
    s_add_u32 s30, s28, 177152
    s_add_u32 m0, s29, 70656
    s_nop 0
    buffer_load_dwordx4 v5, s[16:19], s30 offen lds
    s_add_u32 s30, s28, 178176
    s_add_u32 m0, s29, 71680
    s_nop 0
    buffer_load_dwordx4 v5, s[16:19], s30 offen lds
    s_add_u32 s30, s28, 179200
    s_add_u32 m0, s29, 72704
    s_nop 0
    buffer_load_dwordx4 v5, s[16:19], s30 offen lds
    s_add_u32 s30, s28, 180224
    s_add_u32 m0, s29, 73728
    s_nop 0
    buffer_load_dwordx4 v5, s[16:19], s30 offen lds
    s_add_u32 s30, s28, 181248
    s_add_u32 m0, s29, 74752
    s_nop 0
    buffer_load_dwordx4 v5, s[16:19], s30 offen lds
    s_add_u32 s30, s28, 182272
    s_add_u32 m0, s29, 75776
    s_nop 0
    buffer_load_dwordx4 v5, s[16:19], s30 offen lds
    s_add_u32 s30, s28, 183296
    s_add_u32 m0, s29, 76800
    s_nop 0
    buffer_load_dwordx4 v5, s[16:19], s30 offen lds
    s_add_u32 s30, s28, 184320
    s_add_u32 m0, s29, 77824
    s_nop 0
    buffer_load_dwordx4 v5, s[16:19], s30 offen lds
    s_add_u32 s30, s28, 185344
    s_add_u32 m0, s29, 78848
    s_nop 0
    buffer_load_dwordx4 v5, s[16:19], s30 offen lds
    s_waitcnt vmcnt(16)
    s_barrier
    ds_read_b128 v[144:147], v24 offset:0
    ds_read_b128 v[148:151], v25 offset:0
    ds_read_b128 v[152:155], v24 offset:512
    ds_read_b128 v[156:159], v25 offset:512
    ds_read_b128 v[160:163], v24 offset:4096
    ds_read_b128 v[164:167], v25 offset:4096
    ds_read_b128 v[168:171], v24 offset:4608
    ds_read_b128 v[172:175], v25 offset:4608
    ds_read_b64_tr_b16 v[176:177], v12 offset:0
    ds_read_b64_tr_b16 v[178:179], v12 offset:3584
    ds_read_b64_tr_b16 v[180:181], v12 offset:32
    ds_read_b64_tr_b16 v[182:183], v12 offset:3616
    ds_read_b64_tr_b16 v[184:185], v12 offset:64
    ds_read_b64_tr_b16 v[186:187], v12 offset:3648
    s_waitcnt lgkmcnt(4)
    ds_read_b64_tr_b16 v[188:189], v12 offset:96
    ds_read_b64_tr_b16 v[190:191], v12 offset:3680
    v_mfma_f32_16x16x32_bf16 v[32:35], v[144:147], v[176:179], v[32:35]
    v_mfma_f32_16x16x32_bf16 v[36:39], v[152:155], v[176:179], v[36:39]
    v_mfma_f32_16x16x32_bf16 v[40:43], v[160:163], v[176:179], v[40:43]
    v_mfma_f32_16x16x32_bf16 v[44:47], v[168:171], v[176:179], v[44:47]
    s_waitcnt lgkmcnt(4)
    ds_read_b64_tr_b16 v[176:177], v12 offset:128
    ds_read_b64_tr_b16 v[178:179], v12 offset:3712
    v_mfma_f32_16x16x32_bf16 v[48:51], v[144:147], v[180:183], v[48:51]
    v_mfma_f32_16x16x32_bf16 v[52:55], v[152:155], v[180:183], v[52:55]
    v_mfma_f32_16x16x32_bf16 v[56:59], v[160:163], v[180:183], v[56:59]
    v_mfma_f32_16x16x32_bf16 v[60:63], v[168:171], v[180:183], v[60:63]
    s_waitcnt lgkmcnt(4)
    ds_read_b64_tr_b16 v[180:181], v12 offset:160
    ds_read_b64_tr_b16 v[182:183], v12 offset:3744
    v_mfma_f32_16x16x32_bf16 v[64:67], v[144:147], v[184:187], v[64:67]
    v_mfma_f32_16x16x32_bf16 v[68:71], v[152:155], v[184:187], v[68:71]
    v_mfma_f32_16x16x32_bf16 v[72:75], v[160:163], v[184:187], v[72:75]
    v_mfma_f32_16x16x32_bf16 v[76:79], v[168:171], v[184:187], v[76:79]
    s_waitcnt lgkmcnt(4)
    ds_read_b64_tr_b16 v[184:185], v12 offset:192
    ds_read_b64_tr_b16 v[186:187], v12 offset:3776
    v_mfma_f32_16x16x32_bf16 v[80:83], v[144:147], v[188:191], v[80:83]
    v_mfma_f32_16x16x32_bf16 v[84:87], v[152:155], v[188:191], v[84:87]
    v_mfma_f32_16x16x32_bf16 v[88:91], v[160:163], v[188:191], v[88:91]
    v_mfma_f32_16x16x32_bf16 v[92:95], v[168:171], v[188:191], v[92:95]
    s_waitcnt lgkmcnt(4)
    ds_read_b64_tr_b16 v[188:189], v12 offset:28672
    ds_read_b64_tr_b16 v[190:191], v12 offset:32256
    v_mfma_f32_16x16x32_bf16 v[96:99], v[144:147], v[176:179], v[96:99]
    v_mfma_f32_16x16x32_bf16 v[100:103], v[152:155], v[176:179], v[100:103]
    v_mfma_f32_16x16x32_bf16 v[104:107], v[160:163], v[176:179], v[104:107]
    v_mfma_f32_16x16x32_bf16 v[108:111], v[168:171], v[176:179], v[108:111]
    s_waitcnt lgkmcnt(4)
    ds_read_b64_tr_b16 v[176:177], v12 offset:28704
    ds_read_b64_tr_b16 v[178:179], v12 offset:32288
    v_mfma_f32_16x16x32_bf16 v[112:115], v[144:147], v[180:183], v[112:115]
    v_mfma_f32_16x16x32_bf16 v[116:119], v[152:155], v[180:183], v[116:119]
    v_mfma_f32_16x16x32_bf16 v[120:123], v[160:163], v[180:183], v[120:123]
    v_mfma_f32_16x16x32_bf16 v[124:127], v[168:171], v[180:183], v[124:127]
    s_waitcnt lgkmcnt(4)
    ds_read_b64_tr_b16 v[180:181], v12 offset:28736
    ds_read_b64_tr_b16 v[182:183], v12 offset:32320
    v_mfma_f32_16x16x32_bf16 v[128:131], v[144:147], v[184:187], v[128:131]
    v_mfma_f32_16x16x32_bf16 v[132:135], v[152:155], v[184:187], v[132:135]
    v_mfma_f32_16x16x32_bf16 v[136:139], v[160:163], v[184:187], v[136:139]
    v_mfma_f32_16x16x32_bf16 v[140:143], v[168:171], v[184:187], v[140:143]
    s_waitcnt lgkmcnt(4)
    ds_read_b64_tr_b16 v[184:185], v12 offset:28768
    ds_read_b64_tr_b16 v[186:187], v12 offset:32352
    v_mfma_f32_16x16x32_bf16 v[32:35], v[148:151], v[188:191], v[32:35]
    v_mfma_f32_16x16x32_bf16 v[36:39], v[156:159], v[188:191], v[36:39]
    v_mfma_f32_16x16x32_bf16 v[40:43], v[164:167], v[188:191], v[40:43]
    v_mfma_f32_16x16x32_bf16 v[44:47], v[172:175], v[188:191], v[44:47]
    s_waitcnt lgkmcnt(4)
    ds_read_b64_tr_b16 v[188:189], v12 offset:28800
    ds_read_b64_tr_b16 v[190:191], v12 offset:32384
    v_mfma_f32_16x16x32_bf16 v[48:51], v[148:151], v[176:179], v[48:51]
    v_mfma_f32_16x16x32_bf16 v[52:55], v[156:159], v[176:179], v[52:55]
    v_mfma_f32_16x16x32_bf16 v[56:59], v[164:167], v[176:179], v[56:59]
    v_mfma_f32_16x16x32_bf16 v[60:63], v[172:175], v[176:179], v[60:63]
    s_waitcnt lgkmcnt(4)
    ds_read_b64_tr_b16 v[176:177], v12 offset:28832
    ds_read_b64_tr_b16 v[178:179], v12 offset:32416
    v_mfma_f32_16x16x32_bf16 v[64:67], v[148:151], v[180:183], v[64:67]
    v_mfma_f32_16x16x32_bf16 v[68:71], v[156:159], v[180:183], v[68:71]
    v_mfma_f32_16x16x32_bf16 v[72:75], v[164:167], v[180:183], v[72:75]
    v_mfma_f32_16x16x32_bf16 v[76:79], v[172:175], v[180:183], v[76:79]
    s_waitcnt lgkmcnt(4)
    ds_read_b64_tr_b16 v[180:181], v12 offset:28864
    ds_read_b64_tr_b16 v[182:183], v12 offset:32448
    v_mfma_f32_16x16x32_bf16 v[80:83], v[148:151], v[184:187], v[80:83]
    v_mfma_f32_16x16x32_bf16 v[84:87], v[156:159], v[184:187], v[84:87]
    v_mfma_f32_16x16x32_bf16 v[88:91], v[164:167], v[184:187], v[88:91]
    v_mfma_f32_16x16x32_bf16 v[92:95], v[172:175], v[184:187], v[92:95]
    s_waitcnt lgkmcnt(4)
    v_mfma_f32_16x16x32_bf16 v[96:99], v[148:151], v[188:191], v[96:99]
    v_mfma_f32_16x16x32_bf16 v[100:103], v[156:159], v[188:191], v[100:103]
    v_mfma_f32_16x16x32_bf16 v[104:107], v[164:167], v[188:191], v[104:107]
    v_mfma_f32_16x16x32_bf16 v[108:111], v[172:175], v[188:191], v[108:111]
    s_waitcnt lgkmcnt(2)
    v_mfma_f32_16x16x32_bf16 v[112:115], v[148:151], v[176:179], v[112:115]
    v_mfma_f32_16x16x32_bf16 v[116:119], v[156:159], v[176:179], v[116:119]
    v_mfma_f32_16x16x32_bf16 v[120:123], v[164:167], v[176:179], v[120:123]
    v_mfma_f32_16x16x32_bf16 v[124:127], v[172:175], v[176:179], v[124:127]
    s_waitcnt lgkmcnt(0)
    v_mfma_f32_16x16x32_bf16 v[128:131], v[148:151], v[180:183], v[128:131]
    v_mfma_f32_16x16x32_bf16 v[132:135], v[156:159], v[180:183], v[132:135]
    v_mfma_f32_16x16x32_bf16 v[136:139], v[164:167], v[180:183], v[136:139]
    v_mfma_f32_16x16x32_bf16 v[140:143], v[172:175], v[180:183], v[140:143]
    s_waitcnt vmcnt(0)
    s_barrier
    ds_read_b128 v[144:147], v26 offset:0
    ds_read_b128 v[148:151], v27 offset:0
    ds_read_b128 v[152:155], v26 offset:512
    ds_read_b128 v[156:159], v27 offset:512
    ds_read_b128 v[160:163], v26 offset:4096
    ds_read_b128 v[164:167], v27 offset:4096
    ds_read_b128 v[168:171], v26 offset:4608
    ds_read_b128 v[172:175], v27 offset:4608
    ds_read_b64_tr_b16 v[176:177], v14 offset:0
    ds_read_b64_tr_b16 v[178:179], v14 offset:3584
    ds_read_b64_tr_b16 v[180:181], v14 offset:32
    ds_read_b64_tr_b16 v[182:183], v14 offset:3616
    ds_read_b64_tr_b16 v[184:185], v14 offset:64
    ds_read_b64_tr_b16 v[186:187], v14 offset:3648
    s_waitcnt lgkmcnt(4)
    ds_read_b64_tr_b16 v[188:189], v14 offset:96
    ds_read_b64_tr_b16 v[190:191], v14 offset:3680
    v_mfma_f32_16x16x32_bf16 v[32:35], v[144:147], v[176:179], v[32:35]
    v_mfma_f32_16x16x32_bf16 v[36:39], v[152:155], v[176:179], v[36:39]
    v_mfma_f32_16x16x32_bf16 v[40:43], v[160:163], v[176:179], v[40:43]
    v_mfma_f32_16x16x32_bf16 v[44:47], v[168:171], v[176:179], v[44:47]
    s_waitcnt lgkmcnt(4)
    ds_read_b64_tr_b16 v[176:177], v14 offset:128
    ds_read_b64_tr_b16 v[178:179], v14 offset:3712
    v_mfma_f32_16x16x32_bf16 v[48:51], v[144:147], v[180:183], v[48:51]
    v_mfma_f32_16x16x32_bf16 v[52:55], v[152:155], v[180:183], v[52:55]
    v_mfma_f32_16x16x32_bf16 v[56:59], v[160:163], v[180:183], v[56:59]
    v_mfma_f32_16x16x32_bf16 v[60:63], v[168:171], v[180:183], v[60:63]
    s_waitcnt lgkmcnt(4)
    ds_read_b64_tr_b16 v[180:181], v14 offset:160
    ds_read_b64_tr_b16 v[182:183], v14 offset:3744
    v_mfma_f32_16x16x32_bf16 v[64:67], v[144:147], v[184:187], v[64:67]
    v_mfma_f32_16x16x32_bf16 v[68:71], v[152:155], v[184:187], v[68:71]
    v_mfma_f32_16x16x32_bf16 v[72:75], v[160:163], v[184:187], v[72:75]
    v_mfma_f32_16x16x32_bf16 v[76:79], v[168:171], v[184:187], v[76:79]
    s_waitcnt lgkmcnt(4)
    ds_read_b64_tr_b16 v[184:185], v14 offset:192
    ds_read_b64_tr_b16 v[186:187], v14 offset:3776
    v_mfma_f32_16x16x32_bf16 v[80:83], v[144:147], v[188:191], v[80:83]
    v_mfma_f32_16x16x32_bf16 v[84:87], v[152:155], v[188:191], v[84:87]
    v_mfma_f32_16x16x32_bf16 v[88:91], v[160:163], v[188:191], v[88:91]
    v_mfma_f32_16x16x32_bf16 v[92:95], v[168:171], v[188:191], v[92:95]
    s_waitcnt lgkmcnt(4)
    ds_read_b64_tr_b16 v[188:189], v14 offset:28672
    ds_read_b64_tr_b16 v[190:191], v14 offset:32256
    v_mfma_f32_16x16x32_bf16 v[96:99], v[144:147], v[176:179], v[96:99]
    v_mfma_f32_16x16x32_bf16 v[100:103], v[152:155], v[176:179], v[100:103]
    v_mfma_f32_16x16x32_bf16 v[104:107], v[160:163], v[176:179], v[104:107]
    v_mfma_f32_16x16x32_bf16 v[108:111], v[168:171], v[176:179], v[108:111]
    s_waitcnt lgkmcnt(4)
    ds_read_b64_tr_b16 v[176:177], v14 offset:28704
    ds_read_b64_tr_b16 v[178:179], v14 offset:32288
    v_mfma_f32_16x16x32_bf16 v[112:115], v[144:147], v[180:183], v[112:115]
    v_mfma_f32_16x16x32_bf16 v[116:119], v[152:155], v[180:183], v[116:119]
    v_mfma_f32_16x16x32_bf16 v[120:123], v[160:163], v[180:183], v[120:123]
    v_mfma_f32_16x16x32_bf16 v[124:127], v[168:171], v[180:183], v[124:127]
    s_waitcnt lgkmcnt(4)
    ds_read_b64_tr_b16 v[180:181], v14 offset:28736
    ds_read_b64_tr_b16 v[182:183], v14 offset:32320
    v_mfma_f32_16x16x32_bf16 v[128:131], v[144:147], v[184:187], v[128:131]
    v_mfma_f32_16x16x32_bf16 v[132:135], v[152:155], v[184:187], v[132:135]
    v_mfma_f32_16x16x32_bf16 v[136:139], v[160:163], v[184:187], v[136:139]
    v_mfma_f32_16x16x32_bf16 v[140:143], v[168:171], v[184:187], v[140:143]
    s_waitcnt lgkmcnt(4)
    ds_read_b64_tr_b16 v[184:185], v14 offset:28768
    ds_read_b64_tr_b16 v[186:187], v14 offset:32352
    v_mfma_f32_16x16x32_bf16 v[32:35], v[148:151], v[188:191], v[32:35]
    v_mfma_f32_16x16x32_bf16 v[36:39], v[156:159], v[188:191], v[36:39]
    v_mfma_f32_16x16x32_bf16 v[40:43], v[164:167], v[188:191], v[40:43]
    v_mfma_f32_16x16x32_bf16 v[44:47], v[172:175], v[188:191], v[44:47]
    s_waitcnt lgkmcnt(4)
    ds_read_b64_tr_b16 v[188:189], v14 offset:28800
    ds_read_b64_tr_b16 v[190:191], v14 offset:32384
    v_mfma_f32_16x16x32_bf16 v[48:51], v[148:151], v[176:179], v[48:51]
    v_mfma_f32_16x16x32_bf16 v[52:55], v[156:159], v[176:179], v[52:55]
    v_mfma_f32_16x16x32_bf16 v[56:59], v[164:167], v[176:179], v[56:59]
    v_mfma_f32_16x16x32_bf16 v[60:63], v[172:175], v[176:179], v[60:63]
    s_waitcnt lgkmcnt(4)
    ds_read_b64_tr_b16 v[176:177], v14 offset:28832
    ds_read_b64_tr_b16 v[178:179], v14 offset:32416
    v_mfma_f32_16x16x32_bf16 v[64:67], v[148:151], v[180:183], v[64:67]
    v_mfma_f32_16x16x32_bf16 v[68:71], v[156:159], v[180:183], v[68:71]
    v_mfma_f32_16x16x32_bf16 v[72:75], v[164:167], v[180:183], v[72:75]
    v_mfma_f32_16x16x32_bf16 v[76:79], v[172:175], v[180:183], v[76:79]
    s_waitcnt lgkmcnt(4)
    ds_read_b64_tr_b16 v[180:181], v14 offset:28864
    ds_read_b64_tr_b16 v[182:183], v14 offset:32448
    v_mfma_f32_16x16x32_bf16 v[80:83], v[148:151], v[184:187], v[80:83]
    v_mfma_f32_16x16x32_bf16 v[84:87], v[156:159], v[184:187], v[84:87]
    v_mfma_f32_16x16x32_bf16 v[88:91], v[164:167], v[184:187], v[88:91]
    v_mfma_f32_16x16x32_bf16 v[92:95], v[172:175], v[184:187], v[92:95]
    s_waitcnt lgkmcnt(4)
    v_mfma_f32_16x16x32_bf16 v[96:99], v[148:151], v[188:191], v[96:99]
    v_mfma_f32_16x16x32_bf16 v[100:103], v[156:159], v[188:191], v[100:103]
    v_mfma_f32_16x16x32_bf16 v[104:107], v[164:167], v[188:191], v[104:107]
    v_mfma_f32_16x16x32_bf16 v[108:111], v[172:175], v[188:191], v[108:111]
    s_waitcnt lgkmcnt(2)
    v_mfma_f32_16x16x32_bf16 v[112:115], v[148:151], v[176:179], v[112:115]
    v_mfma_f32_16x16x32_bf16 v[116:119], v[156:159], v[176:179], v[116:119]
    v_mfma_f32_16x16x32_bf16 v[120:123], v[164:167], v[176:179], v[120:123]
    v_mfma_f32_16x16x32_bf16 v[124:127], v[172:175], v[176:179], v[124:127]
    s_waitcnt lgkmcnt(0)
    v_mfma_f32_16x16x32_bf16 v[128:131], v[148:151], v[180:183], v[128:131]
    v_mfma_f32_16x16x32_bf16 v[132:135], v[156:159], v[180:183], v[132:135]
    v_mfma_f32_16x16x32_bf16 v[136:139], v[164:167], v[180:183], v[136:139]
    v_mfma_f32_16x16x32_bf16 v[140:143], v[172:175], v[180:183], v[140:143]
    s_mov_b32 s39, 0x3f800000
K1_EPI:
    s_nop 7
    s_nop 7
    s_lshl_b32 s36, s23, 4
    s_add_u32 s36, s36, s21
    s_mul_i32 s36, s36, 28
    s_mul_i32 s37, s20, 7
    s_add_u32 s36, s36, s37
    s_mul_i32 s36, s36, 7
    s_add_u32 s36, s36, s22
    s_lshl_b32 s36, s36, 11
    s_add_u32 s36, s36, 4194304
    v_mul_f32 v32, s39, v32
    v_mul_f32 v33, s39, v33
    v_mul_f32 v34, s39, v34
    v_mul_f32 v35, s39, v35
    v_cvt_pk_bf16_f32 v144, v32, v33
    v_cvt_pk_bf16_f32 v145, v34, v35
    v_mul_f32 v36, s39, v36
    v_mul_f32 v37, s39, v37
    v_mul_f32 v38, s39, v38
    v_mul_f32 v39, s39, v39
    v_cvt_pk_bf16_f32 v146, v36, v37
    v_cvt_pk_bf16_f32 v147, v38, v39
    buffer_store_dwordx4 v[144:147], v5, s[8:11], s36 offen offset:0
    v_mul_f32 v40, s39, v40
    v_mul_f32 v41, s39, v41
    v_mul_f32 v42, s39, v42
    v_mul_f32 v43, s39, v43
    v_cvt_pk_bf16_f32 v148, v40, v41
    v_cvt_pk_bf16_f32 v149, v42, v43
    v_mul_f32 v44, s39, v44
    v_mul_f32 v45, s39, v45
    v_mul_f32 v46, s39, v46
    v_mul_f32 v47, s39, v47
    v_cvt_pk_bf16_f32 v150, v44, v45
    v_cvt_pk_bf16_f32 v151, v46, v47
    buffer_store_dwordx4 v[148:151], v5, s[8:11], s36 offen offset:1024
    s_add_u32 s36, s36, 14336
    v_mul_f32 v48, s39, v48
    v_mul_f32 v49, s39, v49
    v_mul_f32 v50, s39, v50
    v_mul_f32 v51, s39, v51
    v_cvt_pk_bf16_f32 v152, v48, v49
    v_cvt_pk_bf16_f32 v153, v50, v51
    v_mul_f32 v52, s39, v52
    v_mul_f32 v53, s39, v53
    v_mul_f32 v54, s39, v54
    v_mul_f32 v55, s39, v55
    v_cvt_pk_bf16_f32 v154, v52, v53
    v_cvt_pk_bf16_f32 v155, v54, v55
    buffer_store_dwordx4 v[152:155], v5, s[8:11], s36 offen offset:0
    v_mul_f32 v56, s39, v56
    v_mul_f32 v57, s39, v57
    v_mul_f32 v58, s39, v58
    v_mul_f32 v59, s39, v59
    v_cvt_pk_bf16_f32 v156, v56, v57
    v_cvt_pk_bf16_f32 v157, v58, v59
    v_mul_f32 v60, s39, v60
    v_mul_f32 v61, s39, v61
    v_mul_f32 v62, s39, v62
    v_mul_f32 v63, s39, v63
    v_cvt_pk_bf16_f32 v158, v60, v61
    v_cvt_pk_bf16_f32 v159, v62, v63
    buffer_store_dwordx4 v[156:159], v5, s[8:11], s36 offen offset:1024
    s_add_u32 s36, s36, 14336
    v_mul_f32 v64, s39, v64
    v_mul_f32 v65, s39, v65
    v_mul_f32 v66, s39, v66
    v_mul_f32 v67, s39, v67
    v_cvt_pk_bf16_f32 v160, v64, v65
    v_cvt_pk_bf16_f32 v161, v66, v67
    v_mul_f32 v68, s39, v68
    v_mul_f32 v69, s39, v69
    v_mul_f32 v70, s39, v70
    v_mul_f32 v71, s39, v71
    v_cvt_pk_bf16_f32 v162, v68, v69
    v_cvt_pk_bf16_f32 v163, v70, v71
    buffer_store_dwordx4 v[160:163], v5, s[8:11], s36 offen offset:0
    v_mul_f32 v72, s39, v72
    v_mul_f32 v73, s39, v73
    v_mul_f32 v74, s39, v74
    v_mul_f32 v75, s39, v75
    v_cvt_pk_bf16_f32 v164, v72, v73
    v_cvt_pk_bf16_f32 v165, v74, v75
    v_mul_f32 v76, s39, v76
    v_mul_f32 v77, s39, v77
    v_mul_f32 v78, s39, v78
    v_mul_f32 v79, s39, v79
    v_cvt_pk_bf16_f32 v166, v76, v77
    v_cvt_pk_bf16_f32 v167, v78, v79
    buffer_store_dwordx4 v[164:167], v5, s[8:11], s36 offen offset:1024
    s_add_u32 s36, s36, 14336
    v_mul_f32 v80, s39, v80
    v_mul_f32 v81, s39, v81
    v_mul_f32 v82, s39, v82
    v_mul_f32 v83, s39, v83
    v_cvt_pk_bf16_f32 v168, v80, v81
    v_cvt_pk_bf16_f32 v169, v82, v83
    v_mul_f32 v84, s39, v84
    v_mul_f32 v85, s39, v85
    v_mul_f32 v86, s39, v86
    v_mul_f32 v87, s39, v87
    v_cvt_pk_bf16_f32 v170, v84, v85
    v_cvt_pk_bf16_f32 v171, v86, v87
    buffer_store_dwordx4 v[168:171], v5, s[8:11], s36 offen offset:0
    v_mul_f32 v88, s39, v88
    v_mul_f32 v89, s39, v89
    v_mul_f32 v90, s39, v90
    v_mul_f32 v91, s39, v91
    v_cvt_pk_bf16_f32 v172, v88, v89
    v_cvt_pk_bf16_f32 v173, v90, v91
    v_mul_f32 v92, s39, v92
    v_mul_f32 v93, s39, v93
    v_mul_f32 v94, s39, v94
    v_mul_f32 v95, s39, v95
    v_cvt_pk_bf16_f32 v174, v92, v93
    v_cvt_pk_bf16_f32 v175, v94, v95
    buffer_store_dwordx4 v[172:175], v5, s[8:11], s36 offen offset:1024
    s_waitcnt vmcnt(0)
    s_add_u32 s36, s36, 14336
    v_mul_f32 v96, s39, v96
    v_mul_f32 v97, s39, v97
    v_mul_f32 v98, s39, v98
    v_mul_f32 v99, s39, v99
    v_cvt_pk_bf16_f32 v144, v96, v97
    v_cvt_pk_bf16_f32 v145, v98, v99
    v_mul_f32 v100, s39, v100
    v_mul_f32 v101, s39, v101
    v_mul_f32 v102, s39, v102
    v_mul_f32 v103, s39, v103
    v_cvt_pk_bf16_f32 v146, v100, v101
    v_cvt_pk_bf16_f32 v147, v102, v103
    buffer_store_dwordx4 v[144:147], v5, s[8:11], s36 offen offset:0
    v_mul_f32 v104, s39, v104
    v_mul_f32 v105, s39, v105
    v_mul_f32 v106, s39, v106
    v_mul_f32 v107, s39, v107
    v_cvt_pk_bf16_f32 v148, v104, v105
    v_cvt_pk_bf16_f32 v149, v106, v107
    v_mul_f32 v108, s39, v108
    v_mul_f32 v109, s39, v109
    v_mul_f32 v110, s39, v110
    v_mul_f32 v111, s39, v111
    v_cvt_pk_bf16_f32 v150, v108, v109
    v_cvt_pk_bf16_f32 v151, v110, v111
    buffer_store_dwordx4 v[148:151], v5, s[8:11], s36 offen offset:1024
    s_add_u32 s36, s36, 14336
    v_mul_f32 v112, s39, v112
    v_mul_f32 v113, s39, v113
    v_mul_f32 v114, s39, v114
    v_mul_f32 v115, s39, v115
    v_cvt_pk_bf16_f32 v152, v112, v113
    v_cvt_pk_bf16_f32 v153, v114, v115
    v_mul_f32 v116, s39, v116
    v_mul_f32 v117, s39, v117
    v_mul_f32 v118, s39, v118
    v_mul_f32 v119, s39, v119
    v_cvt_pk_bf16_f32 v154, v116, v117
    v_cvt_pk_bf16_f32 v155, v118, v119
    buffer_store_dwordx4 v[152:155], v5, s[8:11], s36 offen offset:0
    v_mul_f32 v120, s39, v120
    v_mul_f32 v121, s39, v121
    v_mul_f32 v122, s39, v122
    v_mul_f32 v123, s39, v123
    v_cvt_pk_bf16_f32 v156, v120, v121
    v_cvt_pk_bf16_f32 v157, v122, v123
    v_mul_f32 v124, s39, v124
    v_mul_f32 v125, s39, v125
    v_mul_f32 v126, s39, v126
    v_mul_f32 v127, s39, v127
    v_cvt_pk_bf16_f32 v158, v124, v125
    v_cvt_pk_bf16_f32 v159, v126, v127
    buffer_store_dwordx4 v[156:159], v5, s[8:11], s36 offen offset:1024
    s_add_u32 s36, s36, 14336
    v_mul_f32 v128, s39, v128
    v_mul_f32 v129, s39, v129
    v_mul_f32 v130, s39, v130
    v_mul_f32 v131, s39, v131
    v_cvt_pk_bf16_f32 v160, v128, v129
    v_cvt_pk_bf16_f32 v161, v130, v131
    v_mul_f32 v132, s39, v132
    v_mul_f32 v133, s39, v133
    v_mul_f32 v134, s39, v134
    v_mul_f32 v135, s39, v135
    v_cvt_pk_bf16_f32 v162, v132, v133
    v_cvt_pk_bf16_f32 v163, v134, v135
    buffer_store_dwordx4 v[160:163], v5, s[8:11], s36 offen offset:0
    v_mul_f32 v136, s39, v136
    v_mul_f32 v137, s39, v137
    v_mul_f32 v138, s39, v138
    v_mul_f32 v139, s39, v139
    v_cvt_pk_bf16_f32 v164, v136, v137
    v_cvt_pk_bf16_f32 v165, v138, v139
    v_mul_f32 v140, s39, v140
    v_mul_f32 v141, s39, v141
    v_mul_f32 v142, s39, v142
    v_mul_f32 v143, s39, v143
    v_cvt_pk_bf16_f32 v166, v140, v141
    v_cvt_pk_bf16_f32 v167, v142, v143
    buffer_store_dwordx4 v[164:167], v5, s[8:11], s36 offen offset:1024
    s_add_u32 s36, s36, 14336
    s_waitcnt vmcnt(0)
    s_endpgm
K1_MISC:
    s_sub_u32 s35, s2, 224
    s_lshl_b32 s35, s35, 2
    s_add_u32 s35, s35, s20
    s_mov_b32 s12, s48
    s_mov_b32 s13, s49
    s_and_b32 s13, s13, 0xffff
    s_mov_b32 s14, 1835008
    s_mov_b32 s15, 0x00020000
    v_and_b32 v6, 15, v1
    v_lshrrev_b32 v7, 4, v1
    v_mul_u32_u24 v8, 896, v6
    v_lshl_add_u32 v2, v7, 4, v8
    s_mul_i32 s36, s35, 14336
    buffer_load_dwordx4 v[16:19], v2, s[12:15], s36 offen offset:0
    buffer_load_dwordx4 v[20:23], v2, s[12:15], s36 offen offset:64
    buffer_load_dwordx4 v[24:27], v2, s[12:15], s36 offen offset:128
    buffer_load_dwordx4 v[28:31], v2, s[12:15], s36 offen offset:192
    buffer_load_dwordx4 v[32:35], v2, s[12:15], s36 offen offset:256
    buffer_load_dwordx4 v[36:39], v2, s[12:15], s36 offen offset:320
    buffer_load_dwordx4 v[40:43], v2, s[12:15], s36 offen offset:384
    buffer_load_dwordx4 v[44:47], v2, s[12:15], s36 offen offset:448
    buffer_load_dwordx4 v[48:51], v2, s[12:15], s36 offen offset:512
    buffer_load_dwordx4 v[52:55], v2, s[12:15], s36 offen offset:576
    buffer_load_dwordx4 v[56:59], v2, s[12:15], s36 offen offset:640
    buffer_load_dwordx4 v[60:63], v2, s[12:15], s36 offen offset:704
    buffer_load_dwordx4 v[64:67], v2, s[12:15], s36 offen offset:768
    buffer_load_dwordx4 v[68:71], v2, s[12:15], s36 offen offset:832
    v_mov_b32 v12, 4290772927
    v_mov_b32 v13, v12
    v_mov_b32 v14, v12
    v_mov_b32 v15, v12
    s_mul_i32 s37, s35, 13312
    s_add_u32 s37, s37, 91234304
    buffer_store_dwordx4 v[12:15], v5, s[8:11], s37 offen offset:0
    buffer_store_dwordx4 v[12:15], v5, s[8:11], s37 offen offset:1024
    buffer_store_dwordx4 v[12:15], v5, s[8:11], s37 offen offset:2048
    buffer_store_dwordx4 v[12:15], v5, s[8:11], s37 offen offset:3072
    s_add_u32 s37, s37, 4096
    buffer_store_dwordx4 v[12:15], v5, s[8:11], s37 offen offset:0
    buffer_store_dwordx4 v[12:15], v5, s[8:11], s37 offen offset:1024
    buffer_store_dwordx4 v[12:15], v5, s[8:11], s37 offen offset:2048
    buffer_store_dwordx4 v[12:15], v5, s[8:11], s37 offen offset:3072
    s_add_u32 s37, s37, 4096
    buffer_store_dwordx4 v[12:15], v5, s[8:11], s37 offen offset:0
    buffer_store_dwordx4 v[12:15], v5, s[8:11], s37 offen offset:1024
    buffer_store_dwordx4 v[12:15], v5, s[8:11], s37 offen offset:2048
    buffer_store_dwordx4 v[12:15], v5, s[8:11], s37 offen offset:3072
    s_add_u32 s37, s37, 4096
    buffer_store_dwordx4 v[12:15], v5, s[8:11], s37 offen offset:0
    s_lshl_b32 s37, s35, 12
    s_add_u32 s37, s37, 93593600
    buffer_store_dwordx4 v[12:15], v5, s[8:11], s37 offen offset:0
    buffer_store_dwordx4 v[12:15], v5, s[8:11], s37 offen offset:1024
    buffer_store_dwordx4 v[12:15], v5, s[8:11], s37 offen offset:2048
    buffer_store_dwordx4 v[12:15], v5, s[8:11], s37 offen offset:3072
    s_cmp_lt_u32 s35, 16
    s_cbranch_scc0 K1_NOCNT
    v_mov_b32 v8, 0
    v_mov_b32 v9, 0
    v_mov_b32 v10, 0
    v_mov_b32 v11, 0
    s_lshl_b32 s37, s35, 10
    s_add_u32 s37, s37, 92995584
    buffer_store_dwordx4 v[8:11], v5, s[8:11], s37 offen
K1_NOCNT:
    s_sub_u32 s37, s35, 16
    s_cmp_lt_u32 s37, 20
    s_cbranch_scc0 K1_NOFL
    v_mov_b32 v8, 0
    v_mov_b32 v9, 0
    v_mov_b32 v10, 0
    v_mov_b32 v11, 0
    s_lshl_b32 s37, s37, 10
    s_add_u32 s37, s37, 94175232
    buffer_store_dwordx4 v[8:11], v5, s[8:11], s37 offen
K1_NOFL:
    s_mov_b32 s38, 0x3727c5ac
    s_mov_b32 s39, 0x3b124925
    v_and_b32 v9, 1, v7
    v_lshl_add_u32 v9, v9, 5, v6
    v_lshlrev_b32 v9, 4, v9
    v_lshrrev_b32 v10, 1, v7
    v_lshl_add_u32 v3, v10, 3, v9
    s_waitcnt vmcnt(0)
    v_lshlrev_b32 v72, 16, v16
    v_and_b32 v73, 0xffff0000, v16
    v_lshlrev_b32 v74, 16, v17
    v_and_b32 v75, 0xffff0000, v17
    v_lshlrev_b32 v76, 16, v18
    v_and_b32 v77, 0xffff0000, v18
    v_lshlrev_b32 v78, 16, v19
    v_and_b32 v79, 0xffff0000, v19
    v_lshlrev_b32 v80, 16, v20
    v_and_b32 v81, 0xffff0000, v20
    v_lshlrev_b32 v82, 16, v21
    v_and_b32 v83, 0xffff0000, v21
    v_lshlrev_b32 v84, 16, v22
    v_and_b32 v85, 0xffff0000, v22
    v_lshlrev_b32 v86, 16, v23
    v_and_b32 v87, 0xffff0000, v23
    v_lshlrev_b32 v88, 16, v24
    v_and_b32 v89, 0xffff0000, v24
    v_lshlrev_b32 v90, 16, v25
    v_and_b32 v91, 0xffff0000, v25
    v_lshlrev_b32 v92, 16, v26
    v_and_b32 v93, 0xffff0000, v26
    v_lshlrev_b32 v94, 16, v27
    v_and_b32 v95, 0xffff0000, v27
    v_lshlrev_b32 v96, 16, v28
    v_and_b32 v97, 0xffff0000, v28
    v_lshlrev_b32 v98, 16, v29
    v_and_b32 v99, 0xffff0000, v29
    v_lshlrev_b32 v100, 16, v30
    v_and_b32 v101, 0xffff0000, v30
    v_lshlrev_b32 v102, 16, v31
    v_and_b32 v103, 0xffff0000, v31
    v_lshlrev_b32 v104, 16, v32
    v_and_b32 v105, 0xffff0000, v32
    v_lshlrev_b32 v106, 16, v33
    v_and_b32 v107, 0xffff0000, v33
    v_lshlrev_b32 v108, 16, v34
    v_and_b32 v109, 0xffff0000, v34
    v_lshlrev_b32 v110, 16, v35
    v_and_b32 v111, 0xffff0000, v35
    v_lshlrev_b32 v112, 16, v36
    v_and_b32 v113, 0xffff0000, v36
    v_lshlrev_b32 v114, 16, v37
    v_and_b32 v115, 0xffff0000, v37
    v_lshlrev_b32 v116, 16, v38
    v_and_b32 v117, 0xffff0000, v38
    v_lshlrev_b32 v118, 16, v39
    v_and_b32 v119, 0xffff0000, v39
    v_lshlrev_b32 v120, 16, v40
    v_and_b32 v121, 0xffff0000, v40
    v_lshlrev_b32 v122, 16, v41
    v_and_b32 v123, 0xffff0000, v41
    v_lshlrev_b32 v124, 16, v42
    v_and_b32 v125, 0xffff0000, v42
    v_lshlrev_b32 v126, 16, v43
    v_and_b32 v127, 0xffff0000, v43
    v_lshlrev_b32 v128, 16, v44
    v_and_b32 v129, 0xffff0000, v44
    v_lshlrev_b32 v130, 16, v45
    v_and_b32 v131, 0xffff0000, v45
    v_lshlrev_b32 v132, 16, v46
    v_and_b32 v133, 0xffff0000, v46
    v_lshlrev_b32 v134, 16, v47
    v_and_b32 v135, 0xffff0000, v47
    v_lshlrev_b32 v136, 16, v48
    v_and_b32 v137, 0xffff0000, v48
    v_lshlrev_b32 v138, 16, v49
    v_and_b32 v139, 0xffff0000, v49
    v_lshlrev_b32 v140, 16, v50
    v_and_b32 v141, 0xffff0000, v50
    v_lshlrev_b32 v142, 16, v51
    v_and_b32 v143, 0xffff0000, v51
    v_lshlrev_b32 v144, 16, v52
    v_and_b32 v145, 0xffff0000, v52
    v_lshlrev_b32 v146, 16, v53
    v_and_b32 v147, 0xffff0000, v53
    v_lshlrev_b32 v148, 16, v54
    v_and_b32 v149, 0xffff0000, v54
    v_lshlrev_b32 v150, 16, v55
    v_and_b32 v151, 0xffff0000, v55
    v_lshlrev_b32 v152, 16, v56
    v_and_b32 v153, 0xffff0000, v56
    v_lshlrev_b32 v154, 16, v57
    v_and_b32 v155, 0xffff0000, v57
    v_lshlrev_b32 v156, 16, v58
    v_and_b32 v157, 0xffff0000, v58
    v_lshlrev_b32 v158, 16, v59
    v_and_b32 v159, 0xffff0000, v59
    v_lshlrev_b32 v160, 16, v60
    v_and_b32 v161, 0xffff0000, v60
    v_lshlrev_b32 v162, 16, v61
    v_and_b32 v163, 0xffff0000, v61
    v_lshlrev_b32 v164, 16, v62
    v_and_b32 v165, 0xffff0000, v62
    v_lshlrev_b32 v166, 16, v63
    v_and_b32 v167, 0xffff0000, v63
    v_lshlrev_b32 v168, 16, v64
    v_and_b32 v169, 0xffff0000, v64
    v_lshlrev_b32 v170, 16, v65
    v_and_b32 v171, 0xffff0000, v65
    v_lshlrev_b32 v172, 16, v66
    v_and_b32 v173, 0xffff0000, v66
    v_lshlrev_b32 v174, 16, v67
    v_and_b32 v175, 0xffff0000, v67
    v_lshlrev_b32 v176, 16, v68
    v_and_b32 v177, 0xffff0000, v68
    v_lshlrev_b32 v178, 16, v69
    v_and_b32 v179, 0xffff0000, v69
    v_lshlrev_b32 v180, 16, v70
    v_and_b32 v181, 0xffff0000, v70
    v_lshlrev_b32 v182, 16, v71
    v_and_b32 v183, 0xffff0000, v71
    v_add_f32 v184, v72, v76
    v_add_f32 v185, v73, v77
    v_add_f32 v186, v74, v78
    v_add_f32 v187, v75, v79
    v_add_f32 v184, v184, v80
    v_add_f32 v185, v185, v81
    v_add_f32 v186, v186, v82
    v_add_f32 v187, v187, v83
    v_add_f32 v184, v184, v84
    v_add_f32 v185, v185, v85
    v_add_f32 v186, v186, v86
    v_add_f32 v187, v187, v87
    v_add_f32 v184, v184, v88
    v_add_f32 v185, v185, v89
    v_add_f32 v186, v186, v90
    v_add_f32 v187, v187, v91
    v_add_f32 v184, v184, v92
    v_add_f32 v185, v185, v93
    v_add_f32 v186, v186, v94
    v_add_f32 v187, v187, v95
    v_add_f32 v184, v184, v96
    v_add_f32 v185, v185, v97
    v_add_f32 v186, v186, v98
    v_add_f32 v187, v187, v99
    v_add_f32 v184, v184, v100
    v_add_f32 v185, v185, v101
    v_add_f32 v186, v186, v102
    v_add_f32 v187, v187, v103
    v_add_f32 v184, v184, v104
    v_add_f32 v185, v185, v105
    v_add_f32 v186, v186, v106
    v_add_f32 v187, v187, v107
    v_add_f32 v184, v184, v108
    v_add_f32 v185, v185, v109
    v_add_f32 v186, v186, v110
    v_add_f32 v187, v187, v111
    v_add_f32 v184, v184, v112
    v_add_f32 v185, v185, v113
    v_add_f32 v186, v186, v114
    v_add_f32 v187, v187, v115
    v_add_f32 v184, v184, v116
    v_add_f32 v185, v185, v117
    v_add_f32 v186, v186, v118
    v_add_f32 v187, v187, v119
    v_add_f32 v184, v184, v120
    v_add_f32 v185, v185, v121
    v_add_f32 v186, v186, v122
    v_add_f32 v187, v187, v123
    v_add_f32 v184, v184, v124
    v_add_f32 v185, v185, v125
    v_add_f32 v186, v186, v126
    v_add_f32 v187, v187, v127
    v_add_f32 v184, v184, v128
    v_add_f32 v185, v185, v129
    v_add_f32 v186, v186, v130
    v_add_f32 v187, v187, v131
    v_add_f32 v184, v184, v132
    v_add_f32 v185, v185, v133
    v_add_f32 v186, v186, v134
    v_add_f32 v187, v187, v135
    v_add_f32 v184, v184, v136
    v_add_f32 v185, v185, v137
    v_add_f32 v186, v186, v138
    v_add_f32 v187, v187, v139
    v_add_f32 v184, v184, v140
    v_add_f32 v185, v185, v141
    v_add_f32 v186, v186, v142
    v_add_f32 v187, v187, v143
    v_add_f32 v184, v184, v144
    v_add_f32 v185, v185, v145
    v_add_f32 v186, v186, v146
    v_add_f32 v187, v187, v147
    v_add_f32 v184, v184, v148
    v_add_f32 v185, v185, v149
    v_add_f32 v186, v186, v150
    v_add_f32 v187, v187, v151
    v_add_f32 v184, v184, v152
    v_add_f32 v185, v185, v153
    v_add_f32 v186, v186, v154
    v_add_f32 v187, v187, v155
    v_add_f32 v184, v184, v156
    v_add_f32 v185, v185, v157
    v_add_f32 v186, v186, v158
    v_add_f32 v187, v187, v159
    v_add_f32 v184, v184, v160
    v_add_f32 v185, v185, v161
    v_add_f32 v186, v186, v162
    v_add_f32 v187, v187, v163
    v_add_f32 v184, v184, v164
    v_add_f32 v185, v185, v165
    v_add_f32 v186, v186, v166
    v_add_f32 v187, v187, v167
    v_add_f32 v184, v184, v168
    v_add_f32 v185, v185, v169
    v_add_f32 v186, v186, v170
    v_add_f32 v187, v187, v171
    v_add_f32 v184, v184, v172
    v_add_f32 v185, v185, v173
    v_add_f32 v186, v186, v174
    v_add_f32 v187, v187, v175
    v_add_f32 v184, v184, v176
    v_add_f32 v185, v185, v177
    v_add_f32 v186, v186, v178
    v_add_f32 v187, v187, v179
    v_add_f32 v184, v184, v180
    v_add_f32 v185, v185, v181
    v_add_f32 v186, v186, v182
    v_add_f32 v187, v187, v183
    v_add_f32 v184, v184, v185
    v_add_f32 v186, v186, v187
    v_add_f32 v184, v184, v186
    v_mov_b32 v190, v184
    s_nop 1
    v_permlane16_swap_b32 v184, v190
    s_nop 1
    v_add_f32 v184, v184, v190
    v_mov_b32 v190, v184
    s_nop 1
    v_permlane32_swap_b32 v184, v190
    s_nop 1
    v_add_f32 v184, v184, v190
    v_mul_f32 v188, s39, v184
    v_sub_f32 v72, v72, v188
    v_sub_f32 v73, v73, v188
    v_sub_f32 v74, v74, v188
    v_sub_f32 v75, v75, v188
    v_sub_f32 v76, v76, v188
    v_sub_f32 v77, v77, v188
    v_sub_f32 v78, v78, v188
    v_sub_f32 v79, v79, v188
    v_sub_f32 v80, v80, v188
    v_sub_f32 v81, v81, v188
    v_sub_f32 v82, v82, v188
    v_sub_f32 v83, v83, v188
    v_sub_f32 v84, v84, v188
    v_sub_f32 v85, v85, v188
    v_sub_f32 v86, v86, v188
    v_sub_f32 v87, v87, v188
    v_sub_f32 v88, v88, v188
    v_sub_f32 v89, v89, v188
    v_sub_f32 v90, v90, v188
    v_sub_f32 v91, v91, v188
    v_sub_f32 v92, v92, v188
    v_sub_f32 v93, v93, v188
    v_sub_f32 v94, v94, v188
    v_sub_f32 v95, v95, v188
    v_sub_f32 v96, v96, v188
    v_sub_f32 v97, v97, v188
    v_sub_f32 v98, v98, v188
    v_sub_f32 v99, v99, v188
    v_sub_f32 v100, v100, v188
    v_sub_f32 v101, v101, v188
    v_sub_f32 v102, v102, v188
    v_sub_f32 v103, v103, v188
    v_sub_f32 v104, v104, v188
    v_sub_f32 v105, v105, v188
    v_sub_f32 v106, v106, v188
    v_sub_f32 v107, v107, v188
    v_sub_f32 v108, v108, v188
    v_sub_f32 v109, v109, v188
    v_sub_f32 v110, v110, v188
    v_sub_f32 v111, v111, v188
    v_sub_f32 v112, v112, v188
    v_sub_f32 v113, v113, v188
    v_sub_f32 v114, v114, v188
    v_sub_f32 v115, v115, v188
    v_sub_f32 v116, v116, v188
    v_sub_f32 v117, v117, v188
    v_sub_f32 v118, v118, v188
    v_sub_f32 v119, v119, v188
    v_sub_f32 v120, v120, v188
    v_sub_f32 v121, v121, v188
    v_sub_f32 v122, v122, v188
    v_sub_f32 v123, v123, v188
    v_sub_f32 v124, v124, v188
    v_sub_f32 v125, v125, v188
    v_sub_f32 v126, v126, v188
    v_sub_f32 v127, v127, v188
    v_sub_f32 v128, v128, v188
    v_sub_f32 v129, v129, v188
    v_sub_f32 v130, v130, v188
    v_sub_f32 v131, v131, v188
    v_sub_f32 v132, v132, v188
    v_sub_f32 v133, v133, v188
    v_sub_f32 v134, v134, v188
    v_sub_f32 v135, v135, v188
    v_sub_f32 v136, v136, v188
    v_sub_f32 v137, v137, v188
    v_sub_f32 v138, v138, v188
    v_sub_f32 v139, v139, v188
    v_sub_f32 v140, v140, v188
    v_sub_f32 v141, v141, v188
    v_sub_f32 v142, v142, v188
    v_sub_f32 v143, v143, v188
    v_sub_f32 v144, v144, v188
    v_sub_f32 v145, v145, v188
    v_sub_f32 v146, v146, v188
    v_sub_f32 v147, v147, v188
    v_sub_f32 v148, v148, v188
    v_sub_f32 v149, v149, v188
    v_sub_f32 v150, v150, v188
    v_sub_f32 v151, v151, v188
    v_sub_f32 v152, v152, v188
    v_sub_f32 v153, v153, v188
    v_sub_f32 v154, v154, v188
    v_sub_f32 v155, v155, v188
    v_sub_f32 v156, v156, v188
    v_sub_f32 v157, v157, v188
    v_sub_f32 v158, v158, v188
    v_sub_f32 v159, v159, v188
    v_sub_f32 v160, v160, v188
    v_sub_f32 v161, v161, v188
    v_sub_f32 v162, v162, v188
    v_sub_f32 v163, v163, v188
    v_sub_f32 v164, v164, v188
    v_sub_f32 v165, v165, v188
    v_sub_f32 v166, v166, v188
    v_sub_f32 v167, v167, v188
    v_sub_f32 v168, v168, v188
    v_sub_f32 v169, v169, v188
    v_sub_f32 v170, v170, v188
    v_sub_f32 v171, v171, v188
    v_sub_f32 v172, v172, v188
    v_sub_f32 v173, v173, v188
    v_sub_f32 v174, v174, v188
    v_sub_f32 v175, v175, v188
    v_sub_f32 v176, v176, v188
    v_sub_f32 v177, v177, v188
    v_sub_f32 v178, v178, v188
    v_sub_f32 v179, v179, v188
    v_sub_f32 v180, v180, v188
    v_sub_f32 v181, v181, v188
    v_sub_f32 v182, v182, v188
    v_sub_f32 v183, v183, v188
    v_mul_f32 v184, v72, v72
    v_mul_f32 v185, v73, v73
    v_mul_f32 v186, v74, v74
    v_mul_f32 v187, v75, v75
    v_fmac_f32 v184, v76, v76
    v_fmac_f32 v185, v77, v77
    v_fmac_f32 v186, v78, v78
    v_fmac_f32 v187, v79, v79
    v_fmac_f32 v184, v80, v80
    v_fmac_f32 v185, v81, v81
    v_fmac_f32 v186, v82, v82
    v_fmac_f32 v187, v83, v83
    v_fmac_f32 v184, v84, v84
    v_fmac_f32 v185, v85, v85
    v_fmac_f32 v186, v86, v86
    v_fmac_f32 v187, v87, v87
    v_fmac_f32 v184, v88, v88
    v_fmac_f32 v185, v89, v89
    v_fmac_f32 v186, v90, v90
    v_fmac_f32 v187, v91, v91
    v_fmac_f32 v184, v92, v92
    v_fmac_f32 v185, v93, v93
    v_fmac_f32 v186, v94, v94
    v_fmac_f32 v187, v95, v95
    v_fmac_f32 v184, v96, v96
    v_fmac_f32 v185, v97, v97
    v_fmac_f32 v186, v98, v98
    v_fmac_f32 v187, v99, v99
    v_fmac_f32 v184, v100, v100
    v_fmac_f32 v185, v101, v101
    v_fmac_f32 v186, v102, v102
    v_fmac_f32 v187, v103, v103
    v_fmac_f32 v184, v104, v104
    v_fmac_f32 v185, v105, v105
    v_fmac_f32 v186, v106, v106
    v_fmac_f32 v187, v107, v107
    v_fmac_f32 v184, v108, v108
    v_fmac_f32 v185, v109, v109
    v_fmac_f32 v186, v110, v110
    v_fmac_f32 v187, v111, v111
    v_fmac_f32 v184, v112, v112
    v_fmac_f32 v185, v113, v113
    v_fmac_f32 v186, v114, v114
    v_fmac_f32 v187, v115, v115
    v_fmac_f32 v184, v116, v116
    v_fmac_f32 v185, v117, v117
    v_fmac_f32 v186, v118, v118
    v_fmac_f32 v187, v119, v119
    v_fmac_f32 v184, v120, v120
    v_fmac_f32 v185, v121, v121
    v_fmac_f32 v186, v122, v122
    v_fmac_f32 v187, v123, v123
    v_fmac_f32 v184, v124, v124
    v_fmac_f32 v185, v125, v125
    v_fmac_f32 v186, v126, v126
    v_fmac_f32 v187, v127, v127
    v_fmac_f32 v184, v128, v128
    v_fmac_f32 v185, v129, v129
    v_fmac_f32 v186, v130, v130
    v_fmac_f32 v187, v131, v131
    v_fmac_f32 v184, v132, v132
    v_fmac_f32 v185, v133, v133
    v_fmac_f32 v186, v134, v134
    v_fmac_f32 v187, v135, v135
    v_fmac_f32 v184, v136, v136
    v_fmac_f32 v185, v137, v137
    v_fmac_f32 v186, v138, v138
    v_fmac_f32 v187, v139, v139
    v_fmac_f32 v184, v140, v140
    v_fmac_f32 v185, v141, v141
    v_fmac_f32 v186, v142, v142
    v_fmac_f32 v187, v143, v143
    v_fmac_f32 v184, v144, v144
    v_fmac_f32 v185, v145, v145
    v_fmac_f32 v186, v146, v146
    v_fmac_f32 v187, v147, v147
    v_fmac_f32 v184, v148, v148
    v_fmac_f32 v185, v149, v149
    v_fmac_f32 v186, v150, v150
    v_fmac_f32 v187, v151, v151
    v_fmac_f32 v184, v152, v152
    v_fmac_f32 v185, v153, v153
    v_fmac_f32 v186, v154, v154
    v_fmac_f32 v187, v155, v155
    v_fmac_f32 v184, v156, v156
    v_fmac_f32 v185, v157, v157
    v_fmac_f32 v186, v158, v158
    v_fmac_f32 v187, v159, v159
    v_fmac_f32 v184, v160, v160
    v_fmac_f32 v185, v161, v161
    v_fmac_f32 v186, v162, v162
    v_fmac_f32 v187, v163, v163
    v_fmac_f32 v184, v164, v164
    v_fmac_f32 v185, v165, v165
    v_fmac_f32 v186, v166, v166
    v_fmac_f32 v187, v167, v167
    v_fmac_f32 v184, v168, v168
    v_fmac_f32 v185, v169, v169
    v_fmac_f32 v186, v170, v170
    v_fmac_f32 v187, v171, v171
    v_fmac_f32 v184, v172, v172
    v_fmac_f32 v185, v173, v173
    v_fmac_f32 v186, v174, v174
    v_fmac_f32 v187, v175, v175
    v_fmac_f32 v184, v176, v176
    v_fmac_f32 v185, v177, v177
    v_fmac_f32 v186, v178, v178
    v_fmac_f32 v187, v179, v179
    v_fmac_f32 v184, v180, v180
    v_fmac_f32 v185, v181, v181
    v_fmac_f32 v186, v182, v182
    v_fmac_f32 v187, v183, v183
    v_add_f32 v184, v184, v185
    v_add_f32 v186, v186, v187
    v_add_f32 v184, v184, v186
    v_mov_b32 v190, v184
    s_nop 1
    v_permlane16_swap_b32 v184, v190
    s_nop 1
    v_add_f32 v184, v184, v190
    v_mov_b32 v190, v184
    s_nop 1
    v_permlane32_swap_b32 v184, v190
    s_nop 1
    v_add_f32 v184, v184, v190
    v_mov_b32 v189, s38
    v_fmac_f32 v189, s39, v184
    v_rsq_f32 v189, v189
    s_nop 0
    v_mul_f32 v72, v72, v189
    v_mul_f32 v73, v73, v189
    v_mul_f32 v74, v74, v189
    v_mul_f32 v75, v75, v189
    v_mul_f32 v76, v76, v189
    v_mul_f32 v77, v77, v189
    v_mul_f32 v78, v78, v189
    v_mul_f32 v79, v79, v189
    v_mul_f32 v80, v80, v189
    v_mul_f32 v81, v81, v189
    v_mul_f32 v82, v82, v189
    v_mul_f32 v83, v83, v189
    v_mul_f32 v84, v84, v189
    v_mul_f32 v85, v85, v189
    v_mul_f32 v86, v86, v189
    v_mul_f32 v87, v87, v189
    v_mul_f32 v88, v88, v189
    v_mul_f32 v89, v89, v189
    v_mul_f32 v90, v90, v189
    v_mul_f32 v91, v91, v189
    v_mul_f32 v92, v92, v189
    v_mul_f32 v93, v93, v189
    v_mul_f32 v94, v94, v189
    v_mul_f32 v95, v95, v189
    v_mul_f32 v96, v96, v189
    v_mul_f32 v97, v97, v189
    v_mul_f32 v98, v98, v189
    v_mul_f32 v99, v99, v189
    v_mul_f32 v100, v100, v189
    v_mul_f32 v101, v101, v189
    v_mul_f32 v102, v102, v189
    v_mul_f32 v103, v103, v189
    v_mul_f32 v104, v104, v189
    v_mul_f32 v105, v105, v189
    v_mul_f32 v106, v106, v189
    v_mul_f32 v107, v107, v189
    v_mul_f32 v108, v108, v189
    v_mul_f32 v109, v109, v189
    v_mul_f32 v110, v110, v189
    v_mul_f32 v111, v111, v189
    v_mul_f32 v112, v112, v189
    v_mul_f32 v113, v113, v189
    v_mul_f32 v114, v114, v189
    v_mul_f32 v115, v115, v189
    v_mul_f32 v116, v116, v189
    v_mul_f32 v117, v117, v189
    v_mul_f32 v118, v118, v189
    v_mul_f32 v119, v119, v189
    v_mul_f32 v120, v120, v189
    v_mul_f32 v121, v121, v189
    v_mul_f32 v122, v122, v189
    v_mul_f32 v123, v123, v189
    v_mul_f32 v124, v124, v189
    v_mul_f32 v125, v125, v189
    v_mul_f32 v126, v126, v189
    v_mul_f32 v127, v127, v189
    v_mul_f32 v128, v128, v189
    v_mul_f32 v129, v129, v189
    v_mul_f32 v130, v130, v189
    v_mul_f32 v131, v131, v189
    v_mul_f32 v132, v132, v189
    v_mul_f32 v133, v133, v189
    v_mul_f32 v134, v134, v189
    v_mul_f32 v135, v135, v189
    v_mul_f32 v136, v136, v189
    v_mul_f32 v137, v137, v189
    v_mul_f32 v138, v138, v189
    v_mul_f32 v139, v139, v189
    v_mul_f32 v140, v140, v189
    v_mul_f32 v141, v141, v189
    v_mul_f32 v142, v142, v189
    v_mul_f32 v143, v143, v189
    v_mul_f32 v144, v144, v189
    v_mul_f32 v145, v145, v189
    v_mul_f32 v146, v146, v189
    v_mul_f32 v147, v147, v189
    v_mul_f32 v148, v148, v189
    v_mul_f32 v149, v149, v189
    v_mul_f32 v150, v150, v189
    v_mul_f32 v151, v151, v189
    v_mul_f32 v152, v152, v189
    v_mul_f32 v153, v153, v189
    v_mul_f32 v154, v154, v189
    v_mul_f32 v155, v155, v189
    v_mul_f32 v156, v156, v189
    v_mul_f32 v157, v157, v189
    v_mul_f32 v158, v158, v189
    v_mul_f32 v159, v159, v189
    v_mul_f32 v160, v160, v189
    v_mul_f32 v161, v161, v189
    v_mul_f32 v162, v162, v189
    v_mul_f32 v163, v163, v189
    v_mul_f32 v164, v164, v189
    v_mul_f32 v165, v165, v189
    v_mul_f32 v166, v166, v189
    v_mul_f32 v167, v167, v189
    v_mul_f32 v168, v168, v189
    v_mul_f32 v169, v169, v189
    v_mul_f32 v170, v170, v189
    v_mul_f32 v171, v171, v189
    v_mul_f32 v172, v172, v189
    v_mul_f32 v173, v173, v189
    v_mul_f32 v174, v174, v189
    v_mul_f32 v175, v175, v189
    v_mul_f32 v176, v176, v189
    v_mul_f32 v177, v177, v189
    v_mul_f32 v178, v178, v189
    v_mul_f32 v179, v179, v189
    v_mul_f32 v180, v180, v189
    v_mul_f32 v181, v181, v189
    v_mul_f32 v182, v182, v189
    v_mul_f32 v183, v183, v189
    v_cvt_pk_bf16_f32 v16, v72, v73
    v_cvt_pk_bf16_f32 v17, v74, v75
    v_cvt_pk_bf16_f32 v18, v76, v77
    v_cvt_pk_bf16_f32 v19, v78, v79
    v_cvt_pk_bf16_f32 v20, v80, v81
    v_cvt_pk_bf16_f32 v21, v82, v83
    v_cvt_pk_bf16_f32 v22, v84, v85
    v_cvt_pk_bf16_f32 v23, v86, v87
    v_cvt_pk_bf16_f32 v24, v88, v89
    v_cvt_pk_bf16_f32 v25, v90, v91
    v_cvt_pk_bf16_f32 v26, v92, v93
    v_cvt_pk_bf16_f32 v27, v94, v95
    v_cvt_pk_bf16_f32 v28, v96, v97
    v_cvt_pk_bf16_f32 v29, v98, v99
    v_cvt_pk_bf16_f32 v30, v100, v101
    v_cvt_pk_bf16_f32 v31, v102, v103
    v_cvt_pk_bf16_f32 v32, v104, v105
    v_cvt_pk_bf16_f32 v33, v106, v107
    v_cvt_pk_bf16_f32 v34, v108, v109
    v_cvt_pk_bf16_f32 v35, v110, v111
    v_cvt_pk_bf16_f32 v36, v112, v113
    v_cvt_pk_bf16_f32 v37, v114, v115
    v_cvt_pk_bf16_f32 v38, v116, v117
    v_cvt_pk_bf16_f32 v39, v118, v119
    v_cvt_pk_bf16_f32 v40, v120, v121
    v_cvt_pk_bf16_f32 v41, v122, v123
    v_cvt_pk_bf16_f32 v42, v124, v125
    v_cvt_pk_bf16_f32 v43, v126, v127
    v_cvt_pk_bf16_f32 v44, v128, v129
    v_cvt_pk_bf16_f32 v45, v130, v131
    v_cvt_pk_bf16_f32 v46, v132, v133
    v_cvt_pk_bf16_f32 v47, v134, v135
    v_cvt_pk_bf16_f32 v48, v136, v137
    v_cvt_pk_bf16_f32 v49, v138, v139
    v_cvt_pk_bf16_f32 v50, v140, v141
    v_cvt_pk_bf16_f32 v51, v142, v143
    v_cvt_pk_bf16_f32 v52, v144, v145
    v_cvt_pk_bf16_f32 v53, v146, v147
    v_cvt_pk_bf16_f32 v54, v148, v149
    v_cvt_pk_bf16_f32 v55, v150, v151
    v_cvt_pk_bf16_f32 v56, v152, v153
    v_cvt_pk_bf16_f32 v57, v154, v155
    v_cvt_pk_bf16_f32 v58, v156, v157
    v_cvt_pk_bf16_f32 v59, v158, v159
    v_cvt_pk_bf16_f32 v60, v160, v161
    v_cvt_pk_bf16_f32 v61, v162, v163
    v_cvt_pk_bf16_f32 v62, v164, v165
    v_cvt_pk_bf16_f32 v63, v166, v167
    v_cvt_pk_bf16_f32 v64, v168, v169
    v_cvt_pk_bf16_f32 v65, v170, v171
    v_cvt_pk_bf16_f32 v66, v172, v173
    v_cvt_pk_bf16_f32 v67, v174, v175
    v_cvt_pk_bf16_f32 v68, v176, v177
    v_cvt_pk_bf16_f32 v69, v178, v179
    v_cvt_pk_bf16_f32 v70, v180, v181
    v_cvt_pk_bf16_f32 v71, v182, v183
    s_mul_i32 s36, s35, 14336
    s_add_u32 s37, s36, 0
    s_add_u32 s40, s36, 2097152
    buffer_store_dwordx4 v[16:19], v5, s[8:11], s37 offen offset:0
    buffer_store_dwordx2 v[16:17], v3, s[8:11], s40 offen offset:0
    buffer_store_dwordx2 v[18:19], v3, s[8:11], s40 offen offset:256
    buffer_store_dwordx4 v[20:23], v5, s[8:11], s37 offen offset:1024
    buffer_store_dwordx2 v[20:21], v3, s[8:11], s40 offen offset:1024
    buffer_store_dwordx2 v[22:23], v3, s[8:11], s40 offen offset:1280
    buffer_store_dwordx4 v[24:27], v5, s[8:11], s37 offen offset:2048
    buffer_store_dwordx2 v[24:25], v3, s[8:11], s40 offen offset:2048
    buffer_store_dwordx2 v[26:27], v3, s[8:11], s40 offen offset:2304
    buffer_store_dwordx4 v[28:31], v5, s[8:11], s37 offen offset:3072
    buffer_store_dwordx2 v[28:29], v3, s[8:11], s40 offen offset:3072
    buffer_store_dwordx2 v[30:31], v3, s[8:11], s40 offen offset:3328
    s_add_u32 s37, s37, 4096
    s_add_u32 s40, s40, 4096
    buffer_store_dwordx4 v[32:35], v5, s[8:11], s37 offen offset:0
    buffer_store_dwordx2 v[32:33], v3, s[8:11], s40 offen offset:0
    buffer_store_dwordx2 v[34:35], v3, s[8:11], s40 offen offset:256
    buffer_store_dwordx4 v[36:39], v5, s[8:11], s37 offen offset:1024
    buffer_store_dwordx2 v[36:37], v3, s[8:11], s40 offen offset:1024
    buffer_store_dwordx2 v[38:39], v3, s[8:11], s40 offen offset:1280
    buffer_store_dwordx4 v[40:43], v5, s[8:11], s37 offen offset:2048
    buffer_store_dwordx2 v[40:41], v3, s[8:11], s40 offen offset:2048
    buffer_store_dwordx2 v[42:43], v3, s[8:11], s40 offen offset:2304
    buffer_store_dwordx4 v[44:47], v5, s[8:11], s37 offen offset:3072
    buffer_store_dwordx2 v[44:45], v3, s[8:11], s40 offen offset:3072
    buffer_store_dwordx2 v[46:47], v3, s[8:11], s40 offen offset:3328
    s_add_u32 s37, s37, 4096
    s_add_u32 s40, s40, 4096
    buffer_store_dwordx4 v[48:51], v5, s[8:11], s37 offen offset:0
    buffer_store_dwordx2 v[48:49], v3, s[8:11], s40 offen offset:0
    buffer_store_dwordx2 v[50:51], v3, s[8:11], s40 offen offset:256
    buffer_store_dwordx4 v[52:55], v5, s[8:11], s37 offen offset:1024
    buffer_store_dwordx2 v[52:53], v3, s[8:11], s40 offen offset:1024
    buffer_store_dwordx2 v[54:55], v3, s[8:11], s40 offen offset:1280
    buffer_store_dwordx4 v[56:59], v5, s[8:11], s37 offen offset:2048
    buffer_store_dwordx2 v[56:57], v3, s[8:11], s40 offen offset:2048
    buffer_store_dwordx2 v[58:59], v3, s[8:11], s40 offen offset:2304
    buffer_store_dwordx4 v[60:63], v5, s[8:11], s37 offen offset:3072
    buffer_store_dwordx2 v[60:61], v3, s[8:11], s40 offen offset:3072
    buffer_store_dwordx2 v[62:63], v3, s[8:11], s40 offen offset:3328
    s_add_u32 s37, s37, 4096
    s_add_u32 s40, s40, 4096
    buffer_store_dwordx4 v[64:67], v5, s[8:11], s37 offen offset:0
    buffer_store_dwordx2 v[64:65], v3, s[8:11], s40 offen offset:0
    buffer_store_dwordx2 v[66:67], v3, s[8:11], s40 offen offset:256
    buffer_store_dwordx4 v[68:71], v5, s[8:11], s37 offen offset:1024
    buffer_store_dwordx2 v[68:69], v3, s[8:11], s40 offen offset:1024
    buffer_store_dwordx2 v[70:71], v3, s[8:11], s40 offen offset:1280
    s_cmp_eq_u32 s2, 255
    s_cbranch_scc0 K1_DONE
    s_waitcnt vmcnt(0)
    s_mov_b32 s12, s50
    s_mov_b32 s13, s51
    s_and_b32 s13, s13, 0xffff
    s_mov_b32 s14, 7168
    s_mov_b32 s15, 0x00020000
    v_lshrrev_b32 v6, 5, v0
    v_and_b32 v7, 31, v0
    v_mul_u32_u24 v8, 896, v6
    v_lshl_add_u32 v2, v7, 2, v8
    buffer_load_dword v16, v2, s[12:15], 0 offen offset:0
    buffer_load_dword v17, v2, s[12:15], 0 offen offset:128
    buffer_load_dword v18, v2, s[12:15], 0 offen offset:256
    buffer_load_dword v19, v2, s[12:15], 0 offen offset:384
    buffer_load_dword v20, v2, s[12:15], 0 offen offset:512
    buffer_load_dword v21, v2, s[12:15], 0 offen offset:640
    buffer_load_dword v22, v2, s[12:15], 0 offen offset:768
    v_lshrrev_b32 v8, 3, v7
    v_lshlrev_b32 v3, 8, v8
    v_and_b32 v9, 1, v7
    v_lshl_add_u32 v9, v9, 3, v6
    v_lshl_add_u32 v3, v9, 4, v3
    v_bfe_u32 v9, v7, 1, 2
    v_lshl_add_u32 v3, v9, 2, v3
    v_lshrrev_b32 v8, 4, v7
    v_lshlrev_b32 v4, 9, v8
    v_lshl_add_u32 v9, v9, 3, v6
    v_lshl_add_u32 v4, v9, 4, v4
    v_bfe_u32 v9, v7, 3, 1
    v_lshlrev_b32 v9, 1, v9
    v_and_b32 v10, 1, v7
    v_add_u32 v9, v9, v10
    v_lshl_add_u32 v4, v9, 2, v4
    s_waitcnt vmcnt(0)
    s_mov_b32 s37, 91226112
    s_mov_b32 s38, 93585408
    buffer_store_dword v16, v3, s[8:11], s37 offen
    buffer_store_dword v16, v3, s[8:11], s38 offen
    s_mov_b32 s37, 91227136
    s_mov_b32 s38, 93586432
    buffer_store_dword v17, v3, s[8:11], s37 offen
    buffer_store_dword v17, v3, s[8:11], s38 offen
    s_mov_b32 s37, 91228160
    s_mov_b32 s38, 93587456
    buffer_store_dword v18, v3, s[8:11], s37 offen
    buffer_store_dword v18, v3, s[8:11], s38 offen
    s_mov_b32 s37, 91229184
    s_mov_b32 s38, 93588480
    buffer_store_dword v19, v3, s[8:11], s37 offen
    buffer_store_dword v19, v3, s[8:11], s38 offen
    s_mov_b32 s37, 91230208
    s_mov_b32 s38, 93589504
    buffer_store_dword v20, v3, s[8:11], s37 offen
    buffer_store_dword v20, v3, s[8:11], s38 offen
    s_mov_b32 s37, 91231232
    s_mov_b32 s38, 93590528
    buffer_store_dword v21, v3, s[8:11], s37 offen
    buffer_store_dword v21, v3, s[8:11], s38 offen
    s_mov_b32 s37, 91232256
    s_mov_b32 s38, 93591552
    buffer_store_dword v22, v3, s[8:11], s37 offen
    buffer_store_dword v22, v3, s[8:11], s38 offen
K1_DONE:
    s_waitcnt vmcnt(0)
K1_END:
    s_endpgm
.globl k3_chain_kernel
.p2align 8
.type k3_chain_kernel,@function
k3_chain_kernel:
    s_cmp_ge_u32 s2, 256
    s_cbranch_scc1 K3_END
    s_load_dwordx2 s[8:9], s[0:1], 112
    s_load_dwordx2 s[16:17], s[0:1], 104
    v_and_b32 v1, 63, v0
    v_lshrrev_b32 v4, 6, v0
    v_lshlrev_b32 v2, 4, v1
    v_readfirstlane_b32 s20, v4
    s_getreg_b32 s3, hwreg(HW_REG_XCC_ID)
    s_and_b32 s3, s3, 15
    s_waitcnt lgkmcnt(0)
    s_and_b32 s9, s9, 0xffff
    s_mov_b32 s10, 268435456
    s_mov_b32 s11, 0x00020000
    s_and_b32 s17, s17, 0xffff
    s_mov_b32 s18, 256
    s_mov_b32 s19, 0x00020000
    s_cmp_eq_u32 s20, 0
    s_cbranch_scc0 K3_ELW
    s_mov_b64 exec, 1
    v_mov_b32 v10, 1
    s_lshl_b32 s4, s3, 2
    v_mov_b32 v11, s4
    v_mov_b32 v12, 1
    v_mov_b32 v13, 64
    s_cmp_eq_u32 s3, 0
    s_cbranch_scc1 K3_ELX0
    v_mov_b32 v14, 1
    v_mov_b32 v15, 128
    buffer_atomic_add v14, v15, s[16:19], 0 offen sc0
    buffer_atomic_add v10, v11, s[16:19], 0 offen sc0
    s_waitcnt vmcnt(0)
    buffer_atomic_add v12, v13, s[16:19], 0 offen
    v_add_u32 v14, 0x100, v14
    s_branch K3_ELWR
K3_ELX0:
    buffer_atomic_add v10, v11, s[16:19], 0 offen sc0
    s_waitcnt vmcnt(0)
    buffer_atomic_add v12, v13, s[16:19], 0 offen
    v_mov_b32 v14, v10
    v_cmp_gt_u32 vcc, 32, v10
    s_cbranch_vccnz K3_ELWR
    v_mov_b32 v14, 1
    v_mov_b32 v15, 128
    buffer_atomic_add v14, v15, s[16:19], 0 offen sc0
    s_waitcnt vmcnt(0)
    v_add_u32 v14, 0x100, v14
K3_ELWR:
    v_mov_b32 v13, 131072
    ds_write_b32 v13, v14
    s_mov_b64 exec, -1
    s_waitcnt lgkmcnt(0)
K3_ELW:
    s_barrier
    v_mov_b32 v13, 131072
    ds_read_b32 v12, v13
    s_waitcnt lgkmcnt(0)
    v_readfirstlane_b32 s12, v12
    s_barrier
    s_cmp_lt_u32 s12, 32
    s_cbranch_scc0 K3_HELP
K3_MEMBER:
    s_and_b32 s12, s12, 31
    s_lshr_b32 s13, s12, 1
    s_and_b32 s14, s12, 1
    s_mov_b32 s21, 4290772927
    s_mov_b32 s22, 0x00ff00ff
    s_mov_b32 s23, 0x00ff00ff
    s_mov_b32 s24, 0x55555555
    s_mov_b32 s25, 0x55555555
    s_mov_b32 s26, 0x3fb8aa3b
    v_and_b32 v4, 15, v1
    v_lshrrev_b32 v5, 4, v1
    v_mov_b32 v3, 0x4444
    v_mov_b32 v6, 0xeeee
    v_cmp_lt_u32 vcc, 7, v4
    s_nop 1
    v_cndmask_b32 v3, v3, v6, vcc
    v_lshlrev_b32 v6, 5, v4
    v_lshl_add_u32 v6, v5, 3, v6
    v_add_u32 v132, 7168, v6
    v_lshlrev_b32 v141, 3, v1
    v_add_u32 v133, 7168, v141
    v_lshl_add_u32 v6, v5, 3, v4
    v_lshlrev_b32 v134, 4, v6
    v_cmp_gt_u32 vcc, 12, v4
    s_nop 1
    v_cndmask_b32 v6, 0, v4, vcc
    s_lshl_b32 s27, s20, 2
    v_add_u32 v7, s27, v5
    v_and_b32 v7, 7, v7
    v_lshl_add_u32 v6, v6, 3, v7
    v_lshlrev_b32 v135, 4, v6
    v_mov_b32 v6, 0xff7fffff
    v_cmp_gt_u32 vcc, 10, v4
    s_nop 1
    v_cndmask_b32 v139, v6, 0, vcc
    v_and_b32 v8, 3, v4
    v_lshrrev_b32 v9, 2, v4
    v_lshrrev_b32 v10, 1, v8
    v_lshl_add_u32 v10, v10, 4, v7
    v_lshlrev_b32 v10, 4, v10
    v_and_b32 v11, 1, v8
    v_lshl_add_u32 v11, v11, 1, v9
    v_lshl_add_u32 v10, v11, 2, v10
    v_add_u32 v11, 32, v7
    v_lshlrev_b32 v11, 4, v11
    v_lshl_add_u32 v11, v8, 3, v11
    v_cmp_gt_u32 vcc, 8, v4
    s_nop 1
    v_cndmask_b32 v10, v11, v10, vcc
    v_add_u32 v10, 16384, v10
    v_mov_b32 v11, 17408
    v_cmp_gt_u32 vcc, 10, v4
    s_nop 1
    v_cndmask_b32 v136, v11, v10, vcc
    v_min_u32 v6, 2, v5
    v_lshl_add_u32 v6, v6, 4, v4
    v_lshlrev_b32 v6, 4, v6
    v_add_u32 v137, 16384, v6
    v_bfe_u32 v6, v1, 2, 1
    v_lshlrev_b32 v6, 2, v6
    v_bfe_u32 v7, v1, 3, 1
    v_add_u32 v6, v6, v7
    v_lshrrev_b32 v7, 5, v1
    v_lshl_add_u32 v6, v7, 1, v6
    v_bfe_u32 v7, v1, 4, 1
    v_lshl_add_u32 v6, v7, 3, v6
    v_lshlrev_b32 v6, 4, v6
    v_and_b32 v7, 3, v1
    v_lshl_add_u32 v138, v7, 2, v6
    v_lshlrev_b32 v6, 4, v4
    v_lshl_add_u32 v6, v5, 2, v6
    s_mul_i32 s27, s14, 3584
    s_add_u32 s27, s27, 0
    v_add_u32 v140, s27, v6
    v_lshlrev_b32 v142, 7, v1
    s_mov_b32 s30, 91226112
    s_lshl_b32 s31, s12, 11
    s_add_u32 s31, s31, 91758592
    s_xor_b32 s27, s12, 1
    s_lshl_b32 s32, s27, 11
    s_add_u32 s32, s32, 91758592
    s_mul_i32 s33, s14, 57344
    s_lshl_b32 s27, s13, 8
    s_add_u32 s33, s33, s27
    s_add_u32 s33, s33, 92020736
    s_lshl_b32 s34, s12, 12
    s_add_u32 s34, s34, 92020736
    s_mul_i32 s35, s13, 28
    s_mul_i32 s27, s14, 14
    s_add_u32 s35, s35, s27
    s_lshl_b32 s36, s35, 10
    s_add_u32 s36, s36, 47185920
    s_lshl_b32 s35, s35, 9
    s_add_u32 s35, s35, 76546048
    s_mul_i32 s37, s14, 7168
    s_add_u32 s37, s37, 2097152
    s_lshl_b32 s38, s12, 8
    s_mov_b32 s15, 0
    s_mul_i32 s40, s13, 28
    s_mul_i32 s27, s14, 14
    s_add_u32 s40, s40, s27
    s_mul_i32 s40, s40, 14336
    s_add_u32 s40, s40, 4194304
    s_add_u32 s41, s40, 6422528
    v_mov_b32 v8, 0
    v_mov_b32 v9, 0
    v_mov_b32 v10, 0
    v_mov_b32 v11, 0
    v_add_u32 v6, 16384, v2
    ds_write_b128 v6, v[8:11]
    s_cmp_eq_u32 s20, 1
    s_cbranch_scc1 K3_W1
    s_cmp_eq_u32 s20, 2
    s_cbranch_scc1 K3_W2
    s_cmp_eq_u32 s20, 3
    s_cbranch_scc1 K3_W3
K3_W0:
    s_add_u32 s27, s40, 0
    buffer_load_dwordx4 a[0:3], v2, s[8:11], s27 offen offset:0
    buffer_load_dwordx4 a[4:7], v2, s[8:11], s27 offen offset:1024
    buffer_load_dwordx4 a[8:11], v2, s[8:11], s27 offen offset:2048
    buffer_load_dwordx4 a[12:15], v2, s[8:11], s27 offen offset:3072
    s_add_u32 s27, s40, 4096
    buffer_load_dwordx4 a[16:19], v2, s[8:11], s27 offen offset:0
    buffer_load_dwordx4 a[20:23], v2, s[8:11], s27 offen offset:1024
    buffer_load_dwordx4 a[24:27], v2, s[8:11], s27 offen offset:2048
    buffer_load_dwordx4 a[28:31], v2, s[8:11], s27 offen offset:3072
    s_add_u32 s27, s40, 8192
    buffer_load_dwordx4 a[32:35], v2, s[8:11], s27 offen offset:0
    buffer_load_dwordx4 a[36:39], v2, s[8:11], s27 offen offset:1024
    buffer_load_dwordx4 a[40:43], v2, s[8:11], s27 offen offset:2048
    buffer_load_dwordx4 a[44:47], v2, s[8:11], s27 offen offset:3072
    s_add_u32 s27, s40, 12288
    buffer_load_dwordx4 a[48:51], v2, s[8:11], s27 offen offset:0
    buffer_load_dwordx4 a[52:55], v2, s[8:11], s27 offen offset:1024
    s_add_u32 s27, s40, 57344
    buffer_load_dwordx4 a[56:59], v2, s[8:11], s27 offen offset:0
    buffer_load_dwordx4 a[60:63], v2, s[8:11], s27 offen offset:1024
    buffer_load_dwordx4 a[64:67], v2, s[8:11], s27 offen offset:2048
    buffer_load_dwordx4 a[68:71], v2, s[8:11], s27 offen offset:3072
    s_add_u32 s27, s40, 61440
    buffer_load_dwordx4 a[72:75], v2, s[8:11], s27 offen offset:0
    buffer_load_dwordx4 a[76:79], v2, s[8:11], s27 offen offset:1024
    buffer_load_dwordx4 a[80:83], v2, s[8:11], s27 offen offset:2048
    buffer_load_dwordx4 a[84:87], v2, s[8:11], s27 offen offset:3072
    s_add_u32 s27, s40, 65536
    buffer_load_dwordx4 a[88:91], v2, s[8:11], s27 offen offset:0
    buffer_load_dwordx4 a[92:95], v2, s[8:11], s27 offen offset:1024
    buffer_load_dwordx4 a[96:99], v2, s[8:11], s27 offen offset:2048
    buffer_load_dwordx4 a[100:103], v2, s[8:11], s27 offen offset:3072
    s_add_u32 s27, s40, 69632
    buffer_load_dwordx4 a[104:107], v2, s[8:11], s27 offen offset:0
    buffer_load_dwordx4 a[108:111], v2, s[8:11], s27 offen offset:1024
    s_add_u32 s27, s40, 114688
    buffer_load_dwordx4 a[112:115], v2, s[8:11], s27 offen offset:0
    buffer_load_dwordx4 a[116:119], v2, s[8:11], s27 offen offset:1024
    buffer_load_dwordx4 a[120:123], v2, s[8:11], s27 offen offset:2048
    buffer_load_dwordx4 a[124:127], v2, s[8:11], s27 offen offset:3072
    s_add_u32 s27, s40, 118784
    buffer_load_dwordx4 a[128:131], v2, s[8:11], s27 offen offset:0
    buffer_load_dwordx4 a[132:135], v2, s[8:11], s27 offen offset:1024
    buffer_load_dwordx4 a[136:139], v2, s[8:11], s27 offen offset:2048
    buffer_load_dwordx4 a[140:143], v2, s[8:11], s27 offen offset:3072
    s_add_u32 s27, s40, 122880
    buffer_load_dwordx4 a[144:147], v2, s[8:11], s27 offen offset:0
    buffer_load_dwordx4 a[148:151], v2, s[8:11], s27 offen offset:1024
    buffer_load_dwordx4 a[152:155], v2, s[8:11], s27 offen offset:2048
    buffer_load_dwordx4 a[156:159], v2, s[8:11], s27 offen offset:3072
    s_add_u32 s27, s40, 126976
    buffer_load_dwordx4 a[160:163], v2, s[8:11], s27 offen offset:0
    buffer_load_dwordx4 a[164:167], v2, s[8:11], s27 offen offset:1024
    s_add_u32 s27, s40, 172032
    buffer_load_dwordx4 a[168:171], v2, s[8:11], s27 offen offset:0
    buffer_load_dwordx4 a[172:175], v2, s[8:11], s27 offen offset:1024
    buffer_load_dwordx4 a[176:179], v2, s[8:11], s27 offen offset:2048
    buffer_load_dwordx4 a[180:183], v2, s[8:11], s27 offen offset:3072
    s_add_u32 s27, s40, 176128
    buffer_load_dwordx4 a[184:187], v2, s[8:11], s27 offen offset:0
    buffer_load_dwordx4 a[188:191], v2, s[8:11], s27 offen offset:1024
    buffer_load_dwordx4 a[192:195], v2, s[8:11], s27 offen offset:2048
    buffer_load_dwordx4 a[196:199], v2, s[8:11], s27 offen offset:3072
    s_add_u32 s27, s40, 180224
    buffer_load_dwordx4 a[200:203], v2, s[8:11], s27 offen offset:0
    buffer_load_dwordx4 a[204:207], v2, s[8:11], s27 offen offset:1024
    buffer_load_dwordx4 a[208:211], v2, s[8:11], s27 offen offset:2048
    buffer_load_dwordx4 a[212:215], v2, s[8:11], s27 offen offset:3072
    s_add_u32 s27, s40, 184320
    buffer_load_dwordx4 a[216:219], v2, s[8:11], s27 offen offset:0
    buffer_load_dwordx4 a[220:223], v2, s[8:11], s27 offen offset:1024
    s_waitcnt vmcnt(8)
    s_add_u32 s27, s41, 0
    buffer_load_dwordx4 v[144:147], v2, s[8:11], s27 offen offset:0
    buffer_load_dwordx4 v[148:151], v2, s[8:11], s27 offen offset:1024
    buffer_load_dwordx4 v[152:155], v2, s[8:11], s27 offen offset:2048
    buffer_load_dwordx4 v[156:159], v2, s[8:11], s27 offen offset:3072
    s_add_u32 s27, s41, 4096
    buffer_load_dwordx4 v[160:163], v2, s[8:11], s27 offen offset:0
    buffer_load_dwordx4 v[164:167], v2, s[8:11], s27 offen offset:1024
    buffer_load_dwordx4 v[168:171], v2, s[8:11], s27 offen offset:2048
    buffer_load_dwordx4 v[172:175], v2, s[8:11], s27 offen offset:3072
    s_add_u32 s27, s41, 8192
    buffer_load_dwordx4 v[176:179], v2, s[8:11], s27 offen offset:0
    buffer_load_dwordx4 v[180:183], v2, s[8:11], s27 offen offset:1024
    buffer_load_dwordx4 v[184:187], v2, s[8:11], s27 offen offset:2048
    buffer_load_dwordx4 v[188:191], v2, s[8:11], s27 offen offset:3072
    s_add_u32 s27, s41, 12288
    buffer_load_dwordx4 v[192:195], v2, s[8:11], s27 offen offset:0
    buffer_load_dwordx4 v[196:199], v2, s[8:11], s27 offen offset:1024
    s_add_u32 s27, s41, 57344
    buffer_load_dwordx4 v[200:203], v2, s[8:11], s27 offen offset:0
    buffer_load_dwordx4 v[204:207], v2, s[8:11], s27 offen offset:1024
    buffer_load_dwordx4 v[208:211], v2, s[8:11], s27 offen offset:2048
    buffer_load_dwordx4 v[212:215], v2, s[8:11], s27 offen offset:3072
    s_add_u32 s27, s41, 61440
    buffer_load_dwordx4 v[216:219], v2, s[8:11], s27 offen offset:0
    buffer_load_dwordx4 v[220:223], v2, s[8:11], s27 offen offset:1024
    buffer_load_dwordx4 v[224:227], v2, s[8:11], s27 offen offset:2048
    buffer_load_dwordx4 v[228:231], v2, s[8:11], s27 offen offset:3072
    s_add_u32 s27, s41, 65536
    buffer_load_dwordx4 v[232:235], v2, s[8:11], s27 offen offset:0
    buffer_load_dwordx4 v[236:239], v2, s[8:11], s27 offen offset:1024
    buffer_load_dwordx4 v[240:243], v2, s[8:11], s27 offen offset:2048
    buffer_load_dwordx4 v[244:247], v2, s[8:11], s27 offen offset:3072
    s_add_u32 s27, s41, 69632
    buffer_load_dwordx4 v[248:251], v2, s[8:11], s27 offen offset:0
    buffer_load_dwordx4 v[252:255], v2, s[8:11], s27 offen offset:1024
    s_add_u32 s27, s41, 114688
    s_mov_b32 m0, 75264
    s_nop 0
    buffer_load_dwordx4 v2, s[8:11], s27 offen offset:0 lds
    buffer_load_dwordx4 v2, s[8:11], s27 offen offset:1024 lds
    buffer_load_dwordx4 v2, s[8:11], s27 offen offset:2048 lds
    buffer_load_dwordx4 v2, s[8:11], s27 offen offset:3072 lds
    s_add_u32 s27, s41, 118784
    s_mov_b32 m0, 79360
    s_nop 0
    buffer_load_dwordx4 v2, s[8:11], s27 offen offset:0 lds
    buffer_load_dwordx4 v2, s[8:11], s27 offen offset:1024 lds
    buffer_load_dwordx4 v2, s[8:11], s27 offen offset:2048 lds
    buffer_load_dwordx4 v2, s[8:11], s27 offen offset:3072 lds
    s_add_u32 s27, s41, 122880
    s_mov_b32 m0, 83456
    s_nop 0
    buffer_load_dwordx4 v2, s[8:11], s27 offen offset:0 lds
    buffer_load_dwordx4 v2, s[8:11], s27 offen offset:1024 lds
    buffer_load_dwordx4 v2, s[8:11], s27 offen offset:2048 lds
    buffer_load_dwordx4 v2, s[8:11], s27 offen offset:3072 lds
    s_add_u32 s27, s41, 126976
    s_mov_b32 m0, 87552
    s_nop 0
    buffer_load_dwordx4 v2, s[8:11], s27 offen offset:0 lds
    buffer_load_dwordx4 v2, s[8:11], s27 offen offset:1024 lds
    s_waitcnt vmcnt(8)
    s_mov_b32 s42, 0
    s_mov_b32 s43, 14336
    s_lshl_b32 s7, s12, 2
    s_add_u32 s7, s7, 92999680
    s_add_u32 s28, s37, 0
    s_add_u32 m0, s42, 17920
    s_nop 0
    buffer_load_dwordx4 v2, s[8:11], s28 offen offset:0 sc1 lds
    buffer_load_dwordx4 v2, s[8:11], s28 offen offset:1024 sc1 lds
    buffer_load_dwordx4 v2, s[8:11], s28 offen offset:2048 sc1 lds
    buffer_load_dwordx4 v2, s[8:11], s28 offen offset:3072 sc1 lds
    s_add_u32 s28, s37, 4096
    s_add_u32 m0, s42, 22016
    s_nop 0
    buffer_load_dwordx4 v2, s[8:11], s28 offen offset:0 sc1 lds
    buffer_load_dwordx4 v2, s[8:11], s28 offen offset:1024 sc1 lds
    buffer_load_dwordx4 v2, s[8:11], s28 offen offset:2048 sc1 lds
    s_add_u32 s36, s36, 458752
    s_add_u32 s37, s37, 28672
    v_add_u32 v143, 75264, v2
    v_add_u32 v140, 132608, v141
    s_lshl_b32 s6, s12, 2
    s_add_u32 s6, s6, 94174720
    v_and_b32 v6, 15, v1
    v_mov_b32 v112, 0
    v_mov_b32 v7, 0x3f80
    v_mov_b32 v8, 0x3f800000
    v_cmp_eq_u32 vcc, 0, v6
    s_nop 1
    v_cndmask_b32 v112, v112, v7, vcc
    v_cmp_eq_u32 vcc, 1, v6
    s_nop 1
    v_cndmask_b32 v112, v112, v8, vcc
    v_mov_b32 v113, 0
    v_mov_b32 v7, 0x3f80
    v_mov_b32 v8, 0x3f800000
    v_cmp_eq_u32 vcc, 2, v6
    s_nop 1
    v_cndmask_b32 v113, v113, v7, vcc
    v_cmp_eq_u32 vcc, 3, v6
    s_nop 1
    v_cndmask_b32 v113, v113, v8, vcc
    v_mov_b32 v114, 0
    v_mov_b32 v7, 0x3f80
    v_mov_b32 v8, 0x3f800000
    v_cmp_eq_u32 vcc, 4, v6
    s_nop 1
    v_cndmask_b32 v114, v114, v7, vcc
    v_cmp_eq_u32 vcc, 5, v6
    s_nop 1
    v_cndmask_b32 v114, v114, v8, vcc
    v_mov_b32 v115, 0
    v_mov_b32 v7, 0x3f80
    v_mov_b32 v8, 0x3f800000
    v_cmp_eq_u32 vcc, 6, v6
    s_nop 1
    v_cndmask_b32 v115, v115, v7, vcc
    v_cmp_eq_u32 vcc, 7, v6
    s_nop 1
    v_cndmask_b32 v115, v115, v8, vcc
    s_mov_b32 s53, 92995584
    s_lshl_b32 s55, s12, 2
    s_add_u32 s55, s55, 92995584
    v_mov_b32 v70, 0
    v_mov_b32 v71, 0
    v_mov_b32 v78, 0
    v_mov_b32 v79, 0
    v_mov_b32 v86, 0
    v_mov_b32 v87, 0
    v_mov_b32 v94, 0
    v_mov_b32 v95, 0
    v_mov_b32 v64, 0
    v_mov_b32 v65, 0
    v_mov_b32 v66, 0
    v_mov_b32 v67, 0
    v_mov_b32 v68, 0
    v_mov_b32 v69, 0
    v_mov_b32 v70, 0
    v_mov_b32 v71, 0
    v_mov_b32 v72, 0
    v_mov_b32 v73, 0
    v_mov_b32 v74, 0
    v_mov_b32 v75, 0
    v_mov_b32 v76, 0
    v_mov_b32 v77, 0
    v_mov_b32 v78, 0
    v_mov_b32 v79, 0
    v_mov_b32 v80, 0
    v_mov_b32 v81, 0
    v_mov_b32 v82, 0
    v_mov_b32 v83, 0
    v_mov_b32 v84, 0
    v_mov_b32 v85, 0
    v_mov_b32 v86, 0
    v_mov_b32 v87, 0
    v_mov_b32 v88, 0
    v_mov_b32 v89, 0
    v_mov_b32 v90, 0
    v_mov_b32 v91, 0
    s_and_b32 s44, s15, 3
    s_lshl_b32 s45, s44, 16
    s_mul_i32 s46, s44, 114688
    s_add_u32 s47, s31, s45
    s_add_u32 s48, s32, s45
    s_add_u32 s49, s33, s46
    s_add_u32 s50, s34, s46
    s_add_u32 s52, s50, 4096
    s_add_u32 s51, s30, 4096
    s_add_u32 s54, s15, 1
    s_add_u32 s59, s15, 3
    s_and_b32 s59, s59, 3
    s_mul_i32 s59, s59, 114688
    s_add_u32 s59, s59, s34
    v_add_u32 v130, s42, v2
    v_mov_b32 v32, 0
    v_mov_b32 v33, 0
    v_mov_b32 v34, 0
    v_mov_b32 v35, 0
    v_mov_b32 v36, 0
    v_mov_b32 v37, 0
    v_mov_b32 v38, 0
    v_mov_b32 v39, 0
    v_mov_b32 v40, 0
    v_mov_b32 v41, 0
    v_mov_b32 v42, 0
    v_mov_b32 v43, 0
    v_mov_b32 v44, 0
    v_mov_b32 v45, 0
    v_mov_b32 v46, 0
    v_mov_b32 v47, 0
    v_mov_b32 v48, 0
    v_mov_b32 v49, 0
    v_mov_b32 v50, 0
    v_mov_b32 v51, 0
    v_mov_b32 v52, 0
    v_mov_b32 v53, 0
    v_mov_b32 v54, 0
    v_mov_b32 v55, 0
    v_mov_b32 v56, 0
    v_mov_b32 v57, 0
    v_mov_b32 v58, 0
    v_mov_b32 v59, 0
    s_waitcnt vmcnt(0) lgkmcnt(0)
    v_mov_b32 v122, 0
    v_mov_b32 v123, 64
    s_mov_b32 s60, 0
K3_MODE0:
    buffer_load_dword v121, v123, s[16:19], 0 offen sc1
    s_waitcnt vmcnt(0)
    buffer_load_dword v120, v122, s[16:19], 0 offen sc1
    s_add_u32 s60, s60, 1
    s_waitcnt vmcnt(0)
    v_readfirstlane_b32 s27, v120
    v_readfirstlane_b32 s28, v121
    s_nop 3
    s_cmp_ge_u32 s27, 32
    s_cbranch_scc1 K3_FAST0
    s_cmp_ge_u32 s28, 256
    s_cbranch_scc1 K3_SLOW0
    s_sleep 2
    s_cmp_lt_u32 s60, 32768
    s_cbranch_scc1 K3_MODE0
    s_branch K3_SLOW0
K3_FAST0:
K3_LOOPF0:
    s_barrier
    s_mov_b32 s60, 0
K3_PMF0:
    buffer_load_dwordx4 v[4:7], v2, s[8:11], s30 offen offset:0 sc1
    buffer_load_dwordx4 v[20:23], v2, s[8:11], s51 offen offset:0 sc1
    s_add_u32 s60, s60, 1
    s_waitcnt vmcnt(0)
    v_max3_u32 v120, v4, v5, v6
    v_max_u32 v120, v120, v7
    v_max3_u32 v121, v20, v21, v22
    v_max_u32 v121, v121, v23
    v_max_u32 v120, v120, v121
    v_cmp_eq_u32 vcc, s21, v120
    s_cbranch_vccz K3_PMF0_ok
    s_cmp_lt_u32 s60, 32768
    s_cbranch_scc1 K3_PMF0
K3_PMF0_ok:
    ds_write_b128 v2, v[4:7] offset:0
    ds_write_b128 v2, v[20:23] offset:4096
    v_smfmac_f32_16x16x64_bf16 v[32:35], v[4:7], a[0:7], v3
    v_smfmac_f32_16x16x64_bf16 v[36:39], v[4:7], a[56:63], v3
    v_smfmac_f32_16x16x64_bf16 v[40:43], v[4:7], a[112:119], v3
    v_smfmac_f32_16x16x64_bf16 v[44:47], v[4:7], a[168:175], v3
    s_waitcnt lgkmcnt(0)
    s_barrier
    ds_read_b128 v[8:11], v2 offset:1024
    ds_read_b128 v[12:15], v2 offset:2048
    ds_read_b128 v[16:19], v2 offset:3072
    ds_read_b128 v[24:27], v2 offset:5120
    ds_read_b128 v[28:31], v2 offset:6144
    v_smfmac_f32_16x16x64_bf16 v[32:35], v[20:23], a[32:39], v3
    v_smfmac_f32_16x16x64_bf16 v[36:39], v[20:23], a[88:95], v3
    v_smfmac_f32_16x16x64_bf16 v[40:43], v[20:23], a[144:151], v3
    v_smfmac_f32_16x16x64_bf16 v[44:47], v[20:23], a[200:207], v3
    s_waitcnt lgkmcnt(4)
    v_smfmac_f32_16x16x64_bf16 v[32:35], v[8:11], a[8:15], v3
    v_smfmac_f32_16x16x64_bf16 v[36:39], v[8:11], a[64:71], v3
    v_smfmac_f32_16x16x64_bf16 v[40:43], v[8:11], a[120:127], v3
    v_smfmac_f32_16x16x64_bf16 v[44:47], v[8:11], a[176:183], v3
    s_waitcnt lgkmcnt(3)
    v_smfmac_f32_16x16x64_bf16 v[32:35], v[12:15], a[16:23], v3
    v_smfmac_f32_16x16x64_bf16 v[36:39], v[12:15], a[72:79], v3
    v_smfmac_f32_16x16x64_bf16 v[40:43], v[12:15], a[128:135], v3
    v_smfmac_f32_16x16x64_bf16 v[44:47], v[12:15], a[184:191], v3
    s_waitcnt lgkmcnt(2)
    v_smfmac_f32_16x16x64_bf16 v[32:35], v[16:19], a[24:31], v3
    v_smfmac_f32_16x16x64_bf16 v[36:39], v[16:19], a[80:87], v3
    v_smfmac_f32_16x16x64_bf16 v[40:43], v[16:19], a[136:143], v3
    v_smfmac_f32_16x16x64_bf16 v[44:47], v[16:19], a[192:199], v3
    s_waitcnt lgkmcnt(1)
    s_waitcnt lgkmcnt(0)
    v_smfmac_f32_16x16x64_bf16 v[32:35], v[24:27], a[40:47], v3
    v_smfmac_f32_16x16x64_bf16 v[32:35], v[28:31], a[48:55], v3
    v_smfmac_f32_16x16x64_bf16 v[36:39], v[24:27], a[96:103], v3
    v_smfmac_f32_16x16x64_bf16 v[36:39], v[28:31], a[104:111], v3
    v_smfmac_f32_16x16x64_bf16 v[40:43], v[24:27], a[152:159], v3
    v_cvt_pk_bf16_f32 v100, v32, v33
    v_cvt_pk_bf16_f32 v101, v34, v35
    ds_write_b64 v132, v[100:101] offset:0
    v_smfmac_f32_16x16x64_bf16 v[40:43], v[28:31], a[160:167], v3
    v_smfmac_f32_16x16x64_bf16 v[44:47], v[24:27], a[208:215], v3
    v_cvt_pk_bf16_f32 v102, v36, v37
    v_cvt_pk_bf16_f32 v103, v38, v39
    ds_write_b64 v132, v[102:103] offset:2048
    v_smfmac_f32_16x16x64_bf16 v[44:47], v[28:31], a[216:223], v3
    v_cvt_pk_bf16_f32 v104, v40, v41
    v_cvt_pk_bf16_f32 v105, v42, v43
    ds_write_b64 v132, v[104:105] offset:4096
    s_nop 4
    v_cvt_pk_bf16_f32 v106, v44, v45
    v_cvt_pk_bf16_f32 v107, v46, v47
    ds_write_b64 v132, v[106:107] offset:6144
    s_waitcnt lgkmcnt(0)
    s_barrier
    ds_read_b128 a[224:227], v143 offset:0
    ds_read_b128 a[228:231], v143 offset:1024
    ds_read_b128 a[232:235], v143 offset:2048
    ds_read_b128 a[236:239], v143 offset:3072
    ds_read_b128 a[240:243], v143 offset:4096
    ds_read_b128 a[244:247], v143 offset:5120
    ds_read_b128 a[248:251], v143 offset:6144
    ds_read_b128 a[252:255], v143 offset:7168
    v_smfmac_f32_16x16x64_bf16 v[48:51], v[4:7], v[144:151], v3
    v_smfmac_f32_16x16x64_bf16 v[48:51], v[8:11], v[152:159], v3
    v_smfmac_f32_16x16x64_bf16 v[48:51], v[12:15], v[160:167], v3
    v_smfmac_f32_16x16x64_bf16 v[48:51], v[16:19], v[168:175], v3
    v_smfmac_f32_16x16x64_bf16 v[48:51], v[20:23], v[176:183], v3
    v_smfmac_f32_16x16x64_bf16 v[48:51], v[24:27], v[184:191], v3
    v_smfmac_f32_16x16x64_bf16 v[48:51], v[28:31], v[192:199], v3
    s_waitcnt lgkmcnt(6)
    v_smfmac_f32_16x16x64_bf16 v[56:59], v[4:7], a[224:231], v3
    ds_read_b128 a[224:227], v143 offset:8192
    ds_read_b128 a[228:231], v143 offset:9216
    s_waitcnt lgkmcnt(6)
    v_smfmac_f32_16x16x64_bf16 v[56:59], v[8:11], a[232:239], v3
    ds_read_b128 a[232:235], v143 offset:10240
    ds_read_b128 a[236:239], v143 offset:11264
    s_waitcnt lgkmcnt(6)
    v_smfmac_f32_16x16x64_bf16 v[56:59], v[12:15], a[240:247], v3
    ds_read_b128 a[240:243], v143 offset:12288
    ds_read_b128 a[244:247], v143 offset:13312
    s_waitcnt lgkmcnt(6)
    v_smfmac_f32_16x16x64_bf16 v[56:59], v[16:19], a[248:255], v3
    s_waitcnt lgkmcnt(4)
    v_smfmac_f32_16x16x64_bf16 v[56:59], v[20:23], a[224:231], v3
    s_waitcnt lgkmcnt(2)
    v_smfmac_f32_16x16x64_bf16 v[56:59], v[24:27], a[232:239], v3
    s_waitcnt lgkmcnt(0)
    v_smfmac_f32_16x16x64_bf16 v[56:59], v[28:31], a[240:247], v3
    v_smfmac_f32_16x16x64_bf16 v[52:55], v[4:7], v[200:207], v3
    v_smfmac_f32_16x16x64_bf16 v[52:55], v[8:11], v[208:215], v3
    s_barrier
    buffer_load_dwordx4 v[124:127], v135, s[8:11], s47 offen sc1
    ds_read_b128 v[120:123], v135 offset:14336
    ds_read_b128 v[64:67], v130 offset:46592
    ds_read_b128 v[72:75], v130 offset:50688
    ds_read_b128 v[80:83], v130 offset:54784
    v_smfmac_f32_16x16x64_bf16 v[52:55], v[12:15], v[216:223], v3
    v_smfmac_f32_16x16x64_bf16 v[52:55], v[16:19], v[224:231], v3
    v_smfmac_f32_16x16x64_bf16 v[52:55], v[20:23], v[232:239], v3
    v_smfmac_f32_16x16x64_bf16 v[52:55], v[24:27], v[240:247], v3
    v_smfmac_f32_16x16x64_bf16 v[52:55], v[28:31], v[248:255], v3
    buffer_load_dwordx4 v[100:103], v135, s[8:11], s47 offen sc1
    v_mov_b32 v32, 0
    v_mov_b32 v33, 0
    v_mov_b32 v34, 0
    v_mov_b32 v35, 0
    v_mov_b32 v36, 0
    v_mov_b32 v37, 0
    v_mov_b32 v38, 0
    v_mov_b32 v39, 0
    v_mov_b32 v40, 0
    v_mov_b32 v41, 0
    v_mov_b32 v42, 0
    v_mov_b32 v43, 0
    s_nop 0
    v_cvt_pk_bf16_f32 v68, v48, v49
    v_cvt_pk_bf16_f32 v69, v50, v51
    v_cvt_pk_bf16_f32 v76, v52, v53
    v_cvt_pk_bf16_f32 v77, v54, v55
    v_cvt_pk_bf16_f32 v84, v56, v57
    v_cvt_pk_bf16_f32 v85, v58, v59
    s_waitcnt lgkmcnt(0)
    v_add_f32 v120, v120, v139
    v_add_f32 v121, v121, v139
    v_add_f32 v122, v122, v139
    v_add_f32 v123, v123, v139
    s_mov_b32 s60, 0
    s_branch K3_PSF0_c1
K3_PSF0:
    buffer_load_dwordx4 v[100:103], v135, s[8:11], s47 offen sc1
K3_PSF0_c1:
    s_add_u32 s60, s60, 1
    s_waitcnt vmcnt(1)
    v_max3_u32 v128, v124, v125, v126
    v_max_u32 v128, v128, v127
    v_cmp_eq_u32 vcc, s21, v128
    s_cbranch_vccz K3_PSF0_ok
    buffer_load_dwordx4 v[124:127], v135, s[8:11], s47 offen sc1
    s_waitcnt vmcnt(1)
    v_max3_u32 v128, v100, v101, v102
    v_max_u32 v128, v128, v103
    v_cmp_eq_u32 vcc, s21, v128
    s_cbranch_vccz K3_PSF0_okB
    s_cmp_lt_u32 s60, 32768
    s_cbranch_scc1 K3_PSF0
K3_PSF0_okB:
    v_mov_b32 v124, v100
    v_mov_b32 v125, v101
    v_mov_b32 v126, v102
    v_mov_b32 v127, v103
K3_PSF0_ok:
    v_add_f32 v120, v120, v124
    v_add_f32 v121, v121, v125
    v_add_f32 v122, v122, v126
    v_add_f32 v123, v123, v127
    v_max3_f32 v128, v120, v121, v122
    v_max_f32 v128, v128, v123
    s_nop 1
    v_max_f32_dpp v128, v128, v128 row_ror:8 row_mask:0xf bank_mask:0xf
    s_nop 1
    v_max_f32_dpp v128, v128, v128 row_ror:4 row_mask:0xf bank_mask:0xf
    s_nop 1
    v_max_f32_dpp v128, v128, v128 row_ror:2 row_mask:0xf bank_mask:0xf
    s_nop 1
    v_max_f32_dpp v128, v128, v128 row_ror:1 row_mask:0xf bank_mask:0xf
    v_mul_f32 v128, s26, v128
    v_fma_f32 v120, v120, s26, -v128
    v_fma_f32 v121, v121, s26, -v128
    v_fma_f32 v122, v122, s26, -v128
    v_fma_f32 v123, v123, s26, -v128
    v_exp_f32 v120, v120
    v_exp_f32 v121, v121
    v_exp_f32 v122, v122
    v_exp_f32 v123, v123
    s_nop 0
    v_add_f32 v129, v120, v121
    v_add_f32 v128, v122, v123
    v_add_f32 v129, v129, v128
    s_nop 1
    v_add_f32_dpp v129, v129, v129 row_ror:8 row_mask:0xf bank_mask:0xf
    s_nop 1
    v_add_f32_dpp v129, v129, v129 row_ror:4 row_mask:0xf bank_mask:0xf
    s_nop 1
    v_add_f32_dpp v129, v129, v129 row_ror:2 row_mask:0xf bank_mask:0xf
    s_nop 1
    v_add_f32_dpp v129, v129, v129 row_ror:1 row_mask:0xf bank_mask:0xf
    v_rcp_f32 v129, v129
    s_nop 0
    v_mul_f32 v120, v120, v129
    v_mul_f32 v121, v121, v129
    v_mul_f32 v122, v122, v129
    v_mul_f32 v123, v123, v129
    v_cvt_pk_bf16_f32 v128, v120, v121
    v_cvt_pk_bf16_f32 v129, v122, v123
    ds_write_b32 v136, v128
    ds_write_b32 v136, v129 offset:128
    s_waitcnt lgkmcnt(0)
    s_barrier
    ds_read_b128 v[96:99], v137
    v_lshlrev_b32 v116, 2, v1
    s_waitcnt lgkmcnt(0)
    v_smfmac_f32_16x16x64_bf16 v[32:35], v[96:99], v[64:71], v3
    v_smfmac_f32_16x16x64_bf16 v[36:39], v[96:99], v[72:79], v3
    v_smfmac_f32_16x16x64_bf16 v[40:43], v[96:99], v[80:87], v3
    s_nop 1
    v_permlane32_swap_b32 v32, v33
    v_permlane32_swap_b32 v34, v35
    s_add_u32 s27, s49, 0
    v_add_f32 v32, v32, v33
    v_add_f32 v33, v34, v35
    v_cvt_pk_bf16_f32 v32, v32, v33
    buffer_store_dword v32, v116, s[8:11], s27 offen
    v_permlane32_swap_b32 v36, v37
    v_permlane32_swap_b32 v38, v39
    s_add_u32 s27, s49, 16384
    v_add_f32 v36, v36, v37
    v_add_f32 v37, v38, v39
    v_cvt_pk_bf16_f32 v36, v36, v37
    buffer_store_dword v36, v116, s[8:11], s27 offen
    s_nop 3
    v_permlane32_swap_b32 v40, v41
    v_permlane32_swap_b32 v42, v43
    s_add_u32 s27, s49, 32768
    v_add_f32 v40, v40, v41
    v_add_f32 v41, v42, v43
    v_cvt_pk_bf16_f32 v40, v40, v41
    buffer_store_dword v40, v116, s[8:11], s27 offen
    v_mov_b32 v108, s21
    v_mov_b32 v109, s21
    v_mov_b32 v110, s21
    v_mov_b32 v111, s21
    buffer_store_dwordx4 v[108:111], v135, s[8:11], s47 offen
    s_mov_b32 s56, s50
    s_mov_b32 s57, s52
    s_mov_b32 s58, s54
    s_add_u32 s61, s30, s38
    s_add_u32 s61, s61, 8192
    s_add_u32 s30, s30, 8192
    s_add_u32 s35, s35, 229376
    s_add_u32 s6, s6, 256
    s_add_u32 s15, s15, 1
    s_cmp_lt_u32 s15, 63
    s_cselect_b32 s27, 458752, 0
    s_cselect_b32 s28, 28672, 0
    s_add_u32 s36, s36, s27
    s_add_u32 s37, s37, s28
    s_mov_b32 s27, s42
    s_mov_b32 s42, s43
    s_mov_b32 s43, s27
    s_and_b32 s44, s15, 3
    s_lshl_b32 s45, s44, 16
    s_mul_i32 s46, s44, 114688
    s_add_u32 s47, s31, s45
    s_add_u32 s48, s32, s45
    s_add_u32 s49, s33, s46
    s_add_u32 s50, s34, s46
    s_add_u32 s52, s50, 4096
    s_add_u32 s51, s30, 4096
    s_add_u32 s54, s15, 1
    s_add_u32 s59, s15, 3
    s_and_b32 s59, s59, 3
    s_mul_i32 s59, s59, 114688
    s_add_u32 s59, s59, s34
    v_add_u32 v130, s42, v2
    s_cmp_ge_u32 s12, 28
    s_cbranch_scc1 K3_NOREDF
    s_mov_b32 s60, 0
    v_mov_b32 v32, 0
    v_mov_b32 v33, 0
    v_mov_b32 v34, 0
    v_mov_b32 v35, 0
    v_mov_b32 v36, 0
    v_mov_b32 v37, 0
    v_mov_b32 v38, 0
    v_mov_b32 v39, 0
    v_mov_b32 v40, 0
    v_mov_b32 v41, 0
    v_mov_b32 v42, 0
    v_mov_b32 v43, 0
    v_mov_b32 v44, 0
    v_mov_b32 v45, 0
    v_mov_b32 v46, 0
    v_mov_b32 v47, 0
    v_mov_b32 v48, 0
    v_mov_b32 v49, 0
    v_mov_b32 v50, 0
    v_mov_b32 v51, 0
    v_mov_b32 v52, 0
    v_mov_b32 v53, 0
    v_mov_b32 v54, 0
    v_mov_b32 v55, 0
    v_mov_b32 v56, 0
    v_mov_b32 v57, 0
    v_mov_b32 v58, 0
    v_mov_b32 v59, 0
    buffer_load_dwordx4 v[64:67], v2, s[8:11], s56 offen offset:0 sc1
    buffer_load_dwordx4 v[68:71], v2, s[8:11], s56 offen offset:1024 sc1
    buffer_load_dwordx4 v[72:75], v2, s[8:11], s56 offen offset:2048 sc1
    buffer_load_dwordx4 v[76:79], v2, s[8:11], s56 offen offset:3072 sc1
    s_branch K3_PRF_chk
K3_PRF:
    buffer_load_dwordx4 v[64:67], v2, s[8:11], s56 offen offset:0 sc1
    buffer_load_dwordx4 v[68:71], v2, s[8:11], s56 offen offset:1024 sc1
    buffer_load_dwordx4 v[72:75], v2, s[8:11], s56 offen offset:2048 sc1
    buffer_load_dwordx4 v[76:79], v2, s[8:11], s56 offen offset:3072 sc1
K3_PRF_chk:
    s_add_u32 s60, s60, 1
    s_waitcnt vmcnt(3)
    v_mfma_f32_16x16x32_bf16 v[120:123], v[112:115], v[64:67], 0
    s_waitcnt vmcnt(2)
    v_mfma_f32_16x16x32_bf16 v[120:123], v[112:115], v[68:71], v[120:123]
    s_waitcnt vmcnt(1)
    v_mfma_f32_16x16x32_bf16 v[120:123], v[112:115], v[72:75], v[120:123]
    s_waitcnt vmcnt(0)
    v_mfma_f32_16x16x32_bf16 v[120:123], v[112:115], v[76:79], v[120:123]
    s_nop 7
    v_cmp_u_f32 vcc, v120, v120
    v_cvt_pk_bf16_f32 v124, v120, v122
    v_cvt_pk_bf16_f32 v125, v121, v123
    s_nop 1
    v_permlane32_swap_b32 v124, v125
    s_cbranch_vccz K3_PRF_ok
    s_cmp_lt_u32 s60, 32768
    s_cbranch_scc1 K3_PRF
K3_PRF_ok:
    buffer_store_dword v124, v138, s[8:11], s61 offen
    s_cmp_eq_u32 s15, 64
    s_cbranch_scc0 L_lastms_1
    s_add_u32 s27, s61, 2359296
    buffer_store_dword v124, v138, s[8:11], s27 offen sc1
L_lastms_1:
    v_lshlrev_b32 v128, 2, v1
    v_add_u32 v128, 135680, v128
    ds_write_b32 v128, v124
    s_waitcnt lgkmcnt(0)
    v_mov_b32 v129, s58
    v_mov_b32 v128, 0
    s_mov_b64 exec, 1
    buffer_store_dword v129, v128, s[8:11], s55 offen
    s_mov_b64 exec, -1
    v_mov_b32 v70, 0
    v_mov_b32 v71, 0
    v_mov_b32 v78, 0
    v_mov_b32 v79, 0
    v_mov_b32 v86, 0
    v_mov_b32 v87, 0
    v_mov_b32 v94, 0
    v_mov_b32 v95, 0
    s_branch K3_REDDONEF
K3_NOREDF:
    v_mov_b32 v32, 0
    v_mov_b32 v33, 0
    v_mov_b32 v34, 0
    v_mov_b32 v35, 0
    v_mov_b32 v36, 0
    v_mov_b32 v37, 0
    v_mov_b32 v38, 0
    v_mov_b32 v39, 0
    v_mov_b32 v40, 0
    v_mov_b32 v41, 0
    v_mov_b32 v42, 0
    v_mov_b32 v43, 0
    v_mov_b32 v44, 0
    v_mov_b32 v45, 0
    v_mov_b32 v46, 0
    v_mov_b32 v47, 0
    v_mov_b32 v48, 0
    v_mov_b32 v49, 0
    v_mov_b32 v50, 0
    v_mov_b32 v51, 0
    v_mov_b32 v52, 0
    v_mov_b32 v53, 0
    v_mov_b32 v54, 0
    v_mov_b32 v55, 0
    v_mov_b32 v56, 0
    v_mov_b32 v57, 0
    v_mov_b32 v58, 0
    v_mov_b32 v59, 0
    v_min_u32 v122, 27, v1
    v_lshlrev_b32 v122, 2, v122
    s_mov_b32 s60, 0
K3_PHF:
    buffer_load_dword v120, v122, s[8:11], s53 offen sc1
    s_add_u32 s60, s60, 1
    s_waitcnt vmcnt(0)
    v_cmp_le_u32 vcc, s58, v120
    s_cbranch_vccnz K3_REDDONEF
    s_cmp_lt_u32 s60, 32768
    s_cbranch_scc1 K3_PHF
K3_REDDONEF:
    s_cmp_lt_u32 s15, 64
    s_cbranch_scc1 K3_LOOPF0
    s_waitcnt vmcnt(0) lgkmcnt(0)
    s_endpgm
K3_SLOW0:
    s_barrier
    s_mov_b32 s27, 93007872
    v_and_b32 v121, 31, v1
    v_lshlrev_b32 v121, 2, v121
    s_mov_b32 s60, 0
K3_RV0:
    buffer_load_dword v120, v121, s[8:11], s27 offen sc1
    s_add_u32 s60, s60, 1
    s_waitcnt vmcnt(0)
    v_cmp_eq_u32 vcc, 0, v120
    s_cbranch_vccz K3_RV0_ok
    s_sleep 8
    s_cmp_lt_u32 s60, 32768
    s_cbranch_scc1 K3_RV0
K3_RV0_ok:
K3_LOOPS0:
    s_barrier
    s_mov_b32 s60, 0
K3_PMS0:
    buffer_load_dwordx4 v[4:7], v2, s[8:11], s30 offen offset:0 sc1
    buffer_load_dwordx4 v[20:23], v2, s[8:11], s51 offen offset:0 sc1
    s_add_u32 s60, s60, 1
    s_waitcnt vmcnt(0)
    v_max3_u32 v120, v4, v5, v6
    v_max_u32 v120, v120, v7
    v_max3_u32 v121, v20, v21, v22
    v_max_u32 v121, v121, v23
    v_max_u32 v120, v120, v121
    v_cmp_eq_u32 vcc, s21, v120
    s_cbranch_vccz K3_PMS0_ok
    s_cmp_lt_u32 s60, 32768
    s_cbranch_scc1 K3_PMS0
K3_PMS0_ok:
    ds_write_b128 v2, v[4:7] offset:0
    ds_write_b128 v2, v[20:23] offset:4096
    v_smfmac_f32_16x16x64_bf16 v[32:35], v[4:7], a[0:7], v3
    v_smfmac_f32_16x16x64_bf16 v[36:39], v[4:7], a[56:63], v3
    v_smfmac_f32_16x16x64_bf16 v[40:43], v[4:7], a[112:119], v3
    v_smfmac_f32_16x16x64_bf16 v[44:47], v[4:7], a[168:175], v3
    s_waitcnt lgkmcnt(0)
    s_barrier
    ds_read_b128 v[8:11], v2 offset:1024
    ds_read_b128 v[12:15], v2 offset:2048
    ds_read_b128 v[16:19], v2 offset:3072
    ds_read_b128 v[24:27], v2 offset:5120
    ds_read_b128 v[28:31], v2 offset:6144
    v_smfmac_f32_16x16x64_bf16 v[32:35], v[20:23], a[32:39], v3
    v_smfmac_f32_16x16x64_bf16 v[36:39], v[20:23], a[88:95], v3
    v_smfmac_f32_16x16x64_bf16 v[40:43], v[20:23], a[144:151], v3
    v_smfmac_f32_16x16x64_bf16 v[44:47], v[20:23], a[200:207], v3
    s_waitcnt lgkmcnt(4)
    v_smfmac_f32_16x16x64_bf16 v[32:35], v[8:11], a[8:15], v3
    v_smfmac_f32_16x16x64_bf16 v[36:39], v[8:11], a[64:71], v3
    v_smfmac_f32_16x16x64_bf16 v[40:43], v[8:11], a[120:127], v3
    v_smfmac_f32_16x16x64_bf16 v[44:47], v[8:11], a[176:183], v3
    s_waitcnt lgkmcnt(3)
    v_smfmac_f32_16x16x64_bf16 v[32:35], v[12:15], a[16:23], v3
    v_smfmac_f32_16x16x64_bf16 v[36:39], v[12:15], a[72:79], v3
    v_smfmac_f32_16x16x64_bf16 v[40:43], v[12:15], a[128:135], v3
    v_smfmac_f32_16x16x64_bf16 v[44:47], v[12:15], a[184:191], v3
    s_waitcnt lgkmcnt(2)
    v_smfmac_f32_16x16x64_bf16 v[32:35], v[16:19], a[24:31], v3
    v_smfmac_f32_16x16x64_bf16 v[36:39], v[16:19], a[80:87], v3
    v_smfmac_f32_16x16x64_bf16 v[40:43], v[16:19], a[136:143], v3
    v_smfmac_f32_16x16x64_bf16 v[44:47], v[16:19], a[192:199], v3
    s_waitcnt lgkmcnt(1)
    s_waitcnt lgkmcnt(0)
    v_smfmac_f32_16x16x64_bf16 v[32:35], v[24:27], a[40:47], v3
    v_smfmac_f32_16x16x64_bf16 v[32:35], v[28:31], a[48:55], v3
    v_smfmac_f32_16x16x64_bf16 v[36:39], v[24:27], a[96:103], v3
    v_smfmac_f32_16x16x64_bf16 v[36:39], v[28:31], a[104:111], v3
    v_smfmac_f32_16x16x64_bf16 v[40:43], v[24:27], a[152:159], v3
    v_cvt_pk_bf16_f32 v100, v32, v33
    v_cvt_pk_bf16_f32 v101, v34, v35
    ds_write_b64 v132, v[100:101] offset:0
    v_smfmac_f32_16x16x64_bf16 v[40:43], v[28:31], a[160:167], v3
    v_smfmac_f32_16x16x64_bf16 v[44:47], v[24:27], a[208:215], v3
    v_cvt_pk_bf16_f32 v102, v36, v37
    v_cvt_pk_bf16_f32 v103, v38, v39
    ds_write_b64 v132, v[102:103] offset:2048
    v_smfmac_f32_16x16x64_bf16 v[44:47], v[28:31], a[216:223], v3
    v_cvt_pk_bf16_f32 v104, v40, v41
    v_cvt_pk_bf16_f32 v105, v42, v43
    ds_write_b64 v132, v[104:105] offset:4096
    s_nop 4
    v_cvt_pk_bf16_f32 v106, v44, v45
    v_cvt_pk_bf16_f32 v107, v46, v47
    ds_write_b64 v132, v[106:107] offset:6144
    s_waitcnt lgkmcnt(0)
    s_barrier
    ds_read_b128 a[224:227], v143 offset:0
    ds_read_b128 a[228:231], v143 offset:1024
    ds_read_b128 a[232:235], v143 offset:2048
    ds_read_b128 a[236:239], v143 offset:3072
    ds_read_b128 a[240:243], v143 offset:4096
    ds_read_b128 a[244:247], v143 offset:5120
    ds_read_b128 a[248:251], v143 offset:6144
    ds_read_b128 a[252:255], v143 offset:7168
    v_smfmac_f32_16x16x64_bf16 v[48:51], v[4:7], v[144:151], v3
    v_smfmac_f32_16x16x64_bf16 v[48:51], v[8:11], v[152:159], v3
    v_smfmac_f32_16x16x64_bf16 v[48:51], v[12:15], v[160:167], v3
    v_smfmac_f32_16x16x64_bf16 v[48:51], v[16:19], v[168:175], v3
    v_smfmac_f32_16x16x64_bf16 v[48:51], v[20:23], v[176:183], v3
    v_smfmac_f32_16x16x64_bf16 v[48:51], v[24:27], v[184:191], v3
    v_smfmac_f32_16x16x64_bf16 v[48:51], v[28:31], v[192:199], v3
    s_waitcnt lgkmcnt(6)
    v_smfmac_f32_16x16x64_bf16 v[56:59], v[4:7], a[224:231], v3
    ds_read_b128 a[224:227], v143 offset:8192
    ds_read_b128 a[228:231], v143 offset:9216
    s_waitcnt lgkmcnt(6)
    v_smfmac_f32_16x16x64_bf16 v[56:59], v[8:11], a[232:239], v3
    ds_read_b128 a[232:235], v143 offset:10240
    ds_read_b128 a[236:239], v143 offset:11264
    s_waitcnt lgkmcnt(6)
    v_smfmac_f32_16x16x64_bf16 v[56:59], v[12:15], a[240:247], v3
    ds_read_b128 a[240:243], v143 offset:12288
    ds_read_b128 a[244:247], v143 offset:13312
    s_waitcnt lgkmcnt(6)
    v_smfmac_f32_16x16x64_bf16 v[56:59], v[16:19], a[248:255], v3
    s_waitcnt lgkmcnt(4)
    v_smfmac_f32_16x16x64_bf16 v[56:59], v[20:23], a[224:231], v3
    s_waitcnt lgkmcnt(2)
    v_smfmac_f32_16x16x64_bf16 v[56:59], v[24:27], a[232:239], v3
    s_waitcnt lgkmcnt(0)
    v_smfmac_f32_16x16x64_bf16 v[56:59], v[28:31], a[240:247], v3
    v_smfmac_f32_16x16x64_bf16 v[52:55], v[4:7], v[200:207], v3
    v_smfmac_f32_16x16x64_bf16 v[52:55], v[8:11], v[208:215], v3
    s_barrier
    buffer_load_dwordx4 v[124:127], v135, s[8:11], s47 offen sc1
    ds_read_b128 v[120:123], v135 offset:14336
    ds_read_b128 v[64:67], v130 offset:46592
    ds_read_b128 v[72:75], v130 offset:50688
    ds_read_b128 v[80:83], v130 offset:54784
    v_smfmac_f32_16x16x64_bf16 v[52:55], v[12:15], v[216:223], v3
    v_smfmac_f32_16x16x64_bf16 v[52:55], v[16:19], v[224:231], v3
    v_smfmac_f32_16x16x64_bf16 v[52:55], v[20:23], v[232:239], v3
    v_smfmac_f32_16x16x64_bf16 v[52:55], v[24:27], v[240:247], v3
    v_smfmac_f32_16x16x64_bf16 v[52:55], v[28:31], v[248:255], v3
    buffer_load_dwordx4 v[100:103], v135, s[8:11], s47 offen sc1
    v_mov_b32 v32, 0
    v_mov_b32 v33, 0
    v_mov_b32 v34, 0
    v_mov_b32 v35, 0
    v_mov_b32 v36, 0
    v_mov_b32 v37, 0
    v_mov_b32 v38, 0
    v_mov_b32 v39, 0
    v_mov_b32 v40, 0
    v_mov_b32 v41, 0
    v_mov_b32 v42, 0
    v_mov_b32 v43, 0
    s_nop 0
    v_cvt_pk_bf16_f32 v68, v48, v49
    v_cvt_pk_bf16_f32 v69, v50, v51
    v_cvt_pk_bf16_f32 v76, v52, v53
    v_cvt_pk_bf16_f32 v77, v54, v55
    v_cvt_pk_bf16_f32 v84, v56, v57
    v_cvt_pk_bf16_f32 v85, v58, v59
    s_waitcnt lgkmcnt(0)
    v_add_f32 v120, v120, v139
    v_add_f32 v121, v121, v139
    v_add_f32 v122, v122, v139
    v_add_f32 v123, v123, v139
    s_mov_b32 s60, 0
    s_branch K3_PSS0_c1
K3_PSS0:
    buffer_load_dwordx4 v[100:103], v135, s[8:11], s47 offen sc1
K3_PSS0_c1:
    s_add_u32 s60, s60, 1
    s_waitcnt vmcnt(1)
    v_max3_u32 v128, v124, v125, v126
    v_max_u32 v128, v128, v127
    v_cmp_eq_u32 vcc, s21, v128
    s_cbranch_vccz K3_PSS0_ok
    buffer_load_dwordx4 v[124:127], v135, s[8:11], s47 offen sc1
    s_waitcnt vmcnt(1)
    v_max3_u32 v128, v100, v101, v102
    v_max_u32 v128, v128, v103
    v_cmp_eq_u32 vcc, s21, v128
    s_cbranch_vccz K3_PSS0_okB
    s_cmp_lt_u32 s60, 32768
    s_cbranch_scc1 K3_PSS0
K3_PSS0_okB:
    v_mov_b32 v124, v100
    v_mov_b32 v125, v101
    v_mov_b32 v126, v102
    v_mov_b32 v127, v103
K3_PSS0_ok:
    v_add_f32 v120, v120, v124
    v_add_f32 v121, v121, v125
    v_add_f32 v122, v122, v126
    v_add_f32 v123, v123, v127
    v_max3_f32 v128, v120, v121, v122
    v_max_f32 v128, v128, v123
    s_nop 1
    v_max_f32_dpp v128, v128, v128 row_ror:8 row_mask:0xf bank_mask:0xf
    s_nop 1
    v_max_f32_dpp v128, v128, v128 row_ror:4 row_mask:0xf bank_mask:0xf
    s_nop 1
    v_max_f32_dpp v128, v128, v128 row_ror:2 row_mask:0xf bank_mask:0xf
    s_nop 1
    v_max_f32_dpp v128, v128, v128 row_ror:1 row_mask:0xf bank_mask:0xf
    v_mul_f32 v128, s26, v128
    v_fma_f32 v120, v120, s26, -v128
    v_fma_f32 v121, v121, s26, -v128
    v_fma_f32 v122, v122, s26, -v128
    v_fma_f32 v123, v123, s26, -v128
    v_exp_f32 v120, v120
    v_exp_f32 v121, v121
    v_exp_f32 v122, v122
    v_exp_f32 v123, v123
    s_nop 0
    v_add_f32 v129, v120, v121
    v_add_f32 v128, v122, v123
    v_add_f32 v129, v129, v128
    s_nop 1
    v_add_f32_dpp v129, v129, v129 row_ror:8 row_mask:0xf bank_mask:0xf
    s_nop 1
    v_add_f32_dpp v129, v129, v129 row_ror:4 row_mask:0xf bank_mask:0xf
    s_nop 1
    v_add_f32_dpp v129, v129, v129 row_ror:2 row_mask:0xf bank_mask:0xf
    s_nop 1
    v_add_f32_dpp v129, v129, v129 row_ror:1 row_mask:0xf bank_mask:0xf
    v_rcp_f32 v129, v129
    s_nop 0
    v_mul_f32 v120, v120, v129
    v_mul_f32 v121, v121, v129
    v_mul_f32 v122, v122, v129
    v_mul_f32 v123, v123, v129
    v_cvt_pk_bf16_f32 v128, v120, v121
    v_cvt_pk_bf16_f32 v129, v122, v123
    ds_write_b32 v136, v128
    ds_write_b32 v136, v129 offset:128
    s_waitcnt lgkmcnt(0)
    s_barrier
    ds_read_b128 v[96:99], v137
    v_lshlrev_b32 v116, 2, v1
    s_waitcnt lgkmcnt(0)
    v_smfmac_f32_16x16x64_bf16 v[32:35], v[96:99], v[64:71], v3
    v_smfmac_f32_16x16x64_bf16 v[36:39], v[96:99], v[72:79], v3
    v_smfmac_f32_16x16x64_bf16 v[40:43], v[96:99], v[80:87], v3
    s_nop 1
    v_permlane32_swap_b32 v32, v33
    v_permlane32_swap_b32 v34, v35
    s_add_u32 s27, s49, 0
    v_add_f32 v32, v32, v33
    v_add_f32 v33, v34, v35
    v_cvt_pk_bf16_f32 v32, v32, v33
    buffer_store_dword v32, v116, s[8:11], s27 offen sc1
    v_permlane32_swap_b32 v36, v37
    v_permlane32_swap_b32 v38, v39
    s_add_u32 s27, s49, 16384
    v_add_f32 v36, v36, v37
    v_add_f32 v37, v38, v39
    v_cvt_pk_bf16_f32 v36, v36, v37
    buffer_store_dword v36, v116, s[8:11], s27 offen sc1
    s_nop 3
    v_permlane32_swap_b32 v40, v41
    v_permlane32_swap_b32 v42, v43
    s_add_u32 s27, s49, 32768
    v_add_f32 v40, v40, v41
    v_add_f32 v41, v42, v43
    v_cvt_pk_bf16_f32 v40, v40, v41
    buffer_store_dword v40, v116, s[8:11], s27 offen sc1
    v_mov_b32 v108, s21
    v_mov_b32 v109, s21
    v_mov_b32 v110, s21
    v_mov_b32 v111, s21
    buffer_store_dwordx4 v[108:111], v135, s[8:11], s47 offen sc1
    s_mov_b32 s56, s50
    s_mov_b32 s57, s52
    s_mov_b32 s58, s54
    s_add_u32 s61, s30, s38
    s_add_u32 s61, s61, 8192
    s_add_u32 s30, s30, 8192
    s_add_u32 s35, s35, 229376
    s_add_u32 s6, s6, 256
    s_add_u32 s15, s15, 1
    s_cmp_lt_u32 s15, 63
    s_cselect_b32 s27, 458752, 0
    s_cselect_b32 s28, 28672, 0
    s_add_u32 s36, s36, s27
    s_add_u32 s37, s37, s28
    s_mov_b32 s27, s42
    s_mov_b32 s42, s43
    s_mov_b32 s43, s27
    s_and_b32 s44, s15, 3
    s_lshl_b32 s45, s44, 16
    s_mul_i32 s46, s44, 114688
    s_add_u32 s47, s31, s45
    s_add_u32 s48, s32, s45
    s_add_u32 s49, s33, s46
    s_add_u32 s50, s34, s46
    s_add_u32 s52, s50, 4096
    s_add_u32 s51, s30, 4096
    s_add_u32 s54, s15, 1
    s_add_u32 s59, s15, 3
    s_and_b32 s59, s59, 3
    s_mul_i32 s59, s59, 114688
    s_add_u32 s59, s59, s34
    v_add_u32 v130, s42, v2
    s_cmp_ge_u32 s12, 28
    s_cbranch_scc1 K3_NOREDS
    s_mov_b32 s60, 0
    v_mov_b32 v32, 0
    v_mov_b32 v33, 0
    v_mov_b32 v34, 0
    v_mov_b32 v35, 0
    v_mov_b32 v36, 0
    v_mov_b32 v37, 0
    v_mov_b32 v38, 0
    v_mov_b32 v39, 0
    v_mov_b32 v40, 0
    v_mov_b32 v41, 0
    v_mov_b32 v42, 0
    v_mov_b32 v43, 0
    v_mov_b32 v44, 0
    v_mov_b32 v45, 0
    v_mov_b32 v46, 0
    v_mov_b32 v47, 0
    v_mov_b32 v48, 0
    v_mov_b32 v49, 0
    v_mov_b32 v50, 0
    v_mov_b32 v51, 0
    v_mov_b32 v52, 0
    v_mov_b32 v53, 0
    v_mov_b32 v54, 0
    v_mov_b32 v55, 0
    v_mov_b32 v56, 0
    v_mov_b32 v57, 0
    v_mov_b32 v58, 0
    v_mov_b32 v59, 0
    buffer_load_dwordx4 v[64:67], v2, s[8:11], s56 offen offset:0 sc1
    buffer_load_dwordx4 v[68:71], v2, s[8:11], s56 offen offset:1024 sc1
    buffer_load_dwordx4 v[72:75], v2, s[8:11], s56 offen offset:2048 sc1
    buffer_load_dwordx4 v[76:79], v2, s[8:11], s56 offen offset:3072 sc1
    s_branch K3_PRS_chk
K3_PRS:
    buffer_load_dwordx4 v[64:67], v2, s[8:11], s56 offen offset:0 sc1
    buffer_load_dwordx4 v[68:71], v2, s[8:11], s56 offen offset:1024 sc1
    buffer_load_dwordx4 v[72:75], v2, s[8:11], s56 offen offset:2048 sc1
    buffer_load_dwordx4 v[76:79], v2, s[8:11], s56 offen offset:3072 sc1
K3_PRS_chk:
    s_add_u32 s60, s60, 1
    s_waitcnt vmcnt(3)
    v_mfma_f32_16x16x32_bf16 v[120:123], v[112:115], v[64:67], 0
    s_waitcnt vmcnt(2)
    v_mfma_f32_16x16x32_bf16 v[120:123], v[112:115], v[68:71], v[120:123]
    s_waitcnt vmcnt(1)
    v_mfma_f32_16x16x32_bf16 v[120:123], v[112:115], v[72:75], v[120:123]
    s_waitcnt vmcnt(0)
    v_mfma_f32_16x16x32_bf16 v[120:123], v[112:115], v[76:79], v[120:123]
    s_nop 7
    v_cmp_u_f32 vcc, v120, v120
    v_cvt_pk_bf16_f32 v124, v120, v122
    v_cvt_pk_bf16_f32 v125, v121, v123
    s_nop 1
    v_permlane32_swap_b32 v124, v125
    s_cbranch_vccz K3_PRS_ok
    s_cmp_lt_u32 s60, 32768
    s_cbranch_scc1 K3_PRS
K3_PRS_ok:
    buffer_store_dword v124, v138, s[8:11], s61 offen sc1
    s_cmp_eq_u32 s15, 64
    s_cbranch_scc0 L_lastms_2
    s_add_u32 s27, s61, 2359296
    buffer_store_dword v124, v138, s[8:11], s27 offen sc1
L_lastms_2:
    v_lshlrev_b32 v128, 2, v1
    v_add_u32 v128, 135680, v128
    ds_write_b32 v128, v124
    s_waitcnt lgkmcnt(0)
    v_mov_b32 v129, s58
    v_mov_b32 v128, 0
    s_mov_b64 exec, 1
    buffer_store_dword v129, v128, s[8:11], s55 offen sc1
    s_mov_b64 exec, -1
    v_mov_b32 v70, 0
    v_mov_b32 v71, 0
    v_mov_b32 v78, 0
    v_mov_b32 v79, 0
    v_mov_b32 v86, 0
    v_mov_b32 v87, 0
    v_mov_b32 v94, 0
    v_mov_b32 v95, 0
    s_branch K3_REDDONES
K3_NOREDS:
    v_mov_b32 v32, 0
    v_mov_b32 v33, 0
    v_mov_b32 v34, 0
    v_mov_b32 v35, 0
    v_mov_b32 v36, 0
    v_mov_b32 v37, 0
    v_mov_b32 v38, 0
    v_mov_b32 v39, 0
    v_mov_b32 v40, 0
    v_mov_b32 v41, 0
    v_mov_b32 v42, 0
    v_mov_b32 v43, 0
    v_mov_b32 v44, 0
    v_mov_b32 v45, 0
    v_mov_b32 v46, 0
    v_mov_b32 v47, 0
    v_mov_b32 v48, 0
    v_mov_b32 v49, 0
    v_mov_b32 v50, 0
    v_mov_b32 v51, 0
    v_mov_b32 v52, 0
    v_mov_b32 v53, 0
    v_mov_b32 v54, 0
    v_mov_b32 v55, 0
    v_mov_b32 v56, 0
    v_mov_b32 v57, 0
    v_mov_b32 v58, 0
    v_mov_b32 v59, 0
    v_min_u32 v122, 27, v1
    v_lshlrev_b32 v122, 2, v122
    s_mov_b32 s60, 0
K3_PHS:
    buffer_load_dword v120, v122, s[8:11], s53 offen sc1
    s_add_u32 s60, s60, 1
    s_waitcnt vmcnt(0)
    v_cmp_le_u32 vcc, s58, v120
    s_cbranch_vccnz K3_REDDONES
    s_cmp_lt_u32 s60, 32768
    s_cbranch_scc1 K3_PHS
K3_REDDONES:
    s_cmp_lt_u32 s15, 64
    s_cbranch_scc1 K3_LOOPS0
    s_waitcnt vmcnt(0) lgkmcnt(0)
    s_endpgm
K3_W1:
    s_add_u32 s27, s40, 14336
    buffer_load_dwordx4 a[0:3], v2, s[8:11], s27 offen offset:0
    buffer_load_dwordx4 a[4:7], v2, s[8:11], s27 offen offset:1024
    buffer_load_dwordx4 a[8:11], v2, s[8:11], s27 offen offset:2048
    buffer_load_dwordx4 a[12:15], v2, s[8:11], s27 offen offset:3072
    s_add_u32 s27, s40, 18432
    buffer_load_dwordx4 a[16:19], v2, s[8:11], s27 offen offset:0
    buffer_load_dwordx4 a[20:23], v2, s[8:11], s27 offen offset:1024
    buffer_load_dwordx4 a[24:27], v2, s[8:11], s27 offen offset:2048
    buffer_load_dwordx4 a[28:31], v2, s[8:11], s27 offen offset:3072
    s_add_u32 s27, s40, 22528
    buffer_load_dwordx4 a[32:35], v2, s[8:11], s27 offen offset:0
    buffer_load_dwordx4 a[36:39], v2, s[8:11], s27 offen offset:1024
    buffer_load_dwordx4 a[40:43], v2, s[8:11], s27 offen offset:2048
    buffer_load_dwordx4 a[44:47], v2, s[8:11], s27 offen offset:3072
    s_add_u32 s27, s40, 26624
    buffer_load_dwordx4 a[48:51], v2, s[8:11], s27 offen offset:0
    buffer_load_dwordx4 a[52:55], v2, s[8:11], s27 offen offset:1024
    s_add_u32 s27, s40, 71680
    buffer_load_dwordx4 a[56:59], v2, s[8:11], s27 offen offset:0
    buffer_load_dwordx4 a[60:63], v2, s[8:11], s27 offen offset:1024
    buffer_load_dwordx4 a[64:67], v2, s[8:11], s27 offen offset:2048
    buffer_load_dwordx4 a[68:71], v2, s[8:11], s27 offen offset:3072
    s_add_u32 s27, s40, 75776
    buffer_load_dwordx4 a[72:75], v2, s[8:11], s27 offen offset:0
    buffer_load_dwordx4 a[76:79], v2, s[8:11], s27 offen offset:1024
    buffer_load_dwordx4 a[80:83], v2, s[8:11], s27 offen offset:2048
    buffer_load_dwordx4 a[84:87], v2, s[8:11], s27 offen offset:3072
    s_add_u32 s27, s40, 79872
    buffer_load_dwordx4 a[88:91], v2, s[8:11], s27 offen offset:0
    buffer_load_dwordx4 a[92:95], v2, s[8:11], s27 offen offset:1024
    buffer_load_dwordx4 a[96:99], v2, s[8:11], s27 offen offset:2048
    buffer_load_dwordx4 a[100:103], v2, s[8:11], s27 offen offset:3072
    s_add_u32 s27, s40, 83968
    buffer_load_dwordx4 a[104:107], v2, s[8:11], s27 offen offset:0
    buffer_load_dwordx4 a[108:111], v2, s[8:11], s27 offen offset:1024
    s_add_u32 s27, s40, 129024
    buffer_load_dwordx4 a[112:115], v2, s[8:11], s27 offen offset:0
    buffer_load_dwordx4 a[116:119], v2, s[8:11], s27 offen offset:1024
    buffer_load_dwordx4 a[120:123], v2, s[8:11], s27 offen offset:2048
    buffer_load_dwordx4 a[124:127], v2, s[8:11], s27 offen offset:3072
    s_add_u32 s27, s40, 133120
    buffer_load_dwordx4 a[128:131], v2, s[8:11], s27 offen offset:0
    buffer_load_dwordx4 a[132:135], v2, s[8:11], s27 offen offset:1024
    buffer_load_dwordx4 a[136:139], v2, s[8:11], s27 offen offset:2048
    buffer_load_dwordx4 a[140:143], v2, s[8:11], s27 offen offset:3072
    s_add_u32 s27, s40, 137216
    buffer_load_dwordx4 a[144:147], v2, s[8:11], s27 offen offset:0
    buffer_load_dwordx4 a[148:151], v2, s[8:11], s27 offen offset:1024
    buffer_load_dwordx4 a[152:155], v2, s[8:11], s27 offen offset:2048
    buffer_load_dwordx4 a[156:159], v2, s[8:11], s27 offen offset:3072
    s_add_u32 s27, s40, 141312
    buffer_load_dwordx4 a[160:163], v2, s[8:11], s27 offen offset:0
    buffer_load_dwordx4 a[164:167], v2, s[8:11], s27 offen offset:1024
    s_add_u32 s27, s40, 186368
    buffer_load_dwordx4 a[168:171], v2, s[8:11], s27 offen offset:0
    buffer_load_dwordx4 a[172:175], v2, s[8:11], s27 offen offset:1024
    buffer_load_dwordx4 a[176:179], v2, s[8:11], s27 offen offset:2048
    buffer_load_dwordx4 a[180:183], v2, s[8:11], s27 offen offset:3072
    s_add_u32 s27, s40, 190464
    buffer_load_dwordx4 a[184:187], v2, s[8:11], s27 offen offset:0
    buffer_load_dwordx4 a[188:191], v2, s[8:11], s27 offen offset:1024
    buffer_load_dwordx4 a[192:195], v2, s[8:11], s27 offen offset:2048
    buffer_load_dwordx4 a[196:199], v2, s[8:11], s27 offen offset:3072
    s_add_u32 s27, s40, 194560
    buffer_load_dwordx4 a[200:203], v2, s[8:11], s27 offen offset:0
    buffer_load_dwordx4 a[204:207], v2, s[8:11], s27 offen offset:1024
    buffer_load_dwordx4 a[208:211], v2, s[8:11], s27 offen offset:2048
    buffer_load_dwordx4 a[212:215], v2, s[8:11], s27 offen offset:3072
    s_add_u32 s27, s40, 198656
    buffer_load_dwordx4 a[216:219], v2, s[8:11], s27 offen offset:0
    buffer_load_dwordx4 a[220:223], v2, s[8:11], s27 offen offset:1024
    s_waitcnt vmcnt(8)
    s_add_u32 s27, s41, 14336
    buffer_load_dwordx4 v[144:147], v2, s[8:11], s27 offen offset:0
    buffer_load_dwordx4 v[148:151], v2, s[8:11], s27 offen offset:1024
    buffer_load_dwordx4 v[152:155], v2, s[8:11], s27 offen offset:2048
    buffer_load_dwordx4 v[156:159], v2, s[8:11], s27 offen offset:3072
    s_add_u32 s27, s41, 18432
    buffer_load_dwordx4 v[160:163], v2, s[8:11], s27 offen offset:0
    buffer_load_dwordx4 v[164:167], v2, s[8:11], s27 offen offset:1024
    buffer_load_dwordx4 v[168:171], v2, s[8:11], s27 offen offset:2048
    buffer_load_dwordx4 v[172:175], v2, s[8:11], s27 offen offset:3072
    s_add_u32 s27, s41, 22528
    buffer_load_dwordx4 v[176:179], v2, s[8:11], s27 offen offset:0
    buffer_load_dwordx4 v[180:183], v2, s[8:11], s27 offen offset:1024
    buffer_load_dwordx4 v[184:187], v2, s[8:11], s27 offen offset:2048
    buffer_load_dwordx4 v[188:191], v2, s[8:11], s27 offen offset:3072
    s_add_u32 s27, s41, 26624
    buffer_load_dwordx4 v[192:195], v2, s[8:11], s27 offen offset:0
    buffer_load_dwordx4 v[196:199], v2, s[8:11], s27 offen offset:1024
    s_add_u32 s27, s41, 71680
    buffer_load_dwordx4 v[200:203], v2, s[8:11], s27 offen offset:0
    buffer_load_dwordx4 v[204:207], v2, s[8:11], s27 offen offset:1024
    buffer_load_dwordx4 v[208:211], v2, s[8:11], s27 offen offset:2048
    buffer_load_dwordx4 v[212:215], v2, s[8:11], s27 offen offset:3072
    s_add_u32 s27, s41, 75776
    buffer_load_dwordx4 v[216:219], v2, s[8:11], s27 offen offset:0
    buffer_load_dwordx4 v[220:223], v2, s[8:11], s27 offen offset:1024
    buffer_load_dwordx4 v[224:227], v2, s[8:11], s27 offen offset:2048
    buffer_load_dwordx4 v[228:231], v2, s[8:11], s27 offen offset:3072
    s_add_u32 s27, s41, 79872
    buffer_load_dwordx4 v[232:235], v2, s[8:11], s27 offen offset:0
    buffer_load_dwordx4 v[236:239], v2, s[8:11], s27 offen offset:1024
    buffer_load_dwordx4 v[240:243], v2, s[8:11], s27 offen offset:2048
    buffer_load_dwordx4 v[244:247], v2, s[8:11], s27 offen offset:3072
    s_add_u32 s27, s41, 83968
    buffer_load_dwordx4 v[248:251], v2, s[8:11], s27 offen offset:0
    buffer_load_dwordx4 v[252:255], v2, s[8:11], s27 offen offset:1024
    s_add_u32 s27, s41, 129024
    s_mov_b32 m0, 89600
    s_nop 0
    buffer_load_dwordx4 v2, s[8:11], s27 offen offset:0 lds
    buffer_load_dwordx4 v2, s[8:11], s27 offen offset:1024 lds
    buffer_load_dwordx4 v2, s[8:11], s27 offen offset:2048 lds
    buffer_load_dwordx4 v2, s[8:11], s27 offen offset:3072 lds
    s_add_u32 s27, s41, 133120
    s_mov_b32 m0, 93696
    s_nop 0
    buffer_load_dwordx4 v2, s[8:11], s27 offen offset:0 lds
    buffer_load_dwordx4 v2, s[8:11], s27 offen offset:1024 lds
    buffer_load_dwordx4 v2, s[8:11], s27 offen offset:2048 lds
    buffer_load_dwordx4 v2, s[8:11], s27 offen offset:3072 lds
    s_add_u32 s27, s41, 137216
    s_mov_b32 m0, 97792
    s_nop 0
    buffer_load_dwordx4 v2, s[8:11], s27 offen offset:0 lds
    buffer_load_dwordx4 v2, s[8:11], s27 offen offset:1024 lds
    buffer_load_dwordx4 v2, s[8:11], s27 offen offset:2048 lds
    buffer_load_dwordx4 v2, s[8:11], s27 offen offset:3072 lds
    s_add_u32 s27, s41, 141312
    s_mov_b32 m0, 101888
    s_nop 0
    buffer_load_dwordx4 v2, s[8:11], s27 offen offset:0 lds
    buffer_load_dwordx4 v2, s[8:11], s27 offen offset:1024 lds
    s_waitcnt vmcnt(8)
    s_mov_b32 s42, 0
    s_mov_b32 s43, 14336
    s_lshl_b32 s7, s12, 2
    s_add_u32 s7, s7, 92999680
    s_add_u32 s28, s37, 14336
    s_add_u32 m0, s42, 25088
    s_nop 0
    buffer_load_dwordx4 v2, s[8:11], s28 offen offset:0 sc1 lds
    buffer_load_dwordx4 v2, s[8:11], s28 offen offset:1024 sc1 lds
    buffer_load_dwordx4 v2, s[8:11], s28 offen offset:2048 sc1 lds
    buffer_load_dwordx4 v2, s[8:11], s28 offen offset:3072 sc1 lds
    s_add_u32 s28, s37, 18432
    s_add_u32 m0, s42, 29184
    s_nop 0
    buffer_load_dwordx4 v2, s[8:11], s28 offen offset:0 sc1 lds
    buffer_load_dwordx4 v2, s[8:11], s28 offen offset:1024 sc1 lds
    buffer_load_dwordx4 v2, s[8:11], s28 offen offset:2048 sc1 lds
    s_add_u32 s36, s36, 458752
    s_add_u32 s37, s37, 28672
    v_add_u32 v143, 89600, v2
    v_add_u32 v140, 132608, v141
    s_lshl_b32 s6, s12, 2
    s_add_u32 s6, s6, 94174720
    s_mov_b32 s53, 92995584
    s_lshl_b32 s55, s12, 2
    s_add_u32 s55, s55, 92995584
    v_mov_b32 v70, 0
    v_mov_b32 v71, 0
    v_mov_b32 v78, 0
    v_mov_b32 v79, 0
    v_mov_b32 v86, 0
    v_mov_b32 v87, 0
    v_mov_b32 v94, 0
    v_mov_b32 v95, 0
    v_mov_b32 v64, 0
    v_mov_b32 v65, 0
    v_mov_b32 v66, 0
    v_mov_b32 v67, 0
    v_mov_b32 v68, 0
    v_mov_b32 v69, 0
    v_mov_b32 v70, 0
    v_mov_b32 v71, 0
    v_mov_b32 v72, 0
    v_mov_b32 v73, 0
    v_mov_b32 v74, 0
    v_mov_b32 v75, 0
    v_mov_b32 v76, 0
    v_mov_b32 v77, 0
    v_mov_b32 v78, 0
    v_mov_b32 v79, 0
    v_mov_b32 v80, 0
    v_mov_b32 v81, 0
    v_mov_b32 v82, 0
    v_mov_b32 v83, 0
    v_mov_b32 v84, 0
    v_mov_b32 v85, 0
    v_mov_b32 v86, 0
    v_mov_b32 v87, 0
    v_mov_b32 v88, 0
    v_mov_b32 v89, 0
    v_mov_b32 v90, 0
    v_mov_b32 v91, 0
    s_and_b32 s44, s15, 3
    s_lshl_b32 s45, s44, 16
    s_mul_i32 s46, s44, 114688
    s_add_u32 s47, s31, s45
    s_add_u32 s48, s32, s45
    s_add_u32 s49, s33, s46
    s_add_u32 s50, s34, s46
    s_add_u32 s52, s50, 4096
    s_add_u32 s51, s30, 4096
    s_add_u32 s54, s15, 1
    s_add_u32 s59, s15, 3
    s_and_b32 s59, s59, 3
    s_mul_i32 s59, s59, 114688
    s_add_u32 s59, s59, s34
    v_add_u32 v130, s42, v2
    v_mov_b32 v32, 0
    v_mov_b32 v33, 0
    v_mov_b32 v34, 0
    v_mov_b32 v35, 0
    v_mov_b32 v36, 0
    v_mov_b32 v37, 0
    v_mov_b32 v38, 0
    v_mov_b32 v39, 0
    v_mov_b32 v40, 0
    v_mov_b32 v41, 0
    v_mov_b32 v42, 0
    v_mov_b32 v43, 0
    v_mov_b32 v44, 0
    v_mov_b32 v45, 0
    v_mov_b32 v46, 0
    v_mov_b32 v47, 0
    v_mov_b32 v48, 0
    v_mov_b32 v49, 0
    v_mov_b32 v50, 0
    v_mov_b32 v51, 0
    v_mov_b32 v52, 0
    v_mov_b32 v53, 0
    v_mov_b32 v54, 0
    v_mov_b32 v55, 0
    v_mov_b32 v56, 0
    v_mov_b32 v57, 0
    v_mov_b32 v58, 0
    v_mov_b32 v59, 0
    s_waitcnt vmcnt(0) lgkmcnt(0)
    v_mov_b32 v122, 0
    v_mov_b32 v123, 64
    s_mov_b32 s60, 0
K3_MODE1:
    buffer_load_dword v121, v123, s[16:19], 0 offen sc1
    s_waitcnt vmcnt(0)
    buffer_load_dword v120, v122, s[16:19], 0 offen sc1
    s_add_u32 s60, s60, 1
    s_waitcnt vmcnt(0)
    v_readfirstlane_b32 s27, v120
    v_readfirstlane_b32 s28, v121
    s_nop 3
    s_cmp_ge_u32 s27, 32
    s_cbranch_scc1 K3_FAST1
    s_cmp_ge_u32 s28, 256
    s_cbranch_scc1 K3_SLOW1
    s_sleep 2
    s_cmp_lt_u32 s60, 32768
    s_cbranch_scc1 K3_MODE1
    s_branch K3_SLOW1
K3_FAST1:
K3_LOOPF1:
    s_barrier
    s_mov_b32 s60, 0
K3_PMF1:
    buffer_load_dwordx4 v[8:11], v2, s[8:11], s30 offen offset:1024 sc1
    buffer_load_dwordx4 v[24:27], v2, s[8:11], s51 offen offset:1024 sc1
    s_add_u32 s60, s60, 1
    s_waitcnt vmcnt(0)
    v_max3_u32 v120, v8, v9, v10
    v_max_u32 v120, v120, v11
    v_max3_u32 v121, v24, v25, v26
    v_max_u32 v121, v121, v27
    v_max_u32 v120, v120, v121
    v_cmp_eq_u32 vcc, s21, v120
    s_cbranch_vccz K3_PMF1_ok
    s_cmp_lt_u32 s60, 32768
    s_cbranch_scc1 K3_PMF1
K3_PMF1_ok:
    ds_write_b128 v2, v[8:11] offset:1024
    ds_write_b128 v2, v[24:27] offset:5120
    v_smfmac_f32_16x16x64_bf16 v[32:35], v[8:11], a[8:15], v3
    v_smfmac_f32_16x16x64_bf16 v[36:39], v[8:11], a[64:71], v3
    v_smfmac_f32_16x16x64_bf16 v[40:43], v[8:11], a[120:127], v3
    v_smfmac_f32_16x16x64_bf16 v[44:47], v[8:11], a[176:183], v3
    s_waitcnt lgkmcnt(0)
    s_barrier
    ds_read_b128 v[4:7], v2 offset:0
    ds_read_b128 v[12:15], v2 offset:2048
    ds_read_b128 v[16:19], v2 offset:3072
    ds_read_b128 v[20:23], v2 offset:4096
    ds_read_b128 v[28:31], v2 offset:6144
    v_smfmac_f32_16x16x64_bf16 v[32:35], v[24:27], a[40:47], v3
    v_smfmac_f32_16x16x64_bf16 v[36:39], v[24:27], a[96:103], v3
    v_smfmac_f32_16x16x64_bf16 v[40:43], v[24:27], a[152:159], v3
    v_smfmac_f32_16x16x64_bf16 v[44:47], v[24:27], a[208:215], v3
    s_waitcnt lgkmcnt(4)
    v_smfmac_f32_16x16x64_bf16 v[32:35], v[4:7], a[0:7], v3
    v_smfmac_f32_16x16x64_bf16 v[36:39], v[4:7], a[56:63], v3
    v_smfmac_f32_16x16x64_bf16 v[40:43], v[4:7], a[112:119], v3
    v_smfmac_f32_16x16x64_bf16 v[44:47], v[4:7], a[168:175], v3
    s_waitcnt lgkmcnt(3)
    v_smfmac_f32_16x16x64_bf16 v[32:35], v[12:15], a[16:23], v3
    v_smfmac_f32_16x16x64_bf16 v[36:39], v[12:15], a[72:79], v3
    v_smfmac_f32_16x16x64_bf16 v[40:43], v[12:15], a[128:135], v3
    v_smfmac_f32_16x16x64_bf16 v[44:47], v[12:15], a[184:191], v3
    s_waitcnt lgkmcnt(2)
    v_smfmac_f32_16x16x64_bf16 v[32:35], v[16:19], a[24:31], v3
    v_smfmac_f32_16x16x64_bf16 v[36:39], v[16:19], a[80:87], v3
    v_smfmac_f32_16x16x64_bf16 v[40:43], v[16:19], a[136:143], v3
    v_smfmac_f32_16x16x64_bf16 v[44:47], v[16:19], a[192:199], v3
    s_waitcnt lgkmcnt(1)
    s_waitcnt lgkmcnt(0)
    v_smfmac_f32_16x16x64_bf16 v[32:35], v[20:23], a[32:39], v3
    v_smfmac_f32_16x16x64_bf16 v[32:35], v[28:31], a[48:55], v3
    v_smfmac_f32_16x16x64_bf16 v[36:39], v[20:23], a[88:95], v3
    v_smfmac_f32_16x16x64_bf16 v[36:39], v[28:31], a[104:111], v3
    v_smfmac_f32_16x16x64_bf16 v[40:43], v[20:23], a[144:151], v3
    v_cvt_pk_bf16_f32 v100, v32, v33
    v_cvt_pk_bf16_f32 v101, v34, v35
    ds_write_b64 v132, v[100:101] offset:512
    v_smfmac_f32_16x16x64_bf16 v[40:43], v[28:31], a[160:167], v3
    v_smfmac_f32_16x16x64_bf16 v[44:47], v[20:23], a[200:207], v3
    v_cvt_pk_bf16_f32 v102, v36, v37
    v_cvt_pk_bf16_f32 v103, v38, v39
    ds_write_b64 v132, v[102:103] offset:2560
    v_smfmac_f32_16x16x64_bf16 v[44:47], v[28:31], a[216:223], v3
    v_cvt_pk_bf16_f32 v104, v40, v41
    v_cvt_pk_bf16_f32 v105, v42, v43
    ds_write_b64 v132, v[104:105] offset:4608
    s_nop 4
    v_cvt_pk_bf16_f32 v106, v44, v45
    v_cvt_pk_bf16_f32 v107, v46, v47
    ds_write_b64 v132, v[106:107] offset:6656
    s_waitcnt lgkmcnt(0)
    s_barrier
    ds_read_b64_tr_b16 v[100:101], v133 offset:0
    ds_read_b64_tr_b16 v[102:103], v133 offset:512
    ds_read_b128 v[64:67], v130 offset:17920
    ds_read_b64_tr_b16 v[104:105], v133 offset:1024
    ds_read_b64_tr_b16 v[106:107], v133 offset:1536
    ds_read_b128 v[68:71], v130 offset:18944
    ds_read_b64_tr_b16 v[108:109], v133 offset:2048
    ds_read_b64_tr_b16 v[110:111], v133 offset:2560
    ds_read_b128 v[72:75], v130 offset:19968
    v_smfmac_f32_16x16x64_bf16 v[48:51], v[4:7], v[144:151], v3
    v_smfmac_f32_16x16x64_bf16 v[48:51], v[8:11], v[152:159], v3
    v_smfmac_f32_16x16x64_bf16 v[48:51], v[12:15], v[160:167], v3
    v_smfmac_f32_16x16x64_bf16 v[48:51], v[16:19], v[168:175], v3
    v_smfmac_f32_16x16x64_bf16 v[48:51], v[20:23], v[176:183], v3
    v_smfmac_f32_16x16x64_bf16 v[48:51], v[24:27], v[184:191], v3
    s_waitcnt lgkmcnt(6)
    ds_read_b64_tr_b16 v[112:113], v133 offset:3072
    ds_read_b64_tr_b16 v[114:115], v133 offset:3584
    ds_read_b128 v[76:79], v130 offset:20992
    v_mfma_f32_16x16x32_bf16 v[116:119], v[64:67], v[100:103], 0
    s_waitcnt lgkmcnt(6)
    ds_read_b64_tr_b16 v[100:101], v133 offset:4096
    ds_read_b64_tr_b16 v[102:103], v133 offset:4608
    ds_read_b128 v[80:83], v130 offset:22016
    v_mfma_f32_16x16x32_bf16 v[116:119], v[68:71], v[104:107], v[116:119]
    s_waitcnt lgkmcnt(6)
    ds_read_b64_tr_b16 v[104:105], v133 offset:5120
    ds_read_b64_tr_b16 v[106:107], v133 offset:5632
    ds_read_b128 v[84:87], v130 offset:23040
    v_mfma_f32_16x16x32_bf16 v[116:119], v[72:75], v[108:111], v[116:119]
    s_waitcnt lgkmcnt(6)
    ds_read_b64_tr_b16 v[108:109], v133 offset:6144
    ds_read_b64_tr_b16 v[110:111], v133 offset:6656
    ds_read_b128 v[88:91], v130 offset:24064
    v_mfma_f32_16x16x32_bf16 v[116:119], v[76:79], v[112:115], v[116:119]
    s_waitcnt lgkmcnt(6)
    v_mfma_f32_16x16x32_bf16 v[116:119], v[80:83], v[100:103], v[116:119]
    s_waitcnt lgkmcnt(3)
    v_mfma_f32_16x16x32_bf16 v[116:119], v[84:87], v[104:107], v[116:119]
    s_waitcnt lgkmcnt(0)
    v_mfma_f32_16x16x32_bf16 v[116:119], v[88:91], v[108:111], v[116:119]
    v_smfmac_f32_16x16x64_bf16 v[48:51], v[28:31], v[192:199], v3
    v_smfmac_f32_16x16x64_bf16 v[52:55], v[4:7], v[200:207], v3
    s_nop 1
    v_add_f32_dpp v116, v116, v116 row_ror:8 row_mask:0xf bank_mask:0xf
    v_add_f32_dpp v117, v117, v117 row_ror:8 row_mask:0xf bank_mask:0xf
    v_add_f32_dpp v118, v118, v118 row_ror:8 row_mask:0xf bank_mask:0xf
    v_add_f32_dpp v119, v119, v119 row_ror:8 row_mask:0xf bank_mask:0xf
    s_mov_b64 exec, s[22:23]
    buffer_store_dwordx4 v[116:119], v134, s[8:11], s48 offen offset:0
    ds_write_b128 v134, v[116:119] offset:14336
    s_mov_b64 exec, -1
    ds_read_b128 a[224:227], v143 offset:0
    ds_read_b128 a[228:231], v143 offset:1024
    ds_read_b128 a[232:235], v143 offset:2048
    ds_read_b128 a[236:239], v143 offset:3072
    ds_read_b128 a[240:243], v143 offset:4096
    ds_read_b128 a[244:247], v143 offset:5120
    ds_read_b128 a[248:251], v143 offset:6144
    ds_read_b128 a[252:255], v143 offset:7168
    s_waitcnt lgkmcnt(8)
    s_barrier
    buffer_load_dwordx4 v[124:127], v135, s[8:11], s47 offen sc1
    s_waitcnt lgkmcnt(6)
    v_smfmac_f32_16x16x64_bf16 v[56:59], v[4:7], a[224:231], v3
    ds_read_b128 a[224:227], v143 offset:8192
    ds_read_b128 a[228:231], v143 offset:9216
    s_waitcnt lgkmcnt(6)
    v_smfmac_f32_16x16x64_bf16 v[56:59], v[8:11], a[232:239], v3
    ds_read_b128 a[232:235], v143 offset:10240
    ds_read_b128 a[236:239], v143 offset:11264
    s_waitcnt lgkmcnt(6)
    v_smfmac_f32_16x16x64_bf16 v[56:59], v[12:15], a[240:247], v3
    ds_read_b128 a[240:243], v143 offset:12288
    ds_read_b128 a[244:247], v143 offset:13312
    s_waitcnt lgkmcnt(6)
    v_smfmac_f32_16x16x64_bf16 v[56:59], v[16:19], a[248:255], v3
    s_waitcnt lgkmcnt(4)
    v_smfmac_f32_16x16x64_bf16 v[56:59], v[20:23], a[224:231], v3
    s_waitcnt lgkmcnt(2)
    v_smfmac_f32_16x16x64_bf16 v[56:59], v[24:27], a[232:239], v3
    s_waitcnt lgkmcnt(0)
    v_smfmac_f32_16x16x64_bf16 v[56:59], v[28:31], a[240:247], v3
    buffer_load_dwordx4 v[100:103], v135, s[8:11], s47 offen sc1
    ds_read_b128 v[120:123], v135 offset:14336
    ds_read_b128 v[64:67], v130 offset:47616
    ds_read_b128 v[72:75], v130 offset:51712
    ds_read_b128 v[80:83], v130 offset:55808
    v_mov_b32 v32, 0
    v_mov_b32 v33, 0
    v_mov_b32 v34, 0
    v_mov_b32 v35, 0
    v_mov_b32 v36, 0
    v_mov_b32 v37, 0
    v_mov_b32 v38, 0
    v_mov_b32 v39, 0
    v_mov_b32 v40, 0
    v_mov_b32 v41, 0
    v_mov_b32 v42, 0
    v_mov_b32 v43, 0
    s_waitcnt lgkmcnt(0)
    v_add_f32 v120, v120, v139
    v_add_f32 v121, v121, v139
    v_add_f32 v122, v122, v139
    v_add_f32 v123, v123, v139
    s_mov_b32 s60, 0
    s_branch K3_PSF1_c1
K3_PSF1:
    buffer_load_dwordx4 v[100:103], v135, s[8:11], s47 offen sc1
K3_PSF1_c1:
    s_add_u32 s60, s60, 1
    s_waitcnt vmcnt(1)
    v_max3_u32 v128, v124, v125, v126
    v_max_u32 v128, v128, v127
    v_cmp_eq_u32 vcc, s21, v128
    s_cbranch_vccz K3_PSF1_ok
    buffer_load_dwordx4 v[124:127], v135, s[8:11], s47 offen sc1
    s_waitcnt vmcnt(1)
    v_max3_u32 v128, v100, v101, v102
    v_max_u32 v128, v128, v103
    v_cmp_eq_u32 vcc, s21, v128
    s_cbranch_vccz K3_PSF1_okB
    s_cmp_lt_u32 s60, 32768
    s_cbranch_scc1 K3_PSF1
K3_PSF1_okB:
    v_mov_b32 v124, v100
    v_mov_b32 v125, v101
    v_mov_b32 v126, v102
    v_mov_b32 v127, v103
K3_PSF1_ok:
    v_add_f32 v120, v120, v124
    v_add_f32 v121, v121, v125
    v_add_f32 v122, v122, v126
    v_add_f32 v123, v123, v127
    v_max3_f32 v128, v120, v121, v122
    v_max_f32 v128, v128, v123
    v_smfmac_f32_16x16x64_bf16 v[52:55], v[8:11], v[208:215], v3
    s_nop 0
    v_max_f32_dpp v128, v128, v128 row_ror:8 row_mask:0xf bank_mask:0xf
    v_smfmac_f32_16x16x64_bf16 v[52:55], v[12:15], v[216:223], v3
    s_nop 0
    v_max_f32_dpp v128, v128, v128 row_ror:4 row_mask:0xf bank_mask:0xf
    v_smfmac_f32_16x16x64_bf16 v[52:55], v[16:19], v[224:231], v3
    s_nop 0
    v_max_f32_dpp v128, v128, v128 row_ror:2 row_mask:0xf bank_mask:0xf
    v_smfmac_f32_16x16x64_bf16 v[52:55], v[20:23], v[232:239], v3
    s_nop 0
    v_max_f32_dpp v128, v128, v128 row_ror:1 row_mask:0xf bank_mask:0xf
    v_mul_f32 v128, s26, v128
    v_fma_f32 v120, v120, s26, -v128
    v_fma_f32 v121, v121, s26, -v128
    v_fma_f32 v122, v122, s26, -v128
    v_fma_f32 v123, v123, s26, -v128
    v_exp_f32 v120, v120
    v_exp_f32 v121, v121
    v_exp_f32 v122, v122
    v_exp_f32 v123, v123
    v_smfmac_f32_16x16x64_bf16 v[52:55], v[24:27], v[240:247], v3
    v_add_f32 v129, v120, v121
    v_add_f32 v128, v122, v123
    v_add_f32 v129, v129, v128
    v_smfmac_f32_16x16x64_bf16 v[52:55], v[28:31], v[248:255], v3
    s_nop 0
    v_add_f32_dpp v129, v129, v129 row_ror:8 row_mask:0xf bank_mask:0xf
    s_nop 1
    v_add_f32_dpp v129, v129, v129 row_ror:4 row_mask:0xf bank_mask:0xf
    s_nop 1
    v_add_f32_dpp v129, v129, v129 row_ror:2 row_mask:0xf bank_mask:0xf
    s_nop 1
    v_add_f32_dpp v129, v129, v129 row_ror:1 row_mask:0xf bank_mask:0xf
    v_rcp_f32 v129, v129
    s_nop 0
    v_mul_f32 v120, v120, v129
    v_mul_f32 v121, v121, v129
    v_mul_f32 v122, v122, v129
    v_mul_f32 v123, v123, v129
    v_cvt_pk_bf16_f32 v128, v120, v121
    v_cvt_pk_bf16_f32 v129, v122, v123
    ds_write_b32 v136, v128
    ds_write_b32 v136, v129 offset:128
    s_nop 0
    v_cvt_pk_bf16_f32 v68, v48, v49
    v_cvt_pk_bf16_f32 v69, v50, v51
    v_cvt_pk_bf16_f32 v76, v52, v53
    v_cvt_pk_bf16_f32 v77, v54, v55
    v_cvt_pk_bf16_f32 v84, v56, v57
    v_cvt_pk_bf16_f32 v85, v58, v59
    s_waitcnt lgkmcnt(0)
    s_barrier
    ds_read_b128 v[96:99], v137
    v_lshlrev_b32 v116, 2, v1
    s_waitcnt lgkmcnt(0)
    v_smfmac_f32_16x16x64_bf16 v[32:35], v[96:99], v[64:71], v3
    v_smfmac_f32_16x16x64_bf16 v[36:39], v[96:99], v[72:79], v3
    v_smfmac_f32_16x16x64_bf16 v[40:43], v[96:99], v[80:87], v3
    s_nop 1
    v_permlane32_swap_b32 v32, v33
    v_permlane32_swap_b32 v34, v35
    s_add_u32 s27, s49, 4096
    v_add_f32 v32, v32, v33
    v_add_f32 v33, v34, v35
    v_cvt_pk_bf16_f32 v32, v32, v33
    buffer_store_dword v32, v116, s[8:11], s27 offen
    v_permlane32_swap_b32 v36, v37
    v_permlane32_swap_b32 v38, v39
    s_add_u32 s27, s49, 20480
    v_add_f32 v36, v36, v37
    v_add_f32 v37, v38, v39
    v_cvt_pk_bf16_f32 v36, v36, v37
    buffer_store_dword v36, v116, s[8:11], s27 offen
    s_nop 3
    v_permlane32_swap_b32 v40, v41
    v_permlane32_swap_b32 v42, v43
    s_add_u32 s27, s49, 36864
    v_add_f32 v40, v40, v41
    v_add_f32 v41, v42, v43
    v_cvt_pk_bf16_f32 v40, v40, v41
    buffer_store_dword v40, v116, s[8:11], s27 offen
    v_mov_b32 v108, s21
    v_mov_b32 v109, s21
    v_mov_b32 v110, s21
    v_mov_b32 v111, s21
    buffer_store_dwordx4 v[108:111], v135, s[8:11], s47 offen
    s_add_u32 s30, s30, 8192
    s_add_u32 s35, s35, 229376
    s_add_u32 s6, s6, 256
    s_add_u32 s15, s15, 1
    s_cmp_lt_u32 s15, 63
    s_cselect_b32 s27, 458752, 0
    s_cselect_b32 s28, 28672, 0
    s_add_u32 s36, s36, s27
    s_add_u32 s37, s37, s28
    s_mov_b32 s27, s42
    s_mov_b32 s42, s43
    s_mov_b32 s43, s27
    s_and_b32 s44, s15, 3
    s_lshl_b32 s45, s44, 16
    s_mul_i32 s46, s44, 114688
    s_add_u32 s47, s31, s45
    s_add_u32 s48, s32, s45
    s_add_u32 s49, s33, s46
    s_add_u32 s50, s34, s46
    s_add_u32 s52, s50, 4096
    s_add_u32 s51, s30, 4096
    s_add_u32 s54, s15, 1
    s_add_u32 s59, s15, 3
    s_and_b32 s59, s59, 3
    s_mul_i32 s59, s59, 114688
    s_add_u32 s59, s59, s34
    v_add_u32 v130, s42, v2
    v_mov_b32 v32, 0
    v_mov_b32 v33, 0
    v_mov_b32 v34, 0
    v_mov_b32 v35, 0
    v_mov_b32 v36, 0
    v_mov_b32 v37, 0
    v_mov_b32 v38, 0
    v_mov_b32 v39, 0
    v_mov_b32 v40, 0
    v_mov_b32 v41, 0
    v_mov_b32 v42, 0
    v_mov_b32 v43, 0
    v_mov_b32 v44, 0
    v_mov_b32 v45, 0
    v_mov_b32 v46, 0
    v_mov_b32 v47, 0
    v_mov_b32 v48, 0
    v_mov_b32 v49, 0
    v_mov_b32 v50, 0
    v_mov_b32 v51, 0
    v_mov_b32 v52, 0
    v_mov_b32 v53, 0
    v_mov_b32 v54, 0
    v_mov_b32 v55, 0
    v_mov_b32 v56, 0
    v_mov_b32 v57, 0
    v_mov_b32 v58, 0
    v_mov_b32 v59, 0
    s_cmp_lt_u32 s15, 64
    s_cbranch_scc1 K3_LOOPF1
    s_waitcnt vmcnt(0) lgkmcnt(0)
    s_endpgm
K3_SLOW1:
    s_barrier
    s_mov_b32 s27, 93007872
    v_and_b32 v121, 31, v1
    v_lshlrev_b32 v121, 2, v121
    s_mov_b32 s60, 0
K3_RV1:
    buffer_load_dword v120, v121, s[8:11], s27 offen sc1
    s_add_u32 s60, s60, 1
    s_waitcnt vmcnt(0)
    v_cmp_eq_u32 vcc, 0, v120
    s_cbranch_vccz K3_RV1_ok
    s_sleep 8
    s_cmp_lt_u32 s60, 32768
    s_cbranch_scc1 K3_RV1
K3_RV1_ok:
K3_LOOPS1:
    s_barrier
    s_mov_b32 s60, 0
K3_PMS1:
    buffer_load_dwordx4 v[8:11], v2, s[8:11], s30 offen offset:1024 sc1
    buffer_load_dwordx4 v[24:27], v2, s[8:11], s51 offen offset:1024 sc1
    s_add_u32 s60, s60, 1
    s_waitcnt vmcnt(0)
    v_max3_u32 v120, v8, v9, v10
    v_max_u32 v120, v120, v11
    v_max3_u32 v121, v24, v25, v26
    v_max_u32 v121, v121, v27
    v_max_u32 v120, v120, v121
    v_cmp_eq_u32 vcc, s21, v120
    s_cbranch_vccz K3_PMS1_ok
    s_cmp_lt_u32 s60, 32768
    s_cbranch_scc1 K3_PMS1
K3_PMS1_ok:
    ds_write_b128 v2, v[8:11] offset:1024
    ds_write_b128 v2, v[24:27] offset:5120
    v_smfmac_f32_16x16x64_bf16 v[32:35], v[8:11], a[8:15], v3
    v_smfmac_f32_16x16x64_bf16 v[36:39], v[8:11], a[64:71], v3
    v_smfmac_f32_16x16x64_bf16 v[40:43], v[8:11], a[120:127], v3
    v_smfmac_f32_16x16x64_bf16 v[44:47], v[8:11], a[176:183], v3
    s_waitcnt lgkmcnt(0)
    s_barrier
    ds_read_b128 v[4:7], v2 offset:0
    ds_read_b128 v[12:15], v2 offset:2048
    ds_read_b128 v[16:19], v2 offset:3072
    ds_read_b128 v[20:23], v2 offset:4096
    ds_read_b128 v[28:31], v2 offset:6144
    v_smfmac_f32_16x16x64_bf16 v[32:35], v[24:27], a[40:47], v3
    v_smfmac_f32_16x16x64_bf16 v[36:39], v[24:27], a[96:103], v3
    v_smfmac_f32_16x16x64_bf16 v[40:43], v[24:27], a[152:159], v3
    v_smfmac_f32_16x16x64_bf16 v[44:47], v[24:27], a[208:215], v3
    s_waitcnt lgkmcnt(4)
    v_smfmac_f32_16x16x64_bf16 v[32:35], v[4:7], a[0:7], v3
    v_smfmac_f32_16x16x64_bf16 v[36:39], v[4:7], a[56:63], v3
    v_smfmac_f32_16x16x64_bf16 v[40:43], v[4:7], a[112:119], v3
    v_smfmac_f32_16x16x64_bf16 v[44:47], v[4:7], a[168:175], v3
    s_waitcnt lgkmcnt(3)
    v_smfmac_f32_16x16x64_bf16 v[32:35], v[12:15], a[16:23], v3
    v_smfmac_f32_16x16x64_bf16 v[36:39], v[12:15], a[72:79], v3
    v_smfmac_f32_16x16x64_bf16 v[40:43], v[12:15], a[128:135], v3
    v_smfmac_f32_16x16x64_bf16 v[44:47], v[12:15], a[184:191], v3
    s_waitcnt lgkmcnt(2)
    v_smfmac_f32_16x16x64_bf16 v[32:35], v[16:19], a[24:31], v3
    v_smfmac_f32_16x16x64_bf16 v[36:39], v[16:19], a[80:87], v3
    v_smfmac_f32_16x16x64_bf16 v[40:43], v[16:19], a[136:143], v3
    v_smfmac_f32_16x16x64_bf16 v[44:47], v[16:19], a[192:199], v3
    s_waitcnt lgkmcnt(1)
    s_waitcnt lgkmcnt(0)
    v_smfmac_f32_16x16x64_bf16 v[32:35], v[20:23], a[32:39], v3
    v_smfmac_f32_16x16x64_bf16 v[32:35], v[28:31], a[48:55], v3
    v_smfmac_f32_16x16x64_bf16 v[36:39], v[20:23], a[88:95], v3
    v_smfmac_f32_16x16x64_bf16 v[36:39], v[28:31], a[104:111], v3
    v_smfmac_f32_16x16x64_bf16 v[40:43], v[20:23], a[144:151], v3
    v_cvt_pk_bf16_f32 v100, v32, v33
    v_cvt_pk_bf16_f32 v101, v34, v35
    ds_write_b64 v132, v[100:101] offset:512
    v_smfmac_f32_16x16x64_bf16 v[40:43], v[28:31], a[160:167], v3
    v_smfmac_f32_16x16x64_bf16 v[44:47], v[20:23], a[200:207], v3
    v_cvt_pk_bf16_f32 v102, v36, v37
    v_cvt_pk_bf16_f32 v103, v38, v39
    ds_write_b64 v132, v[102:103] offset:2560
    v_smfmac_f32_16x16x64_bf16 v[44:47], v[28:31], a[216:223], v3
    v_cvt_pk_bf16_f32 v104, v40, v41
    v_cvt_pk_bf16_f32 v105, v42, v43
    ds_write_b64 v132, v[104:105] offset:4608
    s_nop 4
    v_cvt_pk_bf16_f32 v106, v44, v45
    v_cvt_pk_bf16_f32 v107, v46, v47
    ds_write_b64 v132, v[106:107] offset:6656
    s_waitcnt lgkmcnt(0)
    s_barrier
    ds_read_b64_tr_b16 v[100:101], v133 offset:0
    ds_read_b64_tr_b16 v[102:103], v133 offset:512
    ds_read_b128 v[64:67], v130 offset:17920
    ds_read_b64_tr_b16 v[104:105], v133 offset:1024
    ds_read_b64_tr_b16 v[106:107], v133 offset:1536
    ds_read_b128 v[68:71], v130 offset:18944
    ds_read_b64_tr_b16 v[108:109], v133 offset:2048
    ds_read_b64_tr_b16 v[110:111], v133 offset:2560
    ds_read_b128 v[72:75], v130 offset:19968
    v_smfmac_f32_16x16x64_bf16 v[48:51], v[4:7], v[144:151], v3
    v_smfmac_f32_16x16x64_bf16 v[48:51], v[8:11], v[152:159], v3
    v_smfmac_f32_16x16x64_bf16 v[48:51], v[12:15], v[160:167], v3
    v_smfmac_f32_16x16x64_bf16 v[48:51], v[16:19], v[168:175], v3
    v_smfmac_f32_16x16x64_bf16 v[48:51], v[20:23], v[176:183], v3
    v_smfmac_f32_16x16x64_bf16 v[48:51], v[24:27], v[184:191], v3
    s_waitcnt lgkmcnt(6)
    ds_read_b64_tr_b16 v[112:113], v133 offset:3072
    ds_read_b64_tr_b16 v[114:115], v133 offset:3584
    ds_read_b128 v[76:79], v130 offset:20992
    v_mfma_f32_16x16x32_bf16 v[116:119], v[64:67], v[100:103], 0
    s_waitcnt lgkmcnt(6)
    ds_read_b64_tr_b16 v[100:101], v133 offset:4096
    ds_read_b64_tr_b16 v[102:103], v133 offset:4608
    ds_read_b128 v[80:83], v130 offset:22016
    v_mfma_f32_16x16x32_bf16 v[116:119], v[68:71], v[104:107], v[116:119]
    s_waitcnt lgkmcnt(6)
    ds_read_b64_tr_b16 v[104:105], v133 offset:5120
    ds_read_b64_tr_b16 v[106:107], v133 offset:5632
    ds_read_b128 v[84:87], v130 offset:23040
    v_mfma_f32_16x16x32_bf16 v[116:119], v[72:75], v[108:111], v[116:119]
    s_waitcnt lgkmcnt(6)
    ds_read_b64_tr_b16 v[108:109], v133 offset:6144
    ds_read_b64_tr_b16 v[110:111], v133 offset:6656
    ds_read_b128 v[88:91], v130 offset:24064
    v_mfma_f32_16x16x32_bf16 v[116:119], v[76:79], v[112:115], v[116:119]
    s_waitcnt lgkmcnt(6)
    v_mfma_f32_16x16x32_bf16 v[116:119], v[80:83], v[100:103], v[116:119]
    s_waitcnt lgkmcnt(3)
    v_mfma_f32_16x16x32_bf16 v[116:119], v[84:87], v[104:107], v[116:119]
    s_waitcnt lgkmcnt(0)
    v_mfma_f32_16x16x32_bf16 v[116:119], v[88:91], v[108:111], v[116:119]
    v_smfmac_f32_16x16x64_bf16 v[48:51], v[28:31], v[192:199], v3
    v_smfmac_f32_16x16x64_bf16 v[52:55], v[4:7], v[200:207], v3
    s_nop 1
    v_add_f32_dpp v116, v116, v116 row_ror:8 row_mask:0xf bank_mask:0xf
    v_add_f32_dpp v117, v117, v117 row_ror:8 row_mask:0xf bank_mask:0xf
    v_add_f32_dpp v118, v118, v118 row_ror:8 row_mask:0xf bank_mask:0xf
    v_add_f32_dpp v119, v119, v119 row_ror:8 row_mask:0xf bank_mask:0xf
    s_mov_b64 exec, s[22:23]
    buffer_store_dwordx4 v[116:119], v134, s[8:11], s48 offen offset:0 sc1
    ds_write_b128 v134, v[116:119] offset:14336
    s_mov_b64 exec, -1
    ds_read_b128 a[224:227], v143 offset:0
    ds_read_b128 a[228:231], v143 offset:1024
    ds_read_b128 a[232:235], v143 offset:2048
    ds_read_b128 a[236:239], v143 offset:3072
    ds_read_b128 a[240:243], v143 offset:4096
    ds_read_b128 a[244:247], v143 offset:5120
    ds_read_b128 a[248:251], v143 offset:6144
    ds_read_b128 a[252:255], v143 offset:7168
    s_waitcnt lgkmcnt(8)
    s_barrier
    buffer_load_dwordx4 v[124:127], v135, s[8:11], s47 offen sc1
    s_waitcnt lgkmcnt(6)
    v_smfmac_f32_16x16x64_bf16 v[56:59], v[4:7], a[224:231], v3
    ds_read_b128 a[224:227], v143 offset:8192
    ds_read_b128 a[228:231], v143 offset:9216
    s_waitcnt lgkmcnt(6)
    v_smfmac_f32_16x16x64_bf16 v[56:59], v[8:11], a[232:239], v3
    ds_read_b128 a[232:235], v143 offset:10240
    ds_read_b128 a[236:239], v143 offset:11264
    s_waitcnt lgkmcnt(6)
    v_smfmac_f32_16x16x64_bf16 v[56:59], v[12:15], a[240:247], v3
    ds_read_b128 a[240:243], v143 offset:12288
    ds_read_b128 a[244:247], v143 offset:13312
    s_waitcnt lgkmcnt(6)
    v_smfmac_f32_16x16x64_bf16 v[56:59], v[16:19], a[248:255], v3
    s_waitcnt lgkmcnt(4)
    v_smfmac_f32_16x16x64_bf16 v[56:59], v[20:23], a[224:231], v3
    s_waitcnt lgkmcnt(2)
    v_smfmac_f32_16x16x64_bf16 v[56:59], v[24:27], a[232:239], v3
    s_waitcnt lgkmcnt(0)
    v_smfmac_f32_16x16x64_bf16 v[56:59], v[28:31], a[240:247], v3
    buffer_load_dwordx4 v[100:103], v135, s[8:11], s47 offen sc1
    ds_read_b128 v[120:123], v135 offset:14336
    ds_read_b128 v[64:67], v130 offset:47616
    ds_read_b128 v[72:75], v130 offset:51712
    ds_read_b128 v[80:83], v130 offset:55808
    v_mov_b32 v32, 0
    v_mov_b32 v33, 0
    v_mov_b32 v34, 0
    v_mov_b32 v35, 0
    v_mov_b32 v36, 0
    v_mov_b32 v37, 0
    v_mov_b32 v38, 0
    v_mov_b32 v39, 0
    v_mov_b32 v40, 0
    v_mov_b32 v41, 0
    v_mov_b32 v42, 0
    v_mov_b32 v43, 0
    s_waitcnt lgkmcnt(0)
    v_add_f32 v120, v120, v139
    v_add_f32 v121, v121, v139
    v_add_f32 v122, v122, v139
    v_add_f32 v123, v123, v139
    s_mov_b32 s60, 0
    s_branch K3_PSS1_c1
K3_PSS1:
    buffer_load_dwordx4 v[100:103], v135, s[8:11], s47 offen sc1
K3_PSS1_c1:
    s_add_u32 s60, s60, 1
    s_waitcnt vmcnt(1)
    v_max3_u32 v128, v124, v125, v126
    v_max_u32 v128, v128, v127
    v_cmp_eq_u32 vcc, s21, v128
    s_cbranch_vccz K3_PSS1_ok
    buffer_load_dwordx4 v[124:127], v135, s[8:11], s47 offen sc1
    s_waitcnt vmcnt(1)
    v_max3_u32 v128, v100, v101, v102
    v_max_u32 v128, v128, v103
    v_cmp_eq_u32 vcc, s21, v128
    s_cbranch_vccz K3_PSS1_okB
    s_cmp_lt_u32 s60, 32768
    s_cbranch_scc1 K3_PSS1
K3_PSS1_okB:
    v_mov_b32 v124, v100
    v_mov_b32 v125, v101
    v_mov_b32 v126, v102
    v_mov_b32 v127, v103
K3_PSS1_ok:
    v_add_f32 v120, v120, v124
    v_add_f32 v121, v121, v125
    v_add_f32 v122, v122, v126
    v_add_f32 v123, v123, v127
    v_max3_f32 v128, v120, v121, v122
    v_max_f32 v128, v128, v123
    v_smfmac_f32_16x16x64_bf16 v[52:55], v[8:11], v[208:215], v3
    s_nop 0
    v_max_f32_dpp v128, v128, v128 row_ror:8 row_mask:0xf bank_mask:0xf
    v_smfmac_f32_16x16x64_bf16 v[52:55], v[12:15], v[216:223], v3
    s_nop 0
    v_max_f32_dpp v128, v128, v128 row_ror:4 row_mask:0xf bank_mask:0xf
    v_smfmac_f32_16x16x64_bf16 v[52:55], v[16:19], v[224:231], v3
    s_nop 0
    v_max_f32_dpp v128, v128, v128 row_ror:2 row_mask:0xf bank_mask:0xf
    v_smfmac_f32_16x16x64_bf16 v[52:55], v[20:23], v[232:239], v3
    s_nop 0
    v_max_f32_dpp v128, v128, v128 row_ror:1 row_mask:0xf bank_mask:0xf
    v_mul_f32 v128, s26, v128
    v_fma_f32 v120, v120, s26, -v128
    v_fma_f32 v121, v121, s26, -v128
    v_fma_f32 v122, v122, s26, -v128
    v_fma_f32 v123, v123, s26, -v128
    v_exp_f32 v120, v120
    v_exp_f32 v121, v121
    v_exp_f32 v122, v122
    v_exp_f32 v123, v123
    v_smfmac_f32_16x16x64_bf16 v[52:55], v[24:27], v[240:247], v3
    v_add_f32 v129, v120, v121
    v_add_f32 v128, v122, v123
    v_add_f32 v129, v129, v128
    v_smfmac_f32_16x16x64_bf16 v[52:55], v[28:31], v[248:255], v3
    s_nop 0
    v_add_f32_dpp v129, v129, v129 row_ror:8 row_mask:0xf bank_mask:0xf
    s_nop 1
    v_add_f32_dpp v129, v129, v129 row_ror:4 row_mask:0xf bank_mask:0xf
    s_nop 1
    v_add_f32_dpp v129, v129, v129 row_ror:2 row_mask:0xf bank_mask:0xf
    s_nop 1
    v_add_f32_dpp v129, v129, v129 row_ror:1 row_mask:0xf bank_mask:0xf
    v_rcp_f32 v129, v129
    s_nop 0
    v_mul_f32 v120, v120, v129
    v_mul_f32 v121, v121, v129
    v_mul_f32 v122, v122, v129
    v_mul_f32 v123, v123, v129
    v_cvt_pk_bf16_f32 v128, v120, v121
    v_cvt_pk_bf16_f32 v129, v122, v123
    ds_write_b32 v136, v128
    ds_write_b32 v136, v129 offset:128
    s_nop 0
    v_cvt_pk_bf16_f32 v68, v48, v49
    v_cvt_pk_bf16_f32 v69, v50, v51
    v_cvt_pk_bf16_f32 v76, v52, v53
    v_cvt_pk_bf16_f32 v77, v54, v55
    v_cvt_pk_bf16_f32 v84, v56, v57
    v_cvt_pk_bf16_f32 v85, v58, v59
    s_waitcnt lgkmcnt(0)
    s_barrier
    ds_read_b128 v[96:99], v137
    v_lshlrev_b32 v116, 2, v1
    s_waitcnt lgkmcnt(0)
    v_smfmac_f32_16x16x64_bf16 v[32:35], v[96:99], v[64:71], v3
    v_smfmac_f32_16x16x64_bf16 v[36:39], v[96:99], v[72:79], v3
    v_smfmac_f32_16x16x64_bf16 v[40:43], v[96:99], v[80:87], v3
    s_nop 1
    v_permlane32_swap_b32 v32, v33
    v_permlane32_swap_b32 v34, v35
    s_add_u32 s27, s49, 4096
    v_add_f32 v32, v32, v33
    v_add_f32 v33, v34, v35
    v_cvt_pk_bf16_f32 v32, v32, v33
    buffer_store_dword v32, v116, s[8:11], s27 offen sc1
    v_permlane32_swap_b32 v36, v37
    v_permlane32_swap_b32 v38, v39
    s_add_u32 s27, s49, 20480
    v_add_f32 v36, v36, v37
    v_add_f32 v37, v38, v39
    v_cvt_pk_bf16_f32 v36, v36, v37
    buffer_store_dword v36, v116, s[8:11], s27 offen sc1
    s_nop 3
    v_permlane32_swap_b32 v40, v41
    v_permlane32_swap_b32 v42, v43
    s_add_u32 s27, s49, 36864
    v_add_f32 v40, v40, v41
    v_add_f32 v41, v42, v43
    v_cvt_pk_bf16_f32 v40, v40, v41
    buffer_store_dword v40, v116, s[8:11], s27 offen sc1
    v_mov_b32 v108, s21
    v_mov_b32 v109, s21
    v_mov_b32 v110, s21
    v_mov_b32 v111, s21
    buffer_store_dwordx4 v[108:111], v135, s[8:11], s47 offen sc1
    s_add_u32 s30, s30, 8192
    s_add_u32 s35, s35, 229376
    s_add_u32 s6, s6, 256
    s_add_u32 s15, s15, 1
    s_cmp_lt_u32 s15, 63
    s_cselect_b32 s27, 458752, 0
    s_cselect_b32 s28, 28672, 0
    s_add_u32 s36, s36, s27
    s_add_u32 s37, s37, s28
    s_mov_b32 s27, s42
    s_mov_b32 s42, s43
    s_mov_b32 s43, s27
    s_and_b32 s44, s15, 3
    s_lshl_b32 s45, s44, 16
    s_mul_i32 s46, s44, 114688
    s_add_u32 s47, s31, s45
    s_add_u32 s48, s32, s45
    s_add_u32 s49, s33, s46
    s_add_u32 s50, s34, s46
    s_add_u32 s52, s50, 4096
    s_add_u32 s51, s30, 4096
    s_add_u32 s54, s15, 1
    s_add_u32 s59, s15, 3
    s_and_b32 s59, s59, 3
    s_mul_i32 s59, s59, 114688
    s_add_u32 s59, s59, s34
    v_add_u32 v130, s42, v2
    v_mov_b32 v32, 0
    v_mov_b32 v33, 0
    v_mov_b32 v34, 0
    v_mov_b32 v35, 0
    v_mov_b32 v36, 0
    v_mov_b32 v37, 0
    v_mov_b32 v38, 0
    v_mov_b32 v39, 0
    v_mov_b32 v40, 0
    v_mov_b32 v41, 0
    v_mov_b32 v42, 0
    v_mov_b32 v43, 0
    v_mov_b32 v44, 0
    v_mov_b32 v45, 0
    v_mov_b32 v46, 0
    v_mov_b32 v47, 0
    v_mov_b32 v48, 0
    v_mov_b32 v49, 0
    v_mov_b32 v50, 0
    v_mov_b32 v51, 0
    v_mov_b32 v52, 0
    v_mov_b32 v53, 0
    v_mov_b32 v54, 0
    v_mov_b32 v55, 0
    v_mov_b32 v56, 0
    v_mov_b32 v57, 0
    v_mov_b32 v58, 0
    v_mov_b32 v59, 0
    s_cmp_lt_u32 s15, 64
    s_cbranch_scc1 K3_LOOPS1
    s_waitcnt vmcnt(0) lgkmcnt(0)
    s_endpgm
K3_W2:
    s_add_u32 s27, s40, 28672
    buffer_load_dwordx4 a[0:3], v2, s[8:11], s27 offen offset:0
    buffer_load_dwordx4 a[4:7], v2, s[8:11], s27 offen offset:1024
    buffer_load_dwordx4 a[8:11], v2, s[8:11], s27 offen offset:2048
    buffer_load_dwordx4 a[12:15], v2, s[8:11], s27 offen offset:3072
    s_add_u32 s27, s40, 32768
    buffer_load_dwordx4 a[16:19], v2, s[8:11], s27 offen offset:0
    buffer_load_dwordx4 a[20:23], v2, s[8:11], s27 offen offset:1024
    buffer_load_dwordx4 a[24:27], v2, s[8:11], s27 offen offset:2048
    buffer_load_dwordx4 a[28:31], v2, s[8:11], s27 offen offset:3072
    s_add_u32 s27, s40, 36864
    buffer_load_dwordx4 a[32:35], v2, s[8:11], s27 offen offset:0
    buffer_load_dwordx4 a[36:39], v2, s[8:11], s27 offen offset:1024
    buffer_load_dwordx4 a[40:43], v2, s[8:11], s27 offen offset:2048
    buffer_load_dwordx4 a[44:47], v2, s[8:11], s27 offen offset:3072
    s_add_u32 s27, s40, 40960
    buffer_load_dwordx4 a[48:51], v2, s[8:11], s27 offen offset:0
    buffer_load_dwordx4 a[52:55], v2, s[8:11], s27 offen offset:1024
    s_add_u32 s27, s40, 86016
    buffer_load_dwordx4 a[56:59], v2, s[8:11], s27 offen offset:0
    buffer_load_dwordx4 a[60:63], v2, s[8:11], s27 offen offset:1024
    buffer_load_dwordx4 a[64:67], v2, s[8:11], s27 offen offset:2048
    buffer_load_dwordx4 a[68:71], v2, s[8:11], s27 offen offset:3072
    s_add_u32 s27, s40, 90112
    buffer_load_dwordx4 a[72:75], v2, s[8:11], s27 offen offset:0
    buffer_load_dwordx4 a[76:79], v2, s[8:11], s27 offen offset:1024
    buffer_load_dwordx4 a[80:83], v2, s[8:11], s27 offen offset:2048
    buffer_load_dwordx4 a[84:87], v2, s[8:11], s27 offen offset:3072
    s_add_u32 s27, s40, 94208
    buffer_load_dwordx4 a[88:91], v2, s[8:11], s27 offen offset:0
    buffer_load_dwordx4 a[92:95], v2, s[8:11], s27 offen offset:1024
    buffer_load_dwordx4 a[96:99], v2, s[8:11], s27 offen offset:2048
    buffer_load_dwordx4 a[100:103], v2, s[8:11], s27 offen offset:3072
    s_add_u32 s27, s40, 98304
    buffer_load_dwordx4 a[104:107], v2, s[8:11], s27 offen offset:0
    buffer_load_dwordx4 a[108:111], v2, s[8:11], s27 offen offset:1024
    s_add_u32 s27, s40, 143360
    buffer_load_dwordx4 a[112:115], v2, s[8:11], s27 offen offset:0
    buffer_load_dwordx4 a[116:119], v2, s[8:11], s27 offen offset:1024
    buffer_load_dwordx4 a[120:123], v2, s[8:11], s27 offen offset:2048
    buffer_load_dwordx4 a[124:127], v2, s[8:11], s27 offen offset:3072
    s_add_u32 s27, s40, 147456
    buffer_load_dwordx4 a[128:131], v2, s[8:11], s27 offen offset:0
    buffer_load_dwordx4 a[132:135], v2, s[8:11], s27 offen offset:1024
    buffer_load_dwordx4 a[136:139], v2, s[8:11], s27 offen offset:2048
    buffer_load_dwordx4 a[140:143], v2, s[8:11], s27 offen offset:3072
    s_add_u32 s27, s40, 151552
    buffer_load_dwordx4 a[144:147], v2, s[8:11], s27 offen offset:0
    buffer_load_dwordx4 a[148:151], v2, s[8:11], s27 offen offset:1024
    buffer_load_dwordx4 a[152:155], v2, s[8:11], s27 offen offset:2048
    buffer_load_dwordx4 a[156:159], v2, s[8:11], s27 offen offset:3072
    s_add_u32 s27, s40, 155648
    buffer_load_dwordx4 a[160:163], v2, s[8:11], s27 offen offset:0
    buffer_load_dwordx4 a[164:167], v2, s[8:11], s27 offen offset:1024
    s_add_u32 s27, s41, 28672
    buffer_load_dwordx4 a[168:171], v2, s[8:11], s27 offen offset:0
    buffer_load_dwordx4 a[172:175], v2, s[8:11], s27 offen offset:1024
    buffer_load_dwordx4 a[176:179], v2, s[8:11], s27 offen offset:2048
    buffer_load_dwordx4 a[180:183], v2, s[8:11], s27 offen offset:3072
    s_add_u32 s27, s41, 32768
    buffer_load_dwordx4 a[184:187], v2, s[8:11], s27 offen offset:0
    buffer_load_dwordx4 a[188:191], v2, s[8:11], s27 offen offset:1024
    buffer_load_dwordx4 a[192:195], v2, s[8:11], s27 offen offset:2048
    buffer_load_dwordx4 a[196:199], v2, s[8:11], s27 offen offset:3072
    s_add_u32 s27, s41, 36864
    buffer_load_dwordx4 a[200:203], v2, s[8:11], s27 offen offset:0
    buffer_load_dwordx4 a[204:207], v2, s[8:11], s27 offen offset:1024
    buffer_load_dwordx4 a[208:211], v2, s[8:11], s27 offen offset:2048
    buffer_load_dwordx4 a[212:215], v2, s[8:11], s27 offen offset:3072
    s_add_u32 s27, s41, 40960
    buffer_load_dwordx4 a[216:219], v2, s[8:11], s27 offen offset:0
    buffer_load_dwordx4 a[220:223], v2, s[8:11], s27 offen offset:1024
    s_waitcnt vmcnt(8)
    s_add_u32 s27, s41, 86016
    buffer_load_dwordx4 v[144:147], v2, s[8:11], s27 offen offset:0
    buffer_load_dwordx4 v[148:151], v2, s[8:11], s27 offen offset:1024
    buffer_load_dwordx4 v[152:155], v2, s[8:11], s27 offen offset:2048
    buffer_load_dwordx4 v[156:159], v2, s[8:11], s27 offen offset:3072
    s_add_u32 s27, s41, 90112
    buffer_load_dwordx4 v[160:163], v2, s[8:11], s27 offen offset:0
    buffer_load_dwordx4 v[164:167], v2, s[8:11], s27 offen offset:1024
    buffer_load_dwordx4 v[168:171], v2, s[8:11], s27 offen offset:2048
    buffer_load_dwordx4 v[172:175], v2, s[8:11], s27 offen offset:3072
    s_add_u32 s27, s41, 94208
    buffer_load_dwordx4 v[176:179], v2, s[8:11], s27 offen offset:0
    buffer_load_dwordx4 v[180:183], v2, s[8:11], s27 offen offset:1024
    buffer_load_dwordx4 v[184:187], v2, s[8:11], s27 offen offset:2048
    buffer_load_dwordx4 v[188:191], v2, s[8:11], s27 offen offset:3072
    s_add_u32 s27, s41, 98304
    buffer_load_dwordx4 v[192:195], v2, s[8:11], s27 offen offset:0
    buffer_load_dwordx4 v[196:199], v2, s[8:11], s27 offen offset:1024
    s_add_u32 s27, s41, 143360
    buffer_load_dwordx4 v[200:203], v2, s[8:11], s27 offen offset:0
    buffer_load_dwordx4 v[204:207], v2, s[8:11], s27 offen offset:1024
    buffer_load_dwordx4 v[208:211], v2, s[8:11], s27 offen offset:2048
    buffer_load_dwordx4 v[212:215], v2, s[8:11], s27 offen offset:3072
    s_add_u32 s27, s41, 147456
    buffer_load_dwordx4 v[216:219], v2, s[8:11], s27 offen offset:0
    buffer_load_dwordx4 v[220:223], v2, s[8:11], s27 offen offset:1024
    buffer_load_dwordx4 v[224:227], v2, s[8:11], s27 offen offset:2048
    buffer_load_dwordx4 v[228:231], v2, s[8:11], s27 offen offset:3072
    s_add_u32 s27, s41, 151552
    buffer_load_dwordx4 v[232:235], v2, s[8:11], s27 offen offset:0
    buffer_load_dwordx4 v[236:239], v2, s[8:11], s27 offen offset:1024
    buffer_load_dwordx4 v[240:243], v2, s[8:11], s27 offen offset:2048
    buffer_load_dwordx4 v[244:247], v2, s[8:11], s27 offen offset:3072
    s_add_u32 s27, s41, 155648
    buffer_load_dwordx4 v[248:251], v2, s[8:11], s27 offen offset:0
    buffer_load_dwordx4 v[252:255], v2, s[8:11], s27 offen offset:1024
    s_add_u32 s27, s41, 172032
    s_mov_b32 m0, 103936
    s_nop 0
    buffer_load_dwordx4 v2, s[8:11], s27 offen offset:0 lds
    buffer_load_dwordx4 v2, s[8:11], s27 offen offset:1024 lds
    buffer_load_dwordx4 v2, s[8:11], s27 offen offset:2048 lds
    buffer_load_dwordx4 v2, s[8:11], s27 offen offset:3072 lds
    s_add_u32 s27, s41, 176128
    s_mov_b32 m0, 108032
    s_nop 0
    buffer_load_dwordx4 v2, s[8:11], s27 offen offset:0 lds
    buffer_load_dwordx4 v2, s[8:11], s27 offen offset:1024 lds
    buffer_load_dwordx4 v2, s[8:11], s27 offen offset:2048 lds
    buffer_load_dwordx4 v2, s[8:11], s27 offen offset:3072 lds
    s_add_u32 s27, s41, 180224
    s_mov_b32 m0, 112128
    s_nop 0
    buffer_load_dwordx4 v2, s[8:11], s27 offen offset:0 lds
    buffer_load_dwordx4 v2, s[8:11], s27 offen offset:1024 lds
    buffer_load_dwordx4 v2, s[8:11], s27 offen offset:2048 lds
    buffer_load_dwordx4 v2, s[8:11], s27 offen offset:3072 lds
    s_add_u32 s27, s41, 184320
    s_mov_b32 m0, 116224
    s_nop 0
    buffer_load_dwordx4 v2, s[8:11], s27 offen offset:0 lds
    buffer_load_dwordx4 v2, s[8:11], s27 offen offset:1024 lds
    s_waitcnt vmcnt(8)
    s_mov_b32 s42, 0
    s_mov_b32 s43, 14336
    s_lshl_b32 s7, s12, 2
    s_add_u32 s7, s7, 92999680
    s_lshl_b32 s27, s12, 3
    s_add_u32 s27, s27, 93001728
    v_and_b32 v121, 1, v1
    v_lshlrev_b32 v121, 2, v121
    s_mov_b32 s60, 0
K3_UWP2:
    buffer_load_dword v120, v121, s[8:11], s27 offen sc1
    s_add_u32 s60, s60, 1
    s_waitcnt vmcnt(0)
    v_cmp_eq_u32 vcc, 0, v120
    s_cbranch_vccz K3_UWP2_ok
    s_sleep 4
    s_cmp_lt_u32 s60, 32768
    s_cbranch_scc1 K3_UWP2
K3_UWP2_ok:
    s_add_u32 s28, s36, 0
    s_add_u32 m0, s42, 46592
    s_nop 0
    buffer_load_dwordx4 v2, s[8:11], s28 offen offset:0 sc1 lds
    buffer_load_dwordx4 v2, s[8:11], s28 offen offset:1024 sc1 lds
    buffer_load_dwordx4 v2, s[8:11], s28 offen offset:2048 sc1 lds
    buffer_load_dwordx4 v2, s[8:11], s28 offen offset:3072 sc1 lds
    s_add_u32 s28, s36, 4096
    s_add_u32 m0, s42, 50688
    s_nop 0
    buffer_load_dwordx4 v2, s[8:11], s28 offen offset:0 sc1 lds
    buffer_load_dwordx4 v2, s[8:11], s28 offen offset:1024 sc1 lds
    buffer_load_dwordx4 v2, s[8:11], s28 offen offset:2048 sc1 lds
    s_add_u32 s36, s36, 458752
    s_add_u32 s37, s37, 28672
    v_add_u32 v143, 103936, v2
    v_add_u32 v139, 132608, v141
    s_lshl_b32 s6, s12, 2
    s_add_u32 s6, s6, 94174720
    s_mov_b32 s53, 92995584
    s_lshl_b32 s55, s12, 2
    s_add_u32 s55, s55, 92995584
    v_mov_b32 v70, 0
    v_mov_b32 v71, 0
    v_mov_b32 v78, 0
    v_mov_b32 v79, 0
    v_mov_b32 v86, 0
    v_mov_b32 v87, 0
    v_mov_b32 v94, 0
    v_mov_b32 v95, 0
    v_mov_b32 v64, 0
    v_mov_b32 v65, 0
    v_mov_b32 v66, 0
    v_mov_b32 v67, 0
    v_mov_b32 v68, 0
    v_mov_b32 v69, 0
    v_mov_b32 v70, 0
    v_mov_b32 v71, 0
    v_mov_b32 v72, 0
    v_mov_b32 v73, 0
    v_mov_b32 v74, 0
    v_mov_b32 v75, 0
    v_mov_b32 v76, 0
    v_mov_b32 v77, 0
    v_mov_b32 v78, 0
    v_mov_b32 v79, 0
    v_mov_b32 v80, 0
    v_mov_b32 v81, 0
    v_mov_b32 v82, 0
    v_mov_b32 v83, 0
    v_mov_b32 v84, 0
    v_mov_b32 v85, 0
    v_mov_b32 v86, 0
    v_mov_b32 v87, 0
    v_mov_b32 v88, 0
    v_mov_b32 v89, 0
    v_mov_b32 v90, 0
    v_mov_b32 v91, 0
    s_and_b32 s44, s15, 3
    s_lshl_b32 s45, s44, 16
    s_mul_i32 s46, s44, 114688
    s_add_u32 s47, s31, s45
    s_add_u32 s48, s32, s45
    s_add_u32 s49, s33, s46
    s_add_u32 s50, s34, s46
    s_add_u32 s52, s50, 4096
    s_add_u32 s51, s30, 4096
    s_add_u32 s54, s15, 1
    s_add_u32 s59, s15, 3
    s_and_b32 s59, s59, 3
    s_mul_i32 s59, s59, 114688
    s_add_u32 s59, s59, s34
    v_add_u32 v130, s42, v2
    v_mov_b32 v32, 0
    v_mov_b32 v33, 0
    v_mov_b32 v34, 0
    v_mov_b32 v35, 0
    v_mov_b32 v36, 0
    v_mov_b32 v37, 0
    v_mov_b32 v38, 0
    v_mov_b32 v39, 0
    v_mov_b32 v40, 0
    v_mov_b32 v41, 0
    v_mov_b32 v42, 0
    v_mov_b32 v43, 0
    v_mov_b32 v44, 0
    v_mov_b32 v45, 0
    v_mov_b32 v46, 0
    v_mov_b32 v47, 0
    v_mov_b32 v48, 0
    v_mov_b32 v49, 0
    v_mov_b32 v50, 0
    v_mov_b32 v51, 0
    v_mov_b32 v52, 0
    v_mov_b32 v53, 0
    v_mov_b32 v54, 0
    v_mov_b32 v55, 0
    v_mov_b32 v56, 0
    v_mov_b32 v57, 0
    v_mov_b32 v58, 0
    v_mov_b32 v59, 0
    v_mov_b32 v60, 0
    v_mov_b32 v61, 0
    v_mov_b32 v62, 0
    v_mov_b32 v63, 0
    s_waitcnt vmcnt(0) lgkmcnt(0)
    v_mov_b32 v122, 0
    v_mov_b32 v123, 64
    s_mov_b32 s60, 0
K3_MODE2:
    buffer_load_dword v121, v123, s[16:19], 0 offen sc1
    s_waitcnt vmcnt(0)
    buffer_load_dword v120, v122, s[16:19], 0 offen sc1
    s_add_u32 s60, s60, 1
    s_waitcnt vmcnt(0)
    v_readfirstlane_b32 s27, v120
    v_readfirstlane_b32 s28, v121
    s_nop 3
    s_cmp_ge_u32 s27, 32
    s_cbranch_scc1 K3_FAST2
    s_cmp_ge_u32 s28, 256
    s_cbranch_scc1 K3_SLOW2
    s_sleep 2
    s_cmp_lt_u32 s60, 32768
    s_cbranch_scc1 K3_MODE2
    s_branch K3_SLOW2
K3_FAST2:
K3_LOOPF2:
    s_barrier
    s_mov_b32 s60, 0
K3_PMF2:
    buffer_load_dwordx4 v[12:15], v2, s[8:11], s30 offen offset:2048 sc1
    buffer_load_dwordx4 v[28:31], v2, s[8:11], s51 offen offset:2048 sc1
    s_add_u32 s60, s60, 1
    s_waitcnt vmcnt(0)
    v_max3_u32 v120, v12, v13, v14
    v_max_u32 v120, v120, v15
    v_max3_u32 v121, v28, v29, v30
    v_max_u32 v121, v121, v31
    v_max_u32 v120, v120, v121
    v_cmp_eq_u32 vcc, s21, v120
    s_cbranch_vccz K3_PMF2_ok
    s_cmp_lt_u32 s60, 32768
    s_cbranch_scc1 K3_PMF2
K3_PMF2_ok:
    ds_write_b128 v2, v[12:15] offset:2048
    ds_write_b128 v2, v[28:31] offset:6144
    v_smfmac_f32_16x16x64_bf16 v[32:35], v[12:15], a[16:23], v3
    v_smfmac_f32_16x16x64_bf16 v[36:39], v[12:15], a[72:79], v3
    v_smfmac_f32_16x16x64_bf16 v[40:43], v[12:15], a[128:135], v3
    s_waitcnt lgkmcnt(0)
    s_barrier
    v_lshlrev_b32 v128, 2, v1
    v_add_u32 v128, 135680, v128
    ds_read_b32 v129, v128
    ds_read_b128 v[4:7], v2 offset:0
    ds_read_b128 v[8:11], v2 offset:1024
    ds_read_b128 v[16:19], v2 offset:3072
    ds_read_b128 v[20:23], v2 offset:4096
    ds_read_b128 v[24:27], v2 offset:5120
    s_add_u32 s27, s30, 16384
    buffer_load_dword v131, v142, s[8:11], s27 offen
    s_add_u32 s28, s36, 0
    s_add_u32 m0, s43, 46592
    s_nop 0
    buffer_load_dwordx4 v2, s[8:11], s28 offen offset:0 sc1 lds
    buffer_load_dwordx4 v2, s[8:11], s28 offen offset:1024 sc1 lds
    buffer_load_dwordx4 v2, s[8:11], s28 offen offset:2048 sc1 lds
    s_cmp_ge_u32 s12, 28
    s_cbranch_scc1 L_noms_3
    s_cmp_eq_u32 s15, 0
    s_cbranch_scc1 L_noms_3
    s_add_u32 s27, s30, s38
    s_add_u32 s27, s27, 2359296
    s_waitcnt lgkmcnt(5)
    buffer_store_dword v129, v138, s[8:11], s27 offen sc1
L_noms_3:
    v_smfmac_f32_16x16x64_bf16 v[32:35], v[28:31], a[48:55], v3
    v_smfmac_f32_16x16x64_bf16 v[36:39], v[28:31], a[104:111], v3
    buffer_load_dwordx4 v2, s[8:11], s28 offen offset:3072 sc1 lds
    v_smfmac_f32_16x16x64_bf16 v[40:43], v[28:31], a[160:167], v3
    s_waitcnt lgkmcnt(4)
    v_smfmac_f32_16x16x64_bf16 v[32:35], v[4:7], a[0:7], v3
    s_add_u32 s28, s36, 4096
    s_add_u32 m0, s43, 50688
    s_nop 0
    buffer_load_dwordx4 v2, s[8:11], s28 offen offset:0 sc1 lds
    v_smfmac_f32_16x16x64_bf16 v[36:39], v[4:7], a[56:63], v3
    v_smfmac_f32_16x16x64_bf16 v[40:43], v[4:7], a[112:119], v3
    buffer_load_dwordx4 v2, s[8:11], s28 offen offset:1024 sc1 lds
    s_waitcnt lgkmcnt(3)
    v_smfmac_f32_16x16x64_bf16 v[32:35], v[8:11], a[8:15], v3
    v_smfmac_f32_16x16x64_bf16 v[36:39], v[8:11], a[64:71], v3
    buffer_load_dwordx4 v2, s[8:11], s28 offen offset:2048 sc1 lds
    v_smfmac_f32_16x16x64_bf16 v[40:43], v[8:11], a[120:127], v3
    s_waitcnt lgkmcnt(2)
    v_smfmac_f32_16x16x64_bf16 v[32:35], v[16:19], a[24:31], v3
    v_smfmac_f32_16x16x64_bf16 v[36:39], v[16:19], a[80:87], v3
    v_smfmac_f32_16x16x64_bf16 v[40:43], v[16:19], a[136:143], v3
    s_waitcnt lgkmcnt(1)
    s_waitcnt lgkmcnt(0)
    v_smfmac_f32_16x16x64_bf16 v[32:35], v[20:23], a[32:39], v3
    v_smfmac_f32_16x16x64_bf16 v[32:35], v[24:27], a[40:47], v3
    v_smfmac_f32_16x16x64_bf16 v[36:39], v[20:23], a[88:95], v3
    v_smfmac_f32_16x16x64_bf16 v[36:39], v[24:27], a[96:103], v3
    v_smfmac_f32_16x16x64_bf16 v[40:43], v[20:23], a[144:151], v3
    v_cvt_pk_bf16_f32 v100, v32, v33
    v_cvt_pk_bf16_f32 v101, v34, v35
    ds_write_b64 v132, v[100:101] offset:1024
    v_smfmac_f32_16x16x64_bf16 v[40:43], v[24:27], a[152:159], v3
    v_cvt_pk_bf16_f32 v102, v36, v37
    v_cvt_pk_bf16_f32 v103, v38, v39
    ds_write_b64 v132, v[102:103] offset:3072
    s_nop 4
    v_cvt_pk_bf16_f32 v104, v40, v41
    v_cvt_pk_bf16_f32 v105, v42, v43
    ds_write_b64 v132, v[104:105] offset:5120
    s_waitcnt lgkmcnt(0)
    s_barrier
    ds_read_b64_tr_b16 v[100:101], v133 offset:0
    ds_read_b64_tr_b16 v[102:103], v133 offset:512
    ds_read_b128 v[64:67], v130 offset:25088
    ds_read_b64_tr_b16 v[104:105], v133 offset:1024
    ds_read_b64_tr_b16 v[106:107], v133 offset:1536
    ds_read_b128 v[68:71], v130 offset:26112
    ds_read_b64_tr_b16 v[108:109], v133 offset:2048
    ds_read_b64_tr_b16 v[110:111], v133 offset:2560
    ds_read_b128 v[72:75], v130 offset:27136
    v_smfmac_f32_16x16x64_bf16 v[48:51], v[4:7], a[168:175], v3
    v_smfmac_f32_16x16x64_bf16 v[48:51], v[8:11], a[176:183], v3
    v_smfmac_f32_16x16x64_bf16 v[48:51], v[12:15], a[184:191], v3
    v_smfmac_f32_16x16x64_bf16 v[48:51], v[16:19], a[192:199], v3
    v_smfmac_f32_16x16x64_bf16 v[48:51], v[20:23], a[200:207], v3
    v_smfmac_f32_16x16x64_bf16 v[48:51], v[24:27], a[208:215], v3
    s_waitcnt lgkmcnt(6)
    ds_read_b64_tr_b16 v[112:113], v133 offset:3072
    ds_read_b64_tr_b16 v[114:115], v133 offset:3584
    ds_read_b128 v[76:79], v130 offset:28160
    v_mfma_f32_16x16x32_bf16 v[116:119], v[64:67], v[100:103], 0
    s_waitcnt lgkmcnt(6)
    ds_read_b64_tr_b16 v[100:101], v133 offset:4096
    ds_read_b64_tr_b16 v[102:103], v133 offset:4608
    ds_read_b128 v[80:83], v130 offset:29184
    v_mfma_f32_16x16x32_bf16 v[116:119], v[68:71], v[104:107], v[116:119]
    s_waitcnt lgkmcnt(6)
    ds_read_b64_tr_b16 v[104:105], v133 offset:5120
    ds_read_b64_tr_b16 v[106:107], v133 offset:5632
    ds_read_b128 v[84:87], v130 offset:30208
    v_mfma_f32_16x16x32_bf16 v[116:119], v[72:75], v[108:111], v[116:119]
    s_waitcnt lgkmcnt(6)
    ds_read_b64_tr_b16 v[108:109], v133 offset:6144
    ds_read_b64_tr_b16 v[110:111], v133 offset:6656
    ds_read_b128 v[88:91], v130 offset:31232
    v_mfma_f32_16x16x32_bf16 v[116:119], v[76:79], v[112:115], v[116:119]
    s_waitcnt lgkmcnt(6)
    v_mfma_f32_16x16x32_bf16 v[116:119], v[80:83], v[100:103], v[116:119]
    s_waitcnt lgkmcnt(3)
    v_mfma_f32_16x16x32_bf16 v[116:119], v[84:87], v[104:107], v[116:119]
    s_waitcnt lgkmcnt(0)
    v_mfma_f32_16x16x32_bf16 v[116:119], v[88:91], v[108:111], v[116:119]
    v_smfmac_f32_16x16x64_bf16 v[48:51], v[28:31], a[216:223], v3
    v_smfmac_f32_16x16x64_bf16 v[52:55], v[4:7], v[144:151], v3
    s_nop 1
    v_add_f32_dpp v116, v116, v116 row_ror:8 row_mask:0xf bank_mask:0xf
    v_add_f32_dpp v117, v117, v117 row_ror:8 row_mask:0xf bank_mask:0xf
    v_add_f32_dpp v118, v118, v118 row_ror:8 row_mask:0xf bank_mask:0xf
    v_add_f32_dpp v119, v119, v119 row_ror:8 row_mask:0xf bank_mask:0xf
    s_mov_b64 exec, s[22:23]
    buffer_store_dwordx4 v[116:119], v134, s[8:11], s48 offen offset:512
    ds_write_b128 v134, v[116:119] offset:14848
    s_mov_b64 exec, -1
    s_waitcnt lgkmcnt(0)
    s_barrier
    ds_read_b128 v[64:67], v130 offset:48640
    ds_read_b128 v[72:75], v130 offset:52736
    ds_read_b128 v[80:83], v130 offset:56832
    ds_read_b128 v[88:91], v130 offset:58880
    v_mov_b32 v124, s21
    v_mov_b32 v125, s21
    v_mov_b32 v126, s21
    v_mov_b32 v127, s21
    s_add_u32 s27, s59, 0
    s_mov_b32 s28, 0
    s_cmp_ge_u32 s12, 28
    s_cselect_b32 s28, 1, s28
    s_cmp_eq_u32 s15, 0
    s_cselect_b32 s28, 1, s28
    v_smfmac_f32_16x16x64_bf16 v[52:55], v[8:11], v[152:159], v3
    v_smfmac_f32_16x16x64_bf16 v[52:55], v[12:15], v[160:167], v3
    v_smfmac_f32_16x16x64_bf16 v[52:55], v[16:19], v[168:175], v3
    v_smfmac_f32_16x16x64_bf16 v[52:55], v[20:23], v[176:183], v3
    s_cmp_eq_u32 s28, 0
    s_cbranch_scc0 L_nopo_4
    buffer_store_dwordx4 v[124:127], v2, s[8:11], s27 offen offset:0
    buffer_store_dwordx4 v[124:127], v2, s[8:11], s27 offen offset:1024
L_nopo_4:
    v_smfmac_f32_16x16x64_bf16 v[52:55], v[24:27], v[184:191], v3
    v_smfmac_f32_16x16x64_bf16 v[52:55], v[28:31], v[192:199], v3
    v_smfmac_f32_16x16x64_bf16 v[56:59], v[4:7], v[200:207], v3
    v_smfmac_f32_16x16x64_bf16 v[56:59], v[8:11], v[208:215], v3
    v_smfmac_f32_16x16x64_bf16 v[56:59], v[12:15], v[216:223], v3
    v_smfmac_f32_16x16x64_bf16 v[56:59], v[16:19], v[224:231], v3
    v_smfmac_f32_16x16x64_bf16 v[56:59], v[20:23], v[232:239], v3
    v_smfmac_f32_16x16x64_bf16 v[56:59], v[24:27], v[240:247], v3
    v_smfmac_f32_16x16x64_bf16 v[56:59], v[28:31], v[248:255], v3
    s_waitcnt lgkmcnt(0)
    ds_read_b128 a[224:227], v143 offset:0
    ds_read_b128 a[228:231], v143 offset:1024
    ds_read_b128 a[232:235], v143 offset:2048
    ds_read_b128 a[236:239], v143 offset:3072
    ds_read_b128 a[240:243], v143 offset:4096
    ds_read_b128 a[244:247], v143 offset:5120
    ds_read_b128 a[248:251], v143 offset:6144
    ds_read_b128 a[252:255], v143 offset:7168
    v_mov_b32 v32, 0
    v_mov_b32 v33, 0
    v_mov_b32 v34, 0
    v_mov_b32 v35, 0
    v_mov_b32 v36, 0
    v_mov_b32 v37, 0
    v_mov_b32 v38, 0
    v_mov_b32 v39, 0
    v_mov_b32 v40, 0
    v_mov_b32 v41, 0
    v_mov_b32 v42, 0
    v_mov_b32 v43, 0
    v_mov_b32 v44, 0
    v_mov_b32 v45, 0
    v_mov_b32 v46, 0
    v_mov_b32 v47, 0
    s_waitcnt lgkmcnt(6)
    v_smfmac_f32_16x16x64_bf16 v[60:63], v[4:7], a[224:231], v3
    ds_read_b128 a[224:227], v143 offset:8192
    ds_read_b128 a[228:231], v143 offset:9216
    s_add_u32 s28, s37, 0
    s_add_u32 m0, s43, 17920
    s_nop 0
    buffer_load_dwordx4 v2, s[8:11], s28 offen offset:0 sc1 lds
    buffer_load_dwordx4 v2, s[8:11], s28 offen offset:1024 sc1 lds
    s_waitcnt lgkmcnt(6)
    v_smfmac_f32_16x16x64_bf16 v[60:63], v[8:11], a[232:239], v3
    ds_read_b128 a[232:235], v143 offset:10240
    ds_read_b128 a[236:239], v143 offset:11264
    buffer_load_dwordx4 v2, s[8:11], s28 offen offset:2048 sc1 lds
    buffer_load_dwordx4 v2, s[8:11], s28 offen offset:3072 sc1 lds
    s_waitcnt lgkmcnt(6)
    v_smfmac_f32_16x16x64_bf16 v[60:63], v[12:15], a[240:247], v3
    ds_read_b128 a[240:243], v143 offset:12288
    ds_read_b128 a[244:247], v143 offset:13312
    s_add_u32 s28, s37, 4096
    s_add_u32 m0, s43, 22016
    s_nop 0
    buffer_load_dwordx4 v2, s[8:11], s28 offen offset:0 sc1 lds
    buffer_load_dwordx4 v2, s[8:11], s28 offen offset:1024 sc1 lds
    s_waitcnt lgkmcnt(6)
    v_smfmac_f32_16x16x64_bf16 v[60:63], v[16:19], a[248:255], v3
    buffer_load_dwordx4 v2, s[8:11], s28 offen offset:2048 sc1 lds
    s_add_u32 s28, s37, 14336
    s_add_u32 m0, s43, 25088
    s_nop 0
    buffer_load_dwordx4 v2, s[8:11], s28 offen offset:0 sc1 lds
    s_waitcnt lgkmcnt(4)
    v_smfmac_f32_16x16x64_bf16 v[60:63], v[20:23], a[224:231], v3
    buffer_load_dwordx4 v2, s[8:11], s28 offen offset:1024 sc1 lds
    buffer_load_dwordx4 v2, s[8:11], s28 offen offset:2048 sc1 lds
    s_waitcnt lgkmcnt(2)
    v_smfmac_f32_16x16x64_bf16 v[60:63], v[24:27], a[232:239], v3
    buffer_load_dwordx4 v2, s[8:11], s28 offen offset:3072 sc1 lds
    s_add_u32 s28, s37, 18432
    s_add_u32 m0, s43, 29184
    s_nop 0
    buffer_load_dwordx4 v2, s[8:11], s28 offen offset:0 sc1 lds
    s_waitcnt lgkmcnt(0)
    v_smfmac_f32_16x16x64_bf16 v[60:63], v[28:31], a[240:247], v3
    buffer_load_dwordx4 v2, s[8:11], s28 offen offset:1024 sc1 lds
    buffer_load_dwordx4 v2, s[8:11], s28 offen offset:2048 sc1 lds
    s_nop 7
    v_cvt_pk_bf16_f32 v68, v48, v49
    v_cvt_pk_bf16_f32 v69, v50, v51
    v_cvt_pk_bf16_f32 v76, v52, v53
    v_cvt_pk_bf16_f32 v77, v54, v55
    v_cvt_pk_bf16_f32 v84, v56, v57
    v_cvt_pk_bf16_f32 v85, v58, v59
    v_cvt_pk_bf16_f32 v92, v60, v61
    v_cvt_pk_bf16_f32 v93, v62, v63
    s_waitcnt lgkmcnt(0)
    s_barrier
    ds_read_b128 v[96:99], v137
    v_lshlrev_b32 v116, 2, v1
    s_waitcnt lgkmcnt(0)
    v_smfmac_f32_16x16x64_bf16 v[32:35], v[96:99], v[64:71], v3
    v_smfmac_f32_16x16x64_bf16 v[36:39], v[96:99], v[72:79], v3
    v_smfmac_f32_16x16x64_bf16 v[40:43], v[96:99], v[80:87], v3
    v_smfmac_f32_16x16x64_bf16 v[44:47], v[96:99], v[88:95], v3
    s_nop 1
    v_permlane32_swap_b32 v32, v33
    v_permlane32_swap_b32 v34, v35
    s_add_u32 s27, s49, 8192
    v_add_f32 v32, v32, v33
    v_add_f32 v33, v34, v35
    v_cvt_pk_bf16_f32 v32, v32, v33
    buffer_store_dword v32, v116, s[8:11], s27 offen
    v_permlane32_swap_b32 v36, v37
    v_permlane32_swap_b32 v38, v39
    s_add_u32 s27, s49, 24576
    v_add_f32 v36, v36, v37
    v_add_f32 v37, v38, v39
    v_cvt_pk_bf16_f32 v36, v36, v37
    buffer_store_dword v36, v116, s[8:11], s27 offen
    v_permlane32_swap_b32 v40, v41
    v_permlane32_swap_b32 v42, v43
    s_add_u32 s27, s49, 40960
    v_add_f32 v40, v40, v41
    v_add_f32 v41, v42, v43
    v_cvt_pk_bf16_f32 v40, v40, v41
    buffer_store_dword v40, v116, s[8:11], s27 offen
    s_nop 3
    v_permlane32_swap_b32 v44, v45
    v_permlane32_swap_b32 v46, v47
    s_add_u32 s27, s49, 49152
    v_add_f32 v44, v44, v45
    v_add_f32 v45, v46, v47
    v_cvt_pk_bf16_f32 v44, v44, v45
    buffer_store_dword v44, v116, s[8:11], s27 offen
    s_add_u32 s30, s30, 8192
    s_add_u32 s35, s35, 229376
    s_add_u32 s6, s6, 256
    s_add_u32 s15, s15, 1
    s_cmp_lt_u32 s15, 63
    s_cselect_b32 s27, 458752, 0
    s_cselect_b32 s28, 28672, 0
    s_add_u32 s36, s36, s27
    s_add_u32 s37, s37, s28
    s_mov_b32 s27, s42
    s_mov_b32 s42, s43
    s_mov_b32 s43, s27
    s_and_b32 s44, s15, 3
    s_lshl_b32 s45, s44, 16
    s_mul_i32 s46, s44, 114688
    s_add_u32 s47, s31, s45
    s_add_u32 s48, s32, s45
    s_add_u32 s49, s33, s46
    s_add_u32 s50, s34, s46
    s_add_u32 s52, s50, 4096
    s_add_u32 s51, s30, 4096
    s_add_u32 s54, s15, 1
    s_add_u32 s59, s15, 3
    s_and_b32 s59, s59, 3
    s_mul_i32 s59, s59, 114688
    s_add_u32 s59, s59, s34
    v_add_u32 v130, s42, v2
    v_mov_b32 v32, 0
    v_mov_b32 v33, 0
    v_mov_b32 v34, 0
    v_mov_b32 v35, 0
    v_mov_b32 v36, 0
    v_mov_b32 v37, 0
    v_mov_b32 v38, 0
    v_mov_b32 v39, 0
    v_mov_b32 v40, 0
    v_mov_b32 v41, 0
    v_mov_b32 v42, 0
    v_mov_b32 v43, 0
    v_mov_b32 v44, 0
    v_mov_b32 v45, 0
    v_mov_b32 v46, 0
    v_mov_b32 v47, 0
    v_mov_b32 v48, 0
    v_mov_b32 v49, 0
    v_mov_b32 v50, 0
    v_mov_b32 v51, 0
    v_mov_b32 v52, 0
    v_mov_b32 v53, 0
    v_mov_b32 v54, 0
    v_mov_b32 v55, 0
    v_mov_b32 v56, 0
    v_mov_b32 v57, 0
    v_mov_b32 v58, 0
    v_mov_b32 v59, 0
    v_mov_b32 v60, 0
    v_mov_b32 v61, 0
    v_mov_b32 v62, 0
    v_mov_b32 v63, 0
    s_add_u32 s27, s15, 1
    s_and_b32 s27, s27, 7
    s_cmp_eq_u32 s27, 0
    s_cbranch_scc0 L_nouw_5
    s_cmp_lt_u32 s15, 63
    s_cbranch_scc0 L_nouw_5
    s_add_u32 s7, s7, 128
    v_mov_b32 v121, 0
    s_mov_b32 s60, 0
K3_UWFL:
    buffer_load_dword v120, v121, s[8:11], s7 offen sc1
    s_add_u32 s60, s60, 1
    s_waitcnt vmcnt(0)
    v_cmp_ne_u32 vcc, 0, v120
    s_cbranch_vccnz K3_UWFL_ok
    s_sleep 4
    s_cmp_lt_u32 s60, 32768
    s_cbranch_scc1 K3_UWFL
K3_UWFL_ok:
L_nouw_5:
    s_cmp_lt_u32 s15, 64
    s_cbranch_scc1 K3_LOOPF2
    s_waitcnt vmcnt(0) lgkmcnt(0)
    s_endpgm
K3_SLOW2:
    s_barrier
    s_mov_b32 s27, 93007872
    v_and_b32 v121, 31, v1
    v_lshlrev_b32 v121, 2, v121
    s_mov_b32 s60, 0
K3_RV2:
    buffer_load_dword v120, v121, s[8:11], s27 offen sc1
    s_add_u32 s60, s60, 1
    s_waitcnt vmcnt(0)
    v_cmp_eq_u32 vcc, 0, v120
    s_cbranch_vccz K3_RV2_ok
    s_sleep 8
    s_cmp_lt_u32 s60, 32768
    s_cbranch_scc1 K3_RV2
K3_RV2_ok:
K3_LOOPS2:
    s_barrier
    s_mov_b32 s60, 0
K3_PMS2:
    buffer_load_dwordx4 v[12:15], v2, s[8:11], s30 offen offset:2048 sc1
    buffer_load_dwordx4 v[28:31], v2, s[8:11], s51 offen offset:2048 sc1
    s_add_u32 s60, s60, 1
    s_waitcnt vmcnt(0)
    v_max3_u32 v120, v12, v13, v14
    v_max_u32 v120, v120, v15
    v_max3_u32 v121, v28, v29, v30
    v_max_u32 v121, v121, v31
    v_max_u32 v120, v120, v121
    v_cmp_eq_u32 vcc, s21, v120
    s_cbranch_vccz K3_PMS2_ok
    s_cmp_lt_u32 s60, 32768
    s_cbranch_scc1 K3_PMS2
K3_PMS2_ok:
    ds_write_b128 v2, v[12:15] offset:2048
    ds_write_b128 v2, v[28:31] offset:6144
    v_smfmac_f32_16x16x64_bf16 v[32:35], v[12:15], a[16:23], v3
    v_smfmac_f32_16x16x64_bf16 v[36:39], v[12:15], a[72:79], v3
    v_smfmac_f32_16x16x64_bf16 v[40:43], v[12:15], a[128:135], v3
    s_waitcnt lgkmcnt(0)
    s_barrier
    v_lshlrev_b32 v128, 2, v1
    v_add_u32 v128, 135680, v128
    ds_read_b32 v129, v128
    ds_read_b128 v[4:7], v2 offset:0
    ds_read_b128 v[8:11], v2 offset:1024
    ds_read_b128 v[16:19], v2 offset:3072
    ds_read_b128 v[20:23], v2 offset:4096
    ds_read_b128 v[24:27], v2 offset:5120
    s_add_u32 s28, s36, 0
    s_add_u32 m0, s43, 46592
    s_nop 0
    buffer_load_dwordx4 v2, s[8:11], s28 offen offset:0 sc1 lds
    buffer_load_dwordx4 v2, s[8:11], s28 offen offset:1024 sc1 lds
    buffer_load_dwordx4 v2, s[8:11], s28 offen offset:2048 sc1 lds
    buffer_load_dwordx4 v2, s[8:11], s28 offen offset:3072 sc1 lds
    s_cmp_ge_u32 s12, 28
    s_cbranch_scc1 L_noms_6
    s_cmp_eq_u32 s15, 0
    s_cbranch_scc1 L_noms_6
    s_add_u32 s27, s30, s38
    s_add_u32 s27, s27, 2359296
    s_waitcnt lgkmcnt(5)
    buffer_store_dword v129, v138, s[8:11], s27 offen sc1
L_noms_6:
    v_smfmac_f32_16x16x64_bf16 v[32:35], v[28:31], a[48:55], v3
    v_smfmac_f32_16x16x64_bf16 v[36:39], v[28:31], a[104:111], v3
    s_add_u32 s28, s36, 4096
    s_add_u32 m0, s43, 50688
    s_nop 0
    buffer_load_dwordx4 v2, s[8:11], s28 offen offset:0 sc1 lds
    v_smfmac_f32_16x16x64_bf16 v[40:43], v[28:31], a[160:167], v3
    s_waitcnt lgkmcnt(4)
    v_smfmac_f32_16x16x64_bf16 v[32:35], v[4:7], a[0:7], v3
    buffer_load_dwordx4 v2, s[8:11], s28 offen offset:1024 sc1 lds
    v_smfmac_f32_16x16x64_bf16 v[36:39], v[4:7], a[56:63], v3
    v_smfmac_f32_16x16x64_bf16 v[40:43], v[4:7], a[112:119], v3
    buffer_load_dwordx4 v2, s[8:11], s28 offen offset:2048 sc1 lds
    s_waitcnt lgkmcnt(3)
    v_smfmac_f32_16x16x64_bf16 v[32:35], v[8:11], a[8:15], v3
    v_smfmac_f32_16x16x64_bf16 v[36:39], v[8:11], a[64:71], v3
    v_smfmac_f32_16x16x64_bf16 v[40:43], v[8:11], a[120:127], v3
    s_waitcnt lgkmcnt(2)
    v_smfmac_f32_16x16x64_bf16 v[32:35], v[16:19], a[24:31], v3
    v_smfmac_f32_16x16x64_bf16 v[36:39], v[16:19], a[80:87], v3
    v_smfmac_f32_16x16x64_bf16 v[40:43], v[16:19], a[136:143], v3
    s_waitcnt lgkmcnt(1)
    s_waitcnt lgkmcnt(0)
    v_smfmac_f32_16x16x64_bf16 v[32:35], v[20:23], a[32:39], v3
    v_smfmac_f32_16x16x64_bf16 v[32:35], v[24:27], a[40:47], v3
    v_smfmac_f32_16x16x64_bf16 v[36:39], v[20:23], a[88:95], v3
    v_smfmac_f32_16x16x64_bf16 v[36:39], v[24:27], a[96:103], v3
    v_smfmac_f32_16x16x64_bf16 v[40:43], v[20:23], a[144:151], v3
    v_cvt_pk_bf16_f32 v100, v32, v33
    v_cvt_pk_bf16_f32 v101, v34, v35
    ds_write_b64 v132, v[100:101] offset:1024
    v_smfmac_f32_16x16x64_bf16 v[40:43], v[24:27], a[152:159], v3
    v_cvt_pk_bf16_f32 v102, v36, v37
    v_cvt_pk_bf16_f32 v103, v38, v39
    ds_write_b64 v132, v[102:103] offset:3072
    s_nop 4
    v_cvt_pk_bf16_f32 v104, v40, v41
    v_cvt_pk_bf16_f32 v105, v42, v43
    ds_write_b64 v132, v[104:105] offset:5120
    s_waitcnt lgkmcnt(0)
    s_barrier
    ds_read_b64_tr_b16 v[100:101], v133 offset:0
    ds_read_b64_tr_b16 v[102:103], v133 offset:512
    ds_read_b128 v[64:67], v130 offset:25088
    ds_read_b64_tr_b16 v[104:105], v133 offset:1024
    ds_read_b64_tr_b16 v[106:107], v133 offset:1536
    ds_read_b128 v[68:71], v130 offset:26112
    ds_read_b64_tr_b16 v[108:109], v133 offset:2048
    ds_read_b64_tr_b16 v[110:111], v133 offset:2560
    ds_read_b128 v[72:75], v130 offset:27136
    v_smfmac_f32_16x16x64_bf16 v[48:51], v[4:7], a[168:175], v3
    v_smfmac_f32_16x16x64_bf16 v[48:51], v[8:11], a[176:183], v3
    v_smfmac_f32_16x16x64_bf16 v[48:51], v[12:15], a[184:191], v3
    v_smfmac_f32_16x16x64_bf16 v[48:51], v[16:19], a[192:199], v3
    v_smfmac_f32_16x16x64_bf16 v[48:51], v[20:23], a[200:207], v3
    v_smfmac_f32_16x16x64_bf16 v[48:51], v[24:27], a[208:215], v3
    s_waitcnt lgkmcnt(6)
    ds_read_b64_tr_b16 v[112:113], v133 offset:3072
    ds_read_b64_tr_b16 v[114:115], v133 offset:3584
    ds_read_b128 v[76:79], v130 offset:28160
    v_mfma_f32_16x16x32_bf16 v[116:119], v[64:67], v[100:103], 0
    s_waitcnt lgkmcnt(6)
    ds_read_b64_tr_b16 v[100:101], v133 offset:4096
    ds_read_b64_tr_b16 v[102:103], v133 offset:4608
    ds_read_b128 v[80:83], v130 offset:29184
    v_mfma_f32_16x16x32_bf16 v[116:119], v[68:71], v[104:107], v[116:119]
    s_waitcnt lgkmcnt(6)
    ds_read_b64_tr_b16 v[104:105], v133 offset:5120
    ds_read_b64_tr_b16 v[106:107], v133 offset:5632
    ds_read_b128 v[84:87], v130 offset:30208
    v_mfma_f32_16x16x32_bf16 v[116:119], v[72:75], v[108:111], v[116:119]
    s_waitcnt lgkmcnt(6)
    ds_read_b64_tr_b16 v[108:109], v133 offset:6144
    ds_read_b64_tr_b16 v[110:111], v133 offset:6656
    ds_read_b128 v[88:91], v130 offset:31232
    v_mfma_f32_16x16x32_bf16 v[116:119], v[76:79], v[112:115], v[116:119]
    s_waitcnt lgkmcnt(6)
    v_mfma_f32_16x16x32_bf16 v[116:119], v[80:83], v[100:103], v[116:119]
    s_waitcnt lgkmcnt(3)
    v_mfma_f32_16x16x32_bf16 v[116:119], v[84:87], v[104:107], v[116:119]
    s_waitcnt lgkmcnt(0)
    v_mfma_f32_16x16x32_bf16 v[116:119], v[88:91], v[108:111], v[116:119]
    v_smfmac_f32_16x16x64_bf16 v[48:51], v[28:31], a[216:223], v3
    v_smfmac_f32_16x16x64_bf16 v[52:55], v[4:7], v[144:151], v3
    s_nop 1
    v_add_f32_dpp v116, v116, v116 row_ror:8 row_mask:0xf bank_mask:0xf
    v_add_f32_dpp v117, v117, v117 row_ror:8 row_mask:0xf bank_mask:0xf
    v_add_f32_dpp v118, v118, v118 row_ror:8 row_mask:0xf bank_mask:0xf
    v_add_f32_dpp v119, v119, v119 row_ror:8 row_mask:0xf bank_mask:0xf
    s_mov_b64 exec, s[22:23]
    buffer_store_dwordx4 v[116:119], v134, s[8:11], s48 offen offset:512 sc1
    ds_write_b128 v134, v[116:119] offset:14848
    s_mov_b64 exec, -1
    s_waitcnt lgkmcnt(0)
    s_barrier
    ds_read_b128 v[64:67], v130 offset:48640
    ds_read_b128 v[72:75], v130 offset:52736
    ds_read_b128 v[80:83], v130 offset:56832
    ds_read_b128 v[88:91], v130 offset:58880
    v_mov_b32 v124, s21
    v_mov_b32 v125, s21
    v_mov_b32 v126, s21
    v_mov_b32 v127, s21
    s_add_u32 s27, s59, 0
    s_mov_b32 s28, 0
    s_cmp_ge_u32 s12, 28
    s_cselect_b32 s28, 1, s28
    s_cmp_eq_u32 s15, 0
    s_cselect_b32 s28, 1, s28
    v_smfmac_f32_16x16x64_bf16 v[52:55], v[8:11], v[152:159], v3
    v_smfmac_f32_16x16x64_bf16 v[52:55], v[12:15], v[160:167], v3
    v_smfmac_f32_16x16x64_bf16 v[52:55], v[16:19], v[168:175], v3
    v_smfmac_f32_16x16x64_bf16 v[52:55], v[20:23], v[176:183], v3
    s_cmp_eq_u32 s28, 0
    s_cbranch_scc0 L_nopo_7
    buffer_store_dwordx4 v[124:127], v2, s[8:11], s27 offen offset:0 sc1
    buffer_store_dwordx4 v[124:127], v2, s[8:11], s27 offen offset:1024 sc1
L_nopo_7:
    v_smfmac_f32_16x16x64_bf16 v[52:55], v[24:27], v[184:191], v3
    v_smfmac_f32_16x16x64_bf16 v[52:55], v[28:31], v[192:199], v3
    v_smfmac_f32_16x16x64_bf16 v[56:59], v[4:7], v[200:207], v3
    v_smfmac_f32_16x16x64_bf16 v[56:59], v[8:11], v[208:215], v3
    v_smfmac_f32_16x16x64_bf16 v[56:59], v[12:15], v[216:223], v3
    v_smfmac_f32_16x16x64_bf16 v[56:59], v[16:19], v[224:231], v3
    v_smfmac_f32_16x16x64_bf16 v[56:59], v[20:23], v[232:239], v3
    v_smfmac_f32_16x16x64_bf16 v[56:59], v[24:27], v[240:247], v3
    v_smfmac_f32_16x16x64_bf16 v[56:59], v[28:31], v[248:255], v3
    s_waitcnt lgkmcnt(0)
    ds_read_b128 a[224:227], v143 offset:0
    ds_read_b128 a[228:231], v143 offset:1024
    ds_read_b128 a[232:235], v143 offset:2048
    ds_read_b128 a[236:239], v143 offset:3072
    ds_read_b128 a[240:243], v143 offset:4096
    ds_read_b128 a[244:247], v143 offset:5120
    ds_read_b128 a[248:251], v143 offset:6144
    ds_read_b128 a[252:255], v143 offset:7168
    v_mov_b32 v32, 0
    v_mov_b32 v33, 0
    v_mov_b32 v34, 0
    v_mov_b32 v35, 0
    v_mov_b32 v36, 0
    v_mov_b32 v37, 0
    v_mov_b32 v38, 0
    v_mov_b32 v39, 0
    v_mov_b32 v40, 0
    v_mov_b32 v41, 0
    v_mov_b32 v42, 0
    v_mov_b32 v43, 0
    v_mov_b32 v44, 0
    v_mov_b32 v45, 0
    v_mov_b32 v46, 0
    v_mov_b32 v47, 0
    s_waitcnt lgkmcnt(6)
    v_smfmac_f32_16x16x64_bf16 v[60:63], v[4:7], a[224:231], v3
    ds_read_b128 a[224:227], v143 offset:8192
    ds_read_b128 a[228:231], v143 offset:9216
    s_add_u32 s28, s37, 0
    s_add_u32 m0, s43, 17920
    s_nop 0
    buffer_load_dwordx4 v2, s[8:11], s28 offen offset:0 sc1 lds
    buffer_load_dwordx4 v2, s[8:11], s28 offen offset:1024 sc1 lds
    s_waitcnt lgkmcnt(6)
    v_smfmac_f32_16x16x64_bf16 v[60:63], v[8:11], a[232:239], v3
    ds_read_b128 a[232:235], v143 offset:10240
    ds_read_b128 a[236:239], v143 offset:11264
    buffer_load_dwordx4 v2, s[8:11], s28 offen offset:2048 sc1 lds
    buffer_load_dwordx4 v2, s[8:11], s28 offen offset:3072 sc1 lds
    s_waitcnt lgkmcnt(6)
    v_smfmac_f32_16x16x64_bf16 v[60:63], v[12:15], a[240:247], v3
    ds_read_b128 a[240:243], v143 offset:12288
    ds_read_b128 a[244:247], v143 offset:13312
    s_add_u32 s28, s37, 4096
    s_add_u32 m0, s43, 22016
    s_nop 0
    buffer_load_dwordx4 v2, s[8:11], s28 offen offset:0 sc1 lds
    buffer_load_dwordx4 v2, s[8:11], s28 offen offset:1024 sc1 lds
    s_waitcnt lgkmcnt(6)
    v_smfmac_f32_16x16x64_bf16 v[60:63], v[16:19], a[248:255], v3
    buffer_load_dwordx4 v2, s[8:11], s28 offen offset:2048 sc1 lds
    s_add_u32 s28, s37, 14336
    s_add_u32 m0, s43, 25088
    s_nop 0
    buffer_load_dwordx4 v2, s[8:11], s28 offen offset:0 sc1 lds
    s_waitcnt lgkmcnt(4)
    v_smfmac_f32_16x16x64_bf16 v[60:63], v[20:23], a[224:231], v3
    buffer_load_dwordx4 v2, s[8:11], s28 offen offset:1024 sc1 lds
    buffer_load_dwordx4 v2, s[8:11], s28 offen offset:2048 sc1 lds
    s_waitcnt lgkmcnt(2)
    v_smfmac_f32_16x16x64_bf16 v[60:63], v[24:27], a[232:239], v3
    buffer_load_dwordx4 v2, s[8:11], s28 offen offset:3072 sc1 lds
    s_add_u32 s28, s37, 18432
    s_add_u32 m0, s43, 29184
    s_nop 0
    buffer_load_dwordx4 v2, s[8:11], s28 offen offset:0 sc1 lds
    s_waitcnt lgkmcnt(0)
    v_smfmac_f32_16x16x64_bf16 v[60:63], v[28:31], a[240:247], v3
    buffer_load_dwordx4 v2, s[8:11], s28 offen offset:1024 sc1 lds
    buffer_load_dwordx4 v2, s[8:11], s28 offen offset:2048 sc1 lds
    s_nop 7
    v_cvt_pk_bf16_f32 v68, v48, v49
    v_cvt_pk_bf16_f32 v69, v50, v51
    v_cvt_pk_bf16_f32 v76, v52, v53
    v_cvt_pk_bf16_f32 v77, v54, v55
    v_cvt_pk_bf16_f32 v84, v56, v57
    v_cvt_pk_bf16_f32 v85, v58, v59
    v_cvt_pk_bf16_f32 v92, v60, v61
    v_cvt_pk_bf16_f32 v93, v62, v63
    s_waitcnt lgkmcnt(0)
    s_barrier
    ds_read_b128 v[96:99], v137
    v_lshlrev_b32 v116, 2, v1
    s_waitcnt lgkmcnt(0)
    v_smfmac_f32_16x16x64_bf16 v[32:35], v[96:99], v[64:71], v3
    v_smfmac_f32_16x16x64_bf16 v[36:39], v[96:99], v[72:79], v3
    v_smfmac_f32_16x16x64_bf16 v[40:43], v[96:99], v[80:87], v3
    v_smfmac_f32_16x16x64_bf16 v[44:47], v[96:99], v[88:95], v3
    s_nop 1
    v_permlane32_swap_b32 v32, v33
    v_permlane32_swap_b32 v34, v35
    s_add_u32 s27, s49, 8192
    v_add_f32 v32, v32, v33
    v_add_f32 v33, v34, v35
    v_cvt_pk_bf16_f32 v32, v32, v33
    buffer_store_dword v32, v116, s[8:11], s27 offen sc1
    v_permlane32_swap_b32 v36, v37
    v_permlane32_swap_b32 v38, v39
    s_add_u32 s27, s49, 24576
    v_add_f32 v36, v36, v37
    v_add_f32 v37, v38, v39
    v_cvt_pk_bf16_f32 v36, v36, v37
    buffer_store_dword v36, v116, s[8:11], s27 offen sc1
    v_permlane32_swap_b32 v40, v41
    v_permlane32_swap_b32 v42, v43
    s_add_u32 s27, s49, 40960
    v_add_f32 v40, v40, v41
    v_add_f32 v41, v42, v43
    v_cvt_pk_bf16_f32 v40, v40, v41
    buffer_store_dword v40, v116, s[8:11], s27 offen sc1
    s_nop 3
    v_permlane32_swap_b32 v44, v45
    v_permlane32_swap_b32 v46, v47
    s_add_u32 s27, s49, 49152
    v_add_f32 v44, v44, v45
    v_add_f32 v45, v46, v47
    v_cvt_pk_bf16_f32 v44, v44, v45
    buffer_store_dword v44, v116, s[8:11], s27 offen sc1
    s_add_u32 s30, s30, 8192
    s_add_u32 s35, s35, 229376
    s_add_u32 s6, s6, 256
    s_add_u32 s15, s15, 1
    s_cmp_lt_u32 s15, 63
    s_cselect_b32 s27, 458752, 0
    s_cselect_b32 s28, 28672, 0
    s_add_u32 s36, s36, s27
    s_add_u32 s37, s37, s28
    s_mov_b32 s27, s42
    s_mov_b32 s42, s43
    s_mov_b32 s43, s27
    s_and_b32 s44, s15, 3
    s_lshl_b32 s45, s44, 16
    s_mul_i32 s46, s44, 114688
    s_add_u32 s47, s31, s45
    s_add_u32 s48, s32, s45
    s_add_u32 s49, s33, s46
    s_add_u32 s50, s34, s46
    s_add_u32 s52, s50, 4096
    s_add_u32 s51, s30, 4096
    s_add_u32 s54, s15, 1
    s_add_u32 s59, s15, 3
    s_and_b32 s59, s59, 3
    s_mul_i32 s59, s59, 114688
    s_add_u32 s59, s59, s34
    v_add_u32 v130, s42, v2
    v_mov_b32 v32, 0
    v_mov_b32 v33, 0
    v_mov_b32 v34, 0
    v_mov_b32 v35, 0
    v_mov_b32 v36, 0
    v_mov_b32 v37, 0
    v_mov_b32 v38, 0
    v_mov_b32 v39, 0
    v_mov_b32 v40, 0
    v_mov_b32 v41, 0
    v_mov_b32 v42, 0
    v_mov_b32 v43, 0
    v_mov_b32 v44, 0
    v_mov_b32 v45, 0
    v_mov_b32 v46, 0
    v_mov_b32 v47, 0
    v_mov_b32 v48, 0
    v_mov_b32 v49, 0
    v_mov_b32 v50, 0
    v_mov_b32 v51, 0
    v_mov_b32 v52, 0
    v_mov_b32 v53, 0
    v_mov_b32 v54, 0
    v_mov_b32 v55, 0
    v_mov_b32 v56, 0
    v_mov_b32 v57, 0
    v_mov_b32 v58, 0
    v_mov_b32 v59, 0
    v_mov_b32 v60, 0
    v_mov_b32 v61, 0
    v_mov_b32 v62, 0
    v_mov_b32 v63, 0
    s_add_u32 s27, s15, 1
    s_and_b32 s27, s27, 7
    s_cmp_eq_u32 s27, 0
    s_cbranch_scc0 L_nouw_8
    s_cmp_lt_u32 s15, 63
    s_cbranch_scc0 L_nouw_8
    s_add_u32 s7, s7, 128
    v_mov_b32 v121, 0
    s_mov_b32 s60, 0
K3_UWSL:
    buffer_load_dword v120, v121, s[8:11], s7 offen sc1
    s_add_u32 s60, s60, 1
    s_waitcnt vmcnt(0)
    v_cmp_ne_u32 vcc, 0, v120
    s_cbranch_vccnz K3_UWSL_ok
    s_sleep 4
    s_cmp_lt_u32 s60, 32768
    s_cbranch_scc1 K3_UWSL
K3_UWSL_ok:
L_nouw_8:
    s_cmp_lt_u32 s15, 64
    s_cbranch_scc1 K3_LOOPS2
    s_waitcnt vmcnt(0) lgkmcnt(0)
    s_endpgm
K3_W3:
    s_add_u32 s27, s40, 43008
    buffer_load_dwordx4 a[0:3], v2, s[8:11], s27 offen offset:0
    buffer_load_dwordx4 a[4:7], v2, s[8:11], s27 offen offset:1024
    buffer_load_dwordx4 a[8:11], v2, s[8:11], s27 offen offset:2048
    buffer_load_dwordx4 a[12:15], v2, s[8:11], s27 offen offset:3072
    s_add_u32 s27, s40, 47104
    buffer_load_dwordx4 a[16:19], v2, s[8:11], s27 offen offset:0
    buffer_load_dwordx4 a[20:23], v2, s[8:11], s27 offen offset:1024
    buffer_load_dwordx4 a[24:27], v2, s[8:11], s27 offen offset:2048
    buffer_load_dwordx4 a[28:31], v2, s[8:11], s27 offen offset:3072
    s_add_u32 s27, s40, 51200
    buffer_load_dwordx4 a[32:35], v2, s[8:11], s27 offen offset:0
    buffer_load_dwordx4 a[36:39], v2, s[8:11], s27 offen offset:1024
    buffer_load_dwordx4 a[40:43], v2, s[8:11], s27 offen offset:2048
    buffer_load_dwordx4 a[44:47], v2, s[8:11], s27 offen offset:3072
    s_add_u32 s27, s40, 55296
    buffer_load_dwordx4 a[48:51], v2, s[8:11], s27 offen offset:0
    buffer_load_dwordx4 a[52:55], v2, s[8:11], s27 offen offset:1024
    s_add_u32 s27, s40, 100352
    buffer_load_dwordx4 a[56:59], v2, s[8:11], s27 offen offset:0
    buffer_load_dwordx4 a[60:63], v2, s[8:11], s27 offen offset:1024
    buffer_load_dwordx4 a[64:67], v2, s[8:11], s27 offen offset:2048
    buffer_load_dwordx4 a[68:71], v2, s[8:11], s27 offen offset:3072
    s_add_u32 s27, s40, 104448
    buffer_load_dwordx4 a[72:75], v2, s[8:11], s27 offen offset:0
    buffer_load_dwordx4 a[76:79], v2, s[8:11], s27 offen offset:1024
    buffer_load_dwordx4 a[80:83], v2, s[8:11], s27 offen offset:2048
    buffer_load_dwordx4 a[84:87], v2, s[8:11], s27 offen offset:3072
    s_add_u32 s27, s40, 108544
    buffer_load_dwordx4 a[88:91], v2, s[8:11], s27 offen offset:0
    buffer_load_dwordx4 a[92:95], v2, s[8:11], s27 offen offset:1024
    buffer_load_dwordx4 a[96:99], v2, s[8:11], s27 offen offset:2048
    buffer_load_dwordx4 a[100:103], v2, s[8:11], s27 offen offset:3072
    s_add_u32 s27, s40, 112640
    buffer_load_dwordx4 a[104:107], v2, s[8:11], s27 offen offset:0
    buffer_load_dwordx4 a[108:111], v2, s[8:11], s27 offen offset:1024
    s_add_u32 s27, s40, 157696
    buffer_load_dwordx4 a[112:115], v2, s[8:11], s27 offen offset:0
    buffer_load_dwordx4 a[116:119], v2, s[8:11], s27 offen offset:1024
    buffer_load_dwordx4 a[120:123], v2, s[8:11], s27 offen offset:2048
    buffer_load_dwordx4 a[124:127], v2, s[8:11], s27 offen offset:3072
    s_add_u32 s27, s40, 161792
    buffer_load_dwordx4 a[128:131], v2, s[8:11], s27 offen offset:0
    buffer_load_dwordx4 a[132:135], v2, s[8:11], s27 offen offset:1024
    buffer_load_dwordx4 a[136:139], v2, s[8:11], s27 offen offset:2048
    buffer_load_dwordx4 a[140:143], v2, s[8:11], s27 offen offset:3072
    s_add_u32 s27, s40, 165888
    buffer_load_dwordx4 a[144:147], v2, s[8:11], s27 offen offset:0
    buffer_load_dwordx4 a[148:151], v2, s[8:11], s27 offen offset:1024
    buffer_load_dwordx4 a[152:155], v2, s[8:11], s27 offen offset:2048
    buffer_load_dwordx4 a[156:159], v2, s[8:11], s27 offen offset:3072
    s_add_u32 s27, s40, 169984
    buffer_load_dwordx4 a[160:163], v2, s[8:11], s27 offen offset:0
    buffer_load_dwordx4 a[164:167], v2, s[8:11], s27 offen offset:1024
    s_add_u32 s27, s41, 43008
    buffer_load_dwordx4 a[168:171], v2, s[8:11], s27 offen offset:0
    buffer_load_dwordx4 a[172:175], v2, s[8:11], s27 offen offset:1024
    buffer_load_dwordx4 a[176:179], v2, s[8:11], s27 offen offset:2048
    buffer_load_dwordx4 a[180:183], v2, s[8:11], s27 offen offset:3072
    s_add_u32 s27, s41, 47104
    buffer_load_dwordx4 a[184:187], v2, s[8:11], s27 offen offset:0
    buffer_load_dwordx4 a[188:191], v2, s[8:11], s27 offen offset:1024
    buffer_load_dwordx4 a[192:195], v2, s[8:11], s27 offen offset:2048
    buffer_load_dwordx4 a[196:199], v2, s[8:11], s27 offen offset:3072
    s_add_u32 s27, s41, 51200
    buffer_load_dwordx4 a[200:203], v2, s[8:11], s27 offen offset:0
    buffer_load_dwordx4 a[204:207], v2, s[8:11], s27 offen offset:1024
    buffer_load_dwordx4 a[208:211], v2, s[8:11], s27 offen offset:2048
    buffer_load_dwordx4 a[212:215], v2, s[8:11], s27 offen offset:3072
    s_add_u32 s27, s41, 55296
    buffer_load_dwordx4 a[216:219], v2, s[8:11], s27 offen offset:0
    buffer_load_dwordx4 a[220:223], v2, s[8:11], s27 offen offset:1024
    s_waitcnt vmcnt(8)
    s_add_u32 s27, s41, 100352
    buffer_load_dwordx4 v[144:147], v2, s[8:11], s27 offen offset:0
    buffer_load_dwordx4 v[148:151], v2, s[8:11], s27 offen offset:1024
    buffer_load_dwordx4 v[152:155], v2, s[8:11], s27 offen offset:2048
    buffer_load_dwordx4 v[156:159], v2, s[8:11], s27 offen offset:3072
    s_add_u32 s27, s41, 104448
    buffer_load_dwordx4 v[160:163], v2, s[8:11], s27 offen offset:0
    buffer_load_dwordx4 v[164:167], v2, s[8:11], s27 offen offset:1024
    buffer_load_dwordx4 v[168:171], v2, s[8:11], s27 offen offset:2048
    buffer_load_dwordx4 v[172:175], v2, s[8:11], s27 offen offset:3072
    s_add_u32 s27, s41, 108544
    buffer_load_dwordx4 v[176:179], v2, s[8:11], s27 offen offset:0
    buffer_load_dwordx4 v[180:183], v2, s[8:11], s27 offen offset:1024
    buffer_load_dwordx4 v[184:187], v2, s[8:11], s27 offen offset:2048
    buffer_load_dwordx4 v[188:191], v2, s[8:11], s27 offen offset:3072
    s_add_u32 s27, s41, 112640
    buffer_load_dwordx4 v[192:195], v2, s[8:11], s27 offen offset:0
    buffer_load_dwordx4 v[196:199], v2, s[8:11], s27 offen offset:1024
    s_add_u32 s27, s41, 157696
    buffer_load_dwordx4 v[200:203], v2, s[8:11], s27 offen offset:0
    buffer_load_dwordx4 v[204:207], v2, s[8:11], s27 offen offset:1024
    buffer_load_dwordx4 v[208:211], v2, s[8:11], s27 offen offset:2048
    buffer_load_dwordx4 v[212:215], v2, s[8:11], s27 offen offset:3072
    s_add_u32 s27, s41, 161792
    buffer_load_dwordx4 v[216:219], v2, s[8:11], s27 offen offset:0
    buffer_load_dwordx4 v[220:223], v2, s[8:11], s27 offen offset:1024
    buffer_load_dwordx4 v[224:227], v2, s[8:11], s27 offen offset:2048
    buffer_load_dwordx4 v[228:231], v2, s[8:11], s27 offen offset:3072
    s_add_u32 s27, s41, 165888
    buffer_load_dwordx4 v[232:235], v2, s[8:11], s27 offen offset:0
    buffer_load_dwordx4 v[236:239], v2, s[8:11], s27 offen offset:1024
    buffer_load_dwordx4 v[240:243], v2, s[8:11], s27 offen offset:2048
    buffer_load_dwordx4 v[244:247], v2, s[8:11], s27 offen offset:3072
    s_add_u32 s27, s41, 169984
    buffer_load_dwordx4 v[248:251], v2, s[8:11], s27 offen offset:0
    buffer_load_dwordx4 v[252:255], v2, s[8:11], s27 offen offset:1024
    s_add_u32 s27, s41, 186368
    s_mov_b32 m0, 118272
    s_nop 0
    buffer_load_dwordx4 v2, s[8:11], s27 offen offset:0 lds
    buffer_load_dwordx4 v2, s[8:11], s27 offen offset:1024 lds
    buffer_load_dwordx4 v2, s[8:11], s27 offen offset:2048 lds
    buffer_load_dwordx4 v2, s[8:11], s27 offen offset:3072 lds
    s_add_u32 s27, s41, 190464
    s_mov_b32 m0, 122368
    s_nop 0
    buffer_load_dwordx4 v2, s[8:11], s27 offen offset:0 lds
    buffer_load_dwordx4 v2, s[8:11], s27 offen offset:1024 lds
    buffer_load_dwordx4 v2, s[8:11], s27 offen offset:2048 lds
    buffer_load_dwordx4 v2, s[8:11], s27 offen offset:3072 lds
    s_add_u32 s27, s41, 194560
    s_mov_b32 m0, 126464
    s_nop 0
    buffer_load_dwordx4 v2, s[8:11], s27 offen offset:0 lds
    buffer_load_dwordx4 v2, s[8:11], s27 offen offset:1024 lds
    buffer_load_dwordx4 v2, s[8:11], s27 offen offset:2048 lds
    buffer_load_dwordx4 v2, s[8:11], s27 offen offset:3072 lds
    s_add_u32 s27, s41, 198656
    s_mov_b32 m0, 130560
    s_nop 0
    buffer_load_dwordx4 v2, s[8:11], s27 offen offset:0 lds
    buffer_load_dwordx4 v2, s[8:11], s27 offen offset:1024 lds
    s_waitcnt vmcnt(8)
    s_mov_b32 s42, 0
    s_mov_b32 s43, 14336
    s_lshl_b32 s7, s12, 2
    s_add_u32 s7, s7, 92999680
    s_lshl_b32 s27, s12, 3
    s_add_u32 s27, s27, 93001728
    v_and_b32 v121, 1, v1
    v_lshlrev_b32 v121, 2, v121
    s_mov_b32 s60, 0
K3_UWP3:
    buffer_load_dword v120, v121, s[8:11], s27 offen sc1
    s_add_u32 s60, s60, 1
    s_waitcnt vmcnt(0)
    v_cmp_eq_u32 vcc, 0, v120
    s_cbranch_vccz K3_UWP3_ok
    s_sleep 4
    s_cmp_lt_u32 s60, 32768
    s_cbranch_scc1 K3_UWP3
K3_UWP3_ok:
    s_add_u32 s28, s36, 7168
    s_add_u32 m0, s42, 53760
    s_nop 0
    buffer_load_dwordx4 v2, s[8:11], s28 offen offset:0 sc1 lds
    buffer_load_dwordx4 v2, s[8:11], s28 offen offset:1024 sc1 lds
    buffer_load_dwordx4 v2, s[8:11], s28 offen offset:2048 sc1 lds
    buffer_load_dwordx4 v2, s[8:11], s28 offen offset:3072 sc1 lds
    s_add_u32 s28, s36, 11264
    s_add_u32 m0, s42, 57856
    s_nop 0
    buffer_load_dwordx4 v2, s[8:11], s28 offen offset:0 sc1 lds
    buffer_load_dwordx4 v2, s[8:11], s28 offen offset:1024 sc1 lds
    buffer_load_dwordx4 v2, s[8:11], s28 offen offset:2048 sc1 lds
    s_add_u32 s36, s36, 458752
    s_add_u32 s37, s37, 28672
    v_add_u32 v143, 118272, v2
    v_add_u32 v139, 132608, v141
    s_lshl_b32 s6, s12, 2
    s_add_u32 s6, s6, 94174720
    s_mov_b32 s53, 92995584
    s_lshl_b32 s55, s12, 2
    s_add_u32 s55, s55, 92995584
    s_mul_i32 s27, s12, 896
    v_add_u32 v142, s27, v142
    v_mov_b32 v70, 0
    v_mov_b32 v71, 0
    v_mov_b32 v78, 0
    v_mov_b32 v79, 0
    v_mov_b32 v86, 0
    v_mov_b32 v87, 0
    v_mov_b32 v94, 0
    v_mov_b32 v95, 0
    v_mov_b32 v64, 0
    v_mov_b32 v65, 0
    v_mov_b32 v66, 0
    v_mov_b32 v67, 0
    v_mov_b32 v68, 0
    v_mov_b32 v69, 0
    v_mov_b32 v70, 0
    v_mov_b32 v71, 0
    v_mov_b32 v72, 0
    v_mov_b32 v73, 0
    v_mov_b32 v74, 0
    v_mov_b32 v75, 0
    v_mov_b32 v76, 0
    v_mov_b32 v77, 0
    v_mov_b32 v78, 0
    v_mov_b32 v79, 0
    v_mov_b32 v80, 0
    v_mov_b32 v81, 0
    v_mov_b32 v82, 0
    v_mov_b32 v83, 0
    v_mov_b32 v84, 0
    v_mov_b32 v85, 0
    v_mov_b32 v86, 0
    v_mov_b32 v87, 0
    v_mov_b32 v88, 0
    v_mov_b32 v89, 0
    v_mov_b32 v90, 0
    v_mov_b32 v91, 0
    s_and_b32 s44, s15, 3
    s_lshl_b32 s45, s44, 16
    s_mul_i32 s46, s44, 114688
    s_add_u32 s47, s31, s45
    s_add_u32 s48, s32, s45
    s_add_u32 s49, s33, s46
    s_add_u32 s50, s34, s46
    s_add_u32 s52, s50, 4096
    s_add_u32 s51, s30, 4096
    s_add_u32 s54, s15, 1
    s_add_u32 s59, s15, 3
    s_and_b32 s59, s59, 3
    s_mul_i32 s59, s59, 114688
    s_add_u32 s59, s59, s34
    v_add_u32 v130, s42, v2
    v_mov_b32 v32, 0
    v_mov_b32 v33, 0
    v_mov_b32 v34, 0
    v_mov_b32 v35, 0
    v_mov_b32 v36, 0
    v_mov_b32 v37, 0
    v_mov_b32 v38, 0
    v_mov_b32 v39, 0
    v_mov_b32 v40, 0
    v_mov_b32 v41, 0
    v_mov_b32 v42, 0
    v_mov_b32 v43, 0
    v_mov_b32 v44, 0
    v_mov_b32 v45, 0
    v_mov_b32 v46, 0
    v_mov_b32 v47, 0
    v_mov_b32 v48, 0
    v_mov_b32 v49, 0
    v_mov_b32 v50, 0
    v_mov_b32 v51, 0
    v_mov_b32 v52, 0
    v_mov_b32 v53, 0
    v_mov_b32 v54, 0
    v_mov_b32 v55, 0
    v_mov_b32 v56, 0
    v_mov_b32 v57, 0
    v_mov_b32 v58, 0
    v_mov_b32 v59, 0
    v_mov_b32 v60, 0
    v_mov_b32 v61, 0
    v_mov_b32 v62, 0
    v_mov_b32 v63, 0
    s_waitcnt vmcnt(0) lgkmcnt(0)
    v_mov_b32 v122, 0
    v_mov_b32 v123, 64
    s_mov_b32 s60, 0
K3_MODE3:
    buffer_load_dword v121, v123, s[16:19], 0 offen sc1
    s_waitcnt vmcnt(0)
    buffer_load_dword v120, v122, s[16:19], 0 offen sc1
    s_add_u32 s60, s60, 1
    s_waitcnt vmcnt(0)
    v_readfirstlane_b32 s27, v120
    v_readfirstlane_b32 s28, v121
    s_nop 3
    s_cmp_ge_u32 s27, 32
    s_cbranch_scc1 K3_FAST3
    s_cmp_ge_u32 s28, 256
    s_cbranch_scc1 K3_SLOW3
    s_sleep 2
    s_cmp_lt_u32 s60, 32768
    s_cbranch_scc1 K3_MODE3
    s_branch K3_SLOW3
K3_FAST3:
K3_LOOPF3:
    s_barrier
    s_mov_b32 s60, 0
K3_PMF3:
    buffer_load_dwordx4 v[16:19], v2, s[8:11], s30 offen offset:3072 sc1
    s_add_u32 s60, s60, 1
    s_waitcnt vmcnt(0)
    v_max3_u32 v120, v16, v17, v18
    v_max_u32 v120, v120, v19
    v_cmp_eq_u32 vcc, s21, v120
    s_cbranch_vccz K3_PMF3_ok
    s_cmp_lt_u32 s60, 32768
    s_cbranch_scc1 K3_PMF3
K3_PMF3_ok:
    ds_write_b128 v2, v[16:19] offset:3072
    v_smfmac_f32_16x16x64_bf16 v[32:35], v[16:19], a[24:31], v3
    v_smfmac_f32_16x16x64_bf16 v[36:39], v[16:19], a[80:87], v3
    v_smfmac_f32_16x16x64_bf16 v[40:43], v[16:19], a[136:143], v3
    s_waitcnt lgkmcnt(0)
    s_barrier
    ds_read_b128 v[4:7], v2 offset:0
    ds_read_b128 v[8:11], v2 offset:1024
    ds_read_b128 v[12:15], v2 offset:2048
    ds_read_b128 v[20:23], v2 offset:4096
    ds_read_b128 v[24:27], v2 offset:5120
    ds_read_b128 v[28:31], v2 offset:6144
    s_add_u32 s27, s37, 28672
    s_mov_b64 exec, 0x7f
    buffer_load_dword v131, v142, s[8:11], s27 offen
    s_mov_b64 exec, -1
    s_waitcnt lgkmcnt(5)
    v_smfmac_f32_16x16x64_bf16 v[32:35], v[4:7], a[0:7], v3
    v_smfmac_f32_16x16x64_bf16 v[36:39], v[4:7], a[56:63], v3
    v_smfmac_f32_16x16x64_bf16 v[40:43], v[4:7], a[112:119], v3
    ds_read_b32 v64, v140 offset:0
    ds_read_b32 v65, v140 offset:128
    ds_read_b32 v66, v140 offset:256
    ds_read_b32 v67, v140 offset:384
    ds_read_b32 v68, v140 offset:512
    ds_read_b32 v69, v140 offset:640
    s_waitcnt lgkmcnt(10)
    v_smfmac_f32_16x16x64_bf16 v[32:35], v[8:11], a[8:15], v3
    v_smfmac_f32_16x16x64_bf16 v[36:39], v[8:11], a[64:71], v3
    v_smfmac_f32_16x16x64_bf16 v[40:43], v[8:11], a[120:127], v3
    ds_read_b32 v70, v140 offset:768
    ds_read_b32 v71, v140 offset:896
    ds_read_b32 v72, v140 offset:1024
    ds_read_b32 v73, v140 offset:1152
    ds_read_b32 v74, v140 offset:1280
    ds_read_b32 v75, v140 offset:1408
    s_waitcnt lgkmcnt(15)
    v_smfmac_f32_16x16x64_bf16 v[32:35], v[12:15], a[16:23], v3
    v_smfmac_f32_16x16x64_bf16 v[36:39], v[12:15], a[72:79], v3
    v_smfmac_f32_16x16x64_bf16 v[40:43], v[12:15], a[128:135], v3
    ds_read_b32 v76, v140 offset:1536
    ds_read_b32 v77, v140 offset:1664
    ds_read_b32 v78, v140 offset:1792
    ds_read_b32 v79, v140 offset:1920
    ds_read_b32 v80, v140 offset:2048
    ds_read_b32 v81, v140 offset:2176
    s_waitcnt lgkmcnt(15)
    v_smfmac_f32_16x16x64_bf16 v[32:35], v[20:23], a[32:39], v3
    v_smfmac_f32_16x16x64_bf16 v[36:39], v[20:23], a[88:95], v3
    v_smfmac_f32_16x16x64_bf16 v[40:43], v[20:23], a[144:151], v3
    ds_read_b32 v82, v140 offset:2304
    ds_read_b32 v83, v140 offset:2432
    ds_read_b32 v84, v140 offset:2560
    ds_read_b32 v85, v140 offset:2688
    ds_read_b32 v86, v140 offset:2816
    ds_read_b32 v87, v140 offset:2944
    ds_read_b32 v88, v140 offset:3072
    ds_read_b32 v89, v140 offset:3200
    ds_read_b32 v90, v140 offset:3328
    ds_read_b32 v91, v140 offset:3456
    s_waitcnt lgkmcnt(15)
    s_waitcnt lgkmcnt(15)
    v_smfmac_f32_16x16x64_bf16 v[32:35], v[24:27], a[40:47], v3
    v_smfmac_f32_16x16x64_bf16 v[32:35], v[28:31], a[48:55], v3
    v_smfmac_f32_16x16x64_bf16 v[36:39], v[24:27], a[96:103], v3
    v_smfmac_f32_16x16x64_bf16 v[36:39], v[28:31], a[104:111], v3
    v_smfmac_f32_16x16x64_bf16 v[40:43], v[24:27], a[152:159], v3
    v_cvt_pk_bf16_f32 v100, v32, v33
    v_cvt_pk_bf16_f32 v101, v34, v35
    ds_write_b64 v132, v[100:101] offset:1536
    v_smfmac_f32_16x16x64_bf16 v[40:43], v[28:31], a[160:167], v3
    v_cvt_pk_bf16_f32 v102, v36, v37
    v_cvt_pk_bf16_f32 v103, v38, v39
    ds_write_b64 v132, v[102:103] offset:3584
    s_nop 4
    v_cvt_pk_bf16_f32 v104, v40, v41
    v_cvt_pk_bf16_f32 v105, v42, v43
    ds_write_b64 v132, v[104:105] offset:5632
    s_waitcnt lgkmcnt(0)
    s_barrier
    ds_read_b64_tr_b16 v[100:101], v133 offset:0
    ds_read_b64_tr_b16 v[102:103], v133 offset:512
    ds_read_b64_tr_b16 v[104:105], v133 offset:1024
    ds_read_b64_tr_b16 v[106:107], v133 offset:1536
    ds_read_b64_tr_b16 v[108:109], v133 offset:2048
    ds_read_b64_tr_b16 v[110:111], v133 offset:2560
    v_smfmac_f32_16x16x64_bf16 v[48:51], v[4:7], a[168:175], v3
    v_smfmac_f32_16x16x64_bf16 v[48:51], v[8:11], a[176:183], v3
    v_smfmac_f32_16x16x64_bf16 v[48:51], v[12:15], a[184:191], v3
    v_smfmac_f32_16x16x64_bf16 v[48:51], v[16:19], a[192:199], v3
    v_smfmac_f32_16x16x64_bf16 v[48:51], v[20:23], a[200:207], v3
    v_smfmac_f32_16x16x64_bf16 v[48:51], v[24:27], a[208:215], v3
    s_waitcnt lgkmcnt(4)
    ds_read_b64_tr_b16 v[112:113], v133 offset:3072
    ds_read_b64_tr_b16 v[114:115], v133 offset:3584
    v_mfma_f32_16x16x32_bf16 v[116:119], v[64:67], v[100:103], 0
    s_waitcnt lgkmcnt(4)
    ds_read_b64_tr_b16 v[100:101], v133 offset:4096
    ds_read_b64_tr_b16 v[102:103], v133 offset:4608
    v_mfma_f32_16x16x32_bf16 v[116:119], v[68:71], v[104:107], v[116:119]
    s_waitcnt lgkmcnt(4)
    ds_read_b64_tr_b16 v[104:105], v133 offset:5120
    ds_read_b64_tr_b16 v[106:107], v133 offset:5632
    v_mfma_f32_16x16x32_bf16 v[116:119], v[72:75], v[108:111], v[116:119]
    s_waitcnt lgkmcnt(4)
    ds_read_b64_tr_b16 v[108:109], v133 offset:6144
    ds_read_b64_tr_b16 v[110:111], v133 offset:6656
    v_mfma_f32_16x16x32_bf16 v[116:119], v[76:79], v[112:115], v[116:119]
    s_waitcnt lgkmcnt(4)
    v_mfma_f32_16x16x32_bf16 v[116:119], v[80:83], v[100:103], v[116:119]
    s_waitcnt lgkmcnt(2)
    v_mfma_f32_16x16x32_bf16 v[116:119], v[84:87], v[104:107], v[116:119]
    s_waitcnt lgkmcnt(0)
    v_mfma_f32_16x16x32_bf16 v[116:119], v[88:91], v[108:111], v[116:119]
    v_smfmac_f32_16x16x64_bf16 v[48:51], v[28:31], a[216:223], v3
    v_smfmac_f32_16x16x64_bf16 v[52:55], v[4:7], v[144:151], v3
    s_nop 1
    v_add_f32_dpp v116, v116, v116 row_ror:8 row_mask:0xf bank_mask:0xf
    v_add_f32_dpp v117, v117, v117 row_ror:8 row_mask:0xf bank_mask:0xf
    v_add_f32_dpp v118, v118, v118 row_ror:8 row_mask:0xf bank_mask:0xf
    v_add_f32_dpp v119, v119, v119 row_ror:8 row_mask:0xf bank_mask:0xf
    s_mov_b64 exec, s[22:23]
    buffer_store_dwordx4 v[116:119], v134, s[8:11], s48 offen offset:1024
    ds_write_b128 v134, v[116:119] offset:15360
    s_mov_b64 exec, -1
    s_waitcnt lgkmcnt(0)
    s_barrier
    ds_read_b128 v[64:67], v130 offset:49664
    ds_read_b128 v[72:75], v130 offset:53760
    ds_read_b128 v[80:83], v130 offset:57856
    ds_read_b128 v[88:91], v130 offset:59904
    v_mov_b32 v124, s21
    v_mov_b32 v125, s21
    v_mov_b32 v126, s21
    v_mov_b32 v127, s21
    s_add_u32 s27, s59, 2048
    s_mov_b32 s28, 0
    s_cmp_ge_u32 s12, 28
    s_cselect_b32 s28, 1, s28
    s_cmp_eq_u32 s15, 0
    s_cselect_b32 s28, 1, s28
    v_smfmac_f32_16x16x64_bf16 v[52:55], v[8:11], v[152:159], v3
    v_smfmac_f32_16x16x64_bf16 v[52:55], v[12:15], v[160:167], v3
    v_smfmac_f32_16x16x64_bf16 v[52:55], v[16:19], v[168:175], v3
    v_smfmac_f32_16x16x64_bf16 v[52:55], v[20:23], v[176:183], v3
    s_cmp_eq_u32 s28, 0
    s_cbranch_scc0 L_nopo_9
    buffer_store_dwordx4 v[124:127], v2, s[8:11], s27 offen offset:0
    buffer_store_dwordx4 v[124:127], v2, s[8:11], s27 offen offset:1024
L_nopo_9:
    v_smfmac_f32_16x16x64_bf16 v[52:55], v[24:27], v[184:191], v3
    v_smfmac_f32_16x16x64_bf16 v[52:55], v[28:31], v[192:199], v3
    v_smfmac_f32_16x16x64_bf16 v[56:59], v[4:7], v[200:207], v3
    v_smfmac_f32_16x16x64_bf16 v[56:59], v[8:11], v[208:215], v3
    v_smfmac_f32_16x16x64_bf16 v[56:59], v[12:15], v[216:223], v3
    v_smfmac_f32_16x16x64_bf16 v[56:59], v[16:19], v[224:231], v3
    v_smfmac_f32_16x16x64_bf16 v[56:59], v[20:23], v[232:239], v3
    v_smfmac_f32_16x16x64_bf16 v[56:59], v[24:27], v[240:247], v3
    v_smfmac_f32_16x16x64_bf16 v[56:59], v[28:31], v[248:255], v3
    s_waitcnt lgkmcnt(0)
    ds_read_b128 a[224:227], v143 offset:0
    ds_read_b128 a[228:231], v143 offset:1024
    ds_read_b128 a[232:235], v143 offset:2048
    ds_read_b128 a[236:239], v143 offset:3072
    ds_read_b128 a[240:243], v143 offset:4096
    ds_read_b128 a[244:247], v143 offset:5120
    ds_read_b128 a[248:251], v143 offset:6144
    ds_read_b128 a[252:255], v143 offset:7168
    v_mov_b32 v32, 0
    v_mov_b32 v33, 0
    v_mov_b32 v34, 0
    v_mov_b32 v35, 0
    v_mov_b32 v36, 0
    v_mov_b32 v37, 0
    v_mov_b32 v38, 0
    v_mov_b32 v39, 0
    v_mov_b32 v40, 0
    v_mov_b32 v41, 0
    v_mov_b32 v42, 0
    v_mov_b32 v43, 0
    v_mov_b32 v44, 0
    v_mov_b32 v45, 0
    v_mov_b32 v46, 0
    v_mov_b32 v47, 0
    s_waitcnt lgkmcnt(6)
    v_smfmac_f32_16x16x64_bf16 v[60:63], v[4:7], a[224:231], v3
    ds_read_b128 a[224:227], v143 offset:8192
    ds_read_b128 a[228:231], v143 offset:9216
    s_add_u32 s28, s36, 7168
    s_add_u32 m0, s43, 53760
    s_nop 0
    buffer_load_dwordx4 v2, s[8:11], s28 offen offset:0 sc1 lds
    s_waitcnt lgkmcnt(6)
    v_smfmac_f32_16x16x64_bf16 v[60:63], v[8:11], a[232:239], v3
    ds_read_b128 a[232:235], v143 offset:10240
    ds_read_b128 a[236:239], v143 offset:11264
    buffer_load_dwordx4 v2, s[8:11], s28 offen offset:1024 sc1 lds
    s_waitcnt lgkmcnt(6)
    v_smfmac_f32_16x16x64_bf16 v[60:63], v[12:15], a[240:247], v3
    ds_read_b128 a[240:243], v143 offset:12288
    ds_read_b128 a[244:247], v143 offset:13312
    buffer_load_dwordx4 v2, s[8:11], s28 offen offset:2048 sc1 lds
    s_waitcnt lgkmcnt(6)
    v_smfmac_f32_16x16x64_bf16 v[60:63], v[16:19], a[248:255], v3
    buffer_load_dwordx4 v2, s[8:11], s28 offen offset:3072 sc1 lds
    s_waitcnt lgkmcnt(4)
    v_smfmac_f32_16x16x64_bf16 v[60:63], v[20:23], a[224:231], v3
    s_add_u32 s28, s36, 11264
    s_add_u32 m0, s43, 57856
    s_nop 0
    buffer_load_dwordx4 v2, s[8:11], s28 offen offset:0 sc1 lds
    s_waitcnt lgkmcnt(2)
    v_smfmac_f32_16x16x64_bf16 v[60:63], v[24:27], a[232:239], v3
    buffer_load_dwordx4 v2, s[8:11], s28 offen offset:1024 sc1 lds
    s_waitcnt lgkmcnt(0)
    v_smfmac_f32_16x16x64_bf16 v[60:63], v[28:31], a[240:247], v3
    buffer_load_dwordx4 v2, s[8:11], s28 offen offset:2048 sc1 lds
    s_nop 7
    v_cvt_pk_bf16_f32 v68, v48, v49
    v_cvt_pk_bf16_f32 v69, v50, v51
    v_cvt_pk_bf16_f32 v76, v52, v53
    v_cvt_pk_bf16_f32 v77, v54, v55
    v_cvt_pk_bf16_f32 v84, v56, v57
    v_cvt_pk_bf16_f32 v85, v58, v59
    v_cvt_pk_bf16_f32 v92, v60, v61
    v_cvt_pk_bf16_f32 v93, v62, v63
    s_waitcnt lgkmcnt(0)
    s_barrier
    ds_read_b128 v[96:99], v137
    v_lshlrev_b32 v116, 2, v1
    s_waitcnt lgkmcnt(0)
    v_smfmac_f32_16x16x64_bf16 v[32:35], v[96:99], v[64:71], v3
    v_smfmac_f32_16x16x64_bf16 v[36:39], v[96:99], v[72:79], v3
    v_smfmac_f32_16x16x64_bf16 v[40:43], v[96:99], v[80:87], v3
    v_smfmac_f32_16x16x64_bf16 v[44:47], v[96:99], v[88:95], v3
    s_nop 1
    v_permlane32_swap_b32 v32, v33
    v_permlane32_swap_b32 v34, v35
    s_add_u32 s27, s49, 12288
    v_add_f32 v32, v32, v33
    v_add_f32 v33, v34, v35
    v_cvt_pk_bf16_f32 v32, v32, v33
    buffer_store_dword v32, v116, s[8:11], s27 offen
    v_permlane32_swap_b32 v36, v37
    v_permlane32_swap_b32 v38, v39
    s_add_u32 s27, s49, 28672
    v_add_f32 v36, v36, v37
    v_add_f32 v37, v38, v39
    v_cvt_pk_bf16_f32 v36, v36, v37
    buffer_store_dword v36, v116, s[8:11], s27 offen
    v_permlane32_swap_b32 v40, v41
    v_permlane32_swap_b32 v42, v43
    s_add_u32 s27, s49, 45056
    v_add_f32 v40, v40, v41
    v_add_f32 v41, v42, v43
    v_cvt_pk_bf16_f32 v40, v40, v41
    buffer_store_dword v40, v116, s[8:11], s27 offen
    s_nop 3
    v_permlane32_swap_b32 v44, v45
    v_permlane32_swap_b32 v46, v47
    s_add_u32 s27, s49, 53248
    v_add_f32 v44, v44, v45
    v_add_f32 v45, v46, v47
    v_cvt_pk_bf16_f32 v44, v44, v45
    buffer_store_dword v44, v116, s[8:11], s27 offen
    s_add_u32 s30, s30, 8192
    s_add_u32 s35, s35, 229376
    s_add_u32 s6, s6, 256
    s_add_u32 s15, s15, 1
    s_cmp_lt_u32 s15, 63
    s_cselect_b32 s27, 458752, 0
    s_cselect_b32 s28, 28672, 0
    s_add_u32 s36, s36, s27
    s_add_u32 s37, s37, s28
    s_mov_b32 s27, s42
    s_mov_b32 s42, s43
    s_mov_b32 s43, s27
    s_and_b32 s44, s15, 3
    s_lshl_b32 s45, s44, 16
    s_mul_i32 s46, s44, 114688
    s_add_u32 s47, s31, s45
    s_add_u32 s48, s32, s45
    s_add_u32 s49, s33, s46
    s_add_u32 s50, s34, s46
    s_add_u32 s52, s50, 4096
    s_add_u32 s51, s30, 4096
    s_add_u32 s54, s15, 1
    s_add_u32 s59, s15, 3
    s_and_b32 s59, s59, 3
    s_mul_i32 s59, s59, 114688
    s_add_u32 s59, s59, s34
    v_add_u32 v130, s42, v2
    v_mov_b32 v32, 0
    v_mov_b32 v33, 0
    v_mov_b32 v34, 0
    v_mov_b32 v35, 0
    v_mov_b32 v36, 0
    v_mov_b32 v37, 0
    v_mov_b32 v38, 0
    v_mov_b32 v39, 0
    v_mov_b32 v40, 0
    v_mov_b32 v41, 0
    v_mov_b32 v42, 0
    v_mov_b32 v43, 0
    v_mov_b32 v44, 0
    v_mov_b32 v45, 0
    v_mov_b32 v46, 0
    v_mov_b32 v47, 0
    v_mov_b32 v48, 0
    v_mov_b32 v49, 0
    v_mov_b32 v50, 0
    v_mov_b32 v51, 0
    v_mov_b32 v52, 0
    v_mov_b32 v53, 0
    v_mov_b32 v54, 0
    v_mov_b32 v55, 0
    v_mov_b32 v56, 0
    v_mov_b32 v57, 0
    v_mov_b32 v58, 0
    v_mov_b32 v59, 0
    v_mov_b32 v60, 0
    v_mov_b32 v61, 0
    v_mov_b32 v62, 0
    v_mov_b32 v63, 0
    s_cmp_lt_u32 s15, 64
    s_cbranch_scc1 K3_LOOPF3
    s_waitcnt vmcnt(0) lgkmcnt(0)
    s_endpgm
K3_SLOW3:
    s_barrier
    s_lshl_b32 s27, s12, 2
    s_add_u32 s27, s27, 93007872
    v_mov_b32 v120, 1
    v_mov_b32 v121, 0
    s_mov_b64 exec, 1
    buffer_store_dword v120, v121, s[8:11], s27 offen sc1
    s_mov_b64 exec, -1
    s_mov_b32 s27, 93007872
    v_and_b32 v121, 31, v1
    v_lshlrev_b32 v121, 2, v121
    s_mov_b32 s60, 0
K3_RV3:
    buffer_load_dword v120, v121, s[8:11], s27 offen sc1
    s_add_u32 s60, s60, 1
    s_waitcnt vmcnt(0)
    v_cmp_eq_u32 vcc, 0, v120
    s_cbranch_vccz K3_RV3_ok
    s_sleep 8
    s_cmp_lt_u32 s60, 32768
    s_cbranch_scc1 K3_RV3
K3_RV3_ok:
K3_LOOPS3:
    s_barrier
    s_mov_b32 s60, 0
K3_PMS3:
    buffer_load_dwordx4 v[16:19], v2, s[8:11], s30 offen offset:3072 sc1
    s_add_u32 s60, s60, 1
    s_waitcnt vmcnt(0)
    v_max3_u32 v120, v16, v17, v18
    v_max_u32 v120, v120, v19
    v_cmp_eq_u32 vcc, s21, v120
    s_cbranch_vccz K3_PMS3_ok
    s_cmp_lt_u32 s60, 32768
    s_cbranch_scc1 K3_PMS3
K3_PMS3_ok:
    ds_write_b128 v2, v[16:19] offset:3072
    v_smfmac_f32_16x16x64_bf16 v[32:35], v[16:19], a[24:31], v3
    v_smfmac_f32_16x16x64_bf16 v[36:39], v[16:19], a[80:87], v3
    v_smfmac_f32_16x16x64_bf16 v[40:43], v[16:19], a[136:143], v3
    s_waitcnt lgkmcnt(0)
    s_barrier
    ds_read_b128 v[4:7], v2 offset:0
    ds_read_b128 v[8:11], v2 offset:1024
    ds_read_b128 v[12:15], v2 offset:2048
    ds_read_b128 v[20:23], v2 offset:4096
    ds_read_b128 v[24:27], v2 offset:5120
    ds_read_b128 v[28:31], v2 offset:6144
    s_add_u32 s27, s37, 28672
    s_mov_b64 exec, 0x7f
    buffer_load_dword v131, v142, s[8:11], s27 offen
    s_mov_b64 exec, -1
    s_waitcnt lgkmcnt(5)
    v_smfmac_f32_16x16x64_bf16 v[32:35], v[4:7], a[0:7], v3
    v_smfmac_f32_16x16x64_bf16 v[36:39], v[4:7], a[56:63], v3
    v_smfmac_f32_16x16x64_bf16 v[40:43], v[4:7], a[112:119], v3
    ds_read_b32 v64, v140 offset:0
    ds_read_b32 v65, v140 offset:128
    ds_read_b32 v66, v140 offset:256
    ds_read_b32 v67, v140 offset:384
    ds_read_b32 v68, v140 offset:512
    ds_read_b32 v69, v140 offset:640
    s_waitcnt lgkmcnt(10)
    v_smfmac_f32_16x16x64_bf16 v[32:35], v[8:11], a[8:15], v3
    v_smfmac_f32_16x16x64_bf16 v[36:39], v[8:11], a[64:71], v3
    v_smfmac_f32_16x16x64_bf16 v[40:43], v[8:11], a[120:127], v3
    ds_read_b32 v70, v140 offset:768
    ds_read_b32 v71, v140 offset:896
    ds_read_b32 v72, v140 offset:1024
    ds_read_b32 v73, v140 offset:1152
    ds_read_b32 v74, v140 offset:1280
    ds_read_b32 v75, v140 offset:1408
    s_waitcnt lgkmcnt(15)
    v_smfmac_f32_16x16x64_bf16 v[32:35], v[12:15], a[16:23], v3
    v_smfmac_f32_16x16x64_bf16 v[36:39], v[12:15], a[72:79], v3
    v_smfmac_f32_16x16x64_bf16 v[40:43], v[12:15], a[128:135], v3
    ds_read_b32 v76, v140 offset:1536
    ds_read_b32 v77, v140 offset:1664
    ds_read_b32 v78, v140 offset:1792
    ds_read_b32 v79, v140 offset:1920
    ds_read_b32 v80, v140 offset:2048
    ds_read_b32 v81, v140 offset:2176
    s_waitcnt lgkmcnt(15)
    v_smfmac_f32_16x16x64_bf16 v[32:35], v[20:23], a[32:39], v3
    v_smfmac_f32_16x16x64_bf16 v[36:39], v[20:23], a[88:95], v3
    v_smfmac_f32_16x16x64_bf16 v[40:43], v[20:23], a[144:151], v3
    ds_read_b32 v82, v140 offset:2304
    ds_read_b32 v83, v140 offset:2432
    ds_read_b32 v84, v140 offset:2560
    ds_read_b32 v85, v140 offset:2688
    ds_read_b32 v86, v140 offset:2816
    ds_read_b32 v87, v140 offset:2944
    ds_read_b32 v88, v140 offset:3072
    ds_read_b32 v89, v140 offset:3200
    ds_read_b32 v90, v140 offset:3328
    ds_read_b32 v91, v140 offset:3456
    s_waitcnt lgkmcnt(15)
    s_waitcnt lgkmcnt(15)
    v_smfmac_f32_16x16x64_bf16 v[32:35], v[24:27], a[40:47], v3
    v_smfmac_f32_16x16x64_bf16 v[32:35], v[28:31], a[48:55], v3
    v_smfmac_f32_16x16x64_bf16 v[36:39], v[24:27], a[96:103], v3
    v_smfmac_f32_16x16x64_bf16 v[36:39], v[28:31], a[104:111], v3
    v_smfmac_f32_16x16x64_bf16 v[40:43], v[24:27], a[152:159], v3
    v_cvt_pk_bf16_f32 v100, v32, v33
    v_cvt_pk_bf16_f32 v101, v34, v35
    ds_write_b64 v132, v[100:101] offset:1536
    v_smfmac_f32_16x16x64_bf16 v[40:43], v[28:31], a[160:167], v3
    v_cvt_pk_bf16_f32 v102, v36, v37
    v_cvt_pk_bf16_f32 v103, v38, v39
    ds_write_b64 v132, v[102:103] offset:3584
    s_nop 4
    v_cvt_pk_bf16_f32 v104, v40, v41
    v_cvt_pk_bf16_f32 v105, v42, v43
    ds_write_b64 v132, v[104:105] offset:5632
    s_waitcnt lgkmcnt(0)
    s_barrier
    ds_read_b64_tr_b16 v[100:101], v133 offset:0
    ds_read_b64_tr_b16 v[102:103], v133 offset:512
    ds_read_b64_tr_b16 v[104:105], v133 offset:1024
    ds_read_b64_tr_b16 v[106:107], v133 offset:1536
    ds_read_b64_tr_b16 v[108:109], v133 offset:2048
    ds_read_b64_tr_b16 v[110:111], v133 offset:2560
    v_smfmac_f32_16x16x64_bf16 v[48:51], v[4:7], a[168:175], v3
    v_smfmac_f32_16x16x64_bf16 v[48:51], v[8:11], a[176:183], v3
    v_smfmac_f32_16x16x64_bf16 v[48:51], v[12:15], a[184:191], v3
    v_smfmac_f32_16x16x64_bf16 v[48:51], v[16:19], a[192:199], v3
    v_smfmac_f32_16x16x64_bf16 v[48:51], v[20:23], a[200:207], v3
    v_smfmac_f32_16x16x64_bf16 v[48:51], v[24:27], a[208:215], v3
    s_waitcnt lgkmcnt(4)
    ds_read_b64_tr_b16 v[112:113], v133 offset:3072
    ds_read_b64_tr_b16 v[114:115], v133 offset:3584
    v_mfma_f32_16x16x32_bf16 v[116:119], v[64:67], v[100:103], 0
    s_waitcnt lgkmcnt(4)
    ds_read_b64_tr_b16 v[100:101], v133 offset:4096
    ds_read_b64_tr_b16 v[102:103], v133 offset:4608
    v_mfma_f32_16x16x32_bf16 v[116:119], v[68:71], v[104:107], v[116:119]
    s_waitcnt lgkmcnt(4)
    ds_read_b64_tr_b16 v[104:105], v133 offset:5120
    ds_read_b64_tr_b16 v[106:107], v133 offset:5632
    v_mfma_f32_16x16x32_bf16 v[116:119], v[72:75], v[108:111], v[116:119]
    s_waitcnt lgkmcnt(4)
    ds_read_b64_tr_b16 v[108:109], v133 offset:6144
    ds_read_b64_tr_b16 v[110:111], v133 offset:6656
    v_mfma_f32_16x16x32_bf16 v[116:119], v[76:79], v[112:115], v[116:119]
    s_waitcnt lgkmcnt(4)
    v_mfma_f32_16x16x32_bf16 v[116:119], v[80:83], v[100:103], v[116:119]
    s_waitcnt lgkmcnt(2)
    v_mfma_f32_16x16x32_bf16 v[116:119], v[84:87], v[104:107], v[116:119]
    s_waitcnt lgkmcnt(0)
    v_mfma_f32_16x16x32_bf16 v[116:119], v[88:91], v[108:111], v[116:119]
    v_smfmac_f32_16x16x64_bf16 v[48:51], v[28:31], a[216:223], v3
    v_smfmac_f32_16x16x64_bf16 v[52:55], v[4:7], v[144:151], v3
    s_nop 1
    v_add_f32_dpp v116, v116, v116 row_ror:8 row_mask:0xf bank_mask:0xf
    v_add_f32_dpp v117, v117, v117 row_ror:8 row_mask:0xf bank_mask:0xf
    v_add_f32_dpp v118, v118, v118 row_ror:8 row_mask:0xf bank_mask:0xf
    v_add_f32_dpp v119, v119, v119 row_ror:8 row_mask:0xf bank_mask:0xf
    s_mov_b64 exec, s[22:23]
    buffer_store_dwordx4 v[116:119], v134, s[8:11], s48 offen offset:1024 sc1
    ds_write_b128 v134, v[116:119] offset:15360
    s_mov_b64 exec, -1
    s_waitcnt lgkmcnt(0)
    s_barrier
    ds_read_b128 v[64:67], v130 offset:49664
    ds_read_b128 v[72:75], v130 offset:53760
    ds_read_b128 v[80:83], v130 offset:57856
    ds_read_b128 v[88:91], v130 offset:59904
    v_mov_b32 v124, s21
    v_mov_b32 v125, s21
    v_mov_b32 v126, s21
    v_mov_b32 v127, s21
    s_add_u32 s27, s59, 2048
    s_mov_b32 s28, 0
    s_cmp_ge_u32 s12, 28
    s_cselect_b32 s28, 1, s28
    s_cmp_eq_u32 s15, 0
    s_cselect_b32 s28, 1, s28
    v_smfmac_f32_16x16x64_bf16 v[52:55], v[8:11], v[152:159], v3
    v_smfmac_f32_16x16x64_bf16 v[52:55], v[12:15], v[160:167], v3
    v_smfmac_f32_16x16x64_bf16 v[52:55], v[16:19], v[168:175], v3
    v_smfmac_f32_16x16x64_bf16 v[52:55], v[20:23], v[176:183], v3
    s_cmp_eq_u32 s28, 0
    s_cbranch_scc0 L_nopo_10
    buffer_store_dwordx4 v[124:127], v2, s[8:11], s27 offen offset:0 sc1
    buffer_store_dwordx4 v[124:127], v2, s[8:11], s27 offen offset:1024 sc1
L_nopo_10:
    v_smfmac_f32_16x16x64_bf16 v[52:55], v[24:27], v[184:191], v3
    v_smfmac_f32_16x16x64_bf16 v[52:55], v[28:31], v[192:199], v3
    v_smfmac_f32_16x16x64_bf16 v[56:59], v[4:7], v[200:207], v3
    v_smfmac_f32_16x16x64_bf16 v[56:59], v[8:11], v[208:215], v3
    v_smfmac_f32_16x16x64_bf16 v[56:59], v[12:15], v[216:223], v3
    v_smfmac_f32_16x16x64_bf16 v[56:59], v[16:19], v[224:231], v3
    v_smfmac_f32_16x16x64_bf16 v[56:59], v[20:23], v[232:239], v3
    v_smfmac_f32_16x16x64_bf16 v[56:59], v[24:27], v[240:247], v3
    v_smfmac_f32_16x16x64_bf16 v[56:59], v[28:31], v[248:255], v3
    s_waitcnt lgkmcnt(0)
    ds_read_b128 a[224:227], v143 offset:0
    ds_read_b128 a[228:231], v143 offset:1024
    ds_read_b128 a[232:235], v143 offset:2048
    ds_read_b128 a[236:239], v143 offset:3072
    ds_read_b128 a[240:243], v143 offset:4096
    ds_read_b128 a[244:247], v143 offset:5120
    ds_read_b128 a[248:251], v143 offset:6144
    ds_read_b128 a[252:255], v143 offset:7168
    v_mov_b32 v32, 0
    v_mov_b32 v33, 0
    v_mov_b32 v34, 0
    v_mov_b32 v35, 0
    v_mov_b32 v36, 0
    v_mov_b32 v37, 0
    v_mov_b32 v38, 0
    v_mov_b32 v39, 0
    v_mov_b32 v40, 0
    v_mov_b32 v41, 0
    v_mov_b32 v42, 0
    v_mov_b32 v43, 0
    v_mov_b32 v44, 0
    v_mov_b32 v45, 0
    v_mov_b32 v46, 0
    v_mov_b32 v47, 0
    s_waitcnt lgkmcnt(6)
    v_smfmac_f32_16x16x64_bf16 v[60:63], v[4:7], a[224:231], v3
    ds_read_b128 a[224:227], v143 offset:8192
    ds_read_b128 a[228:231], v143 offset:9216
    s_add_u32 s28, s36, 7168
    s_add_u32 m0, s43, 53760
    s_nop 0
    buffer_load_dwordx4 v2, s[8:11], s28 offen offset:0 sc1 lds
    s_waitcnt lgkmcnt(6)
    v_smfmac_f32_16x16x64_bf16 v[60:63], v[8:11], a[232:239], v3
    ds_read_b128 a[232:235], v143 offset:10240
    ds_read_b128 a[236:239], v143 offset:11264
    buffer_load_dwordx4 v2, s[8:11], s28 offen offset:1024 sc1 lds
    s_waitcnt lgkmcnt(6)
    v_smfmac_f32_16x16x64_bf16 v[60:63], v[12:15], a[240:247], v3
    ds_read_b128 a[240:243], v143 offset:12288
    ds_read_b128 a[244:247], v143 offset:13312
    buffer_load_dwordx4 v2, s[8:11], s28 offen offset:2048 sc1 lds
    s_waitcnt lgkmcnt(6)
    v_smfmac_f32_16x16x64_bf16 v[60:63], v[16:19], a[248:255], v3
    buffer_load_dwordx4 v2, s[8:11], s28 offen offset:3072 sc1 lds
    s_waitcnt lgkmcnt(4)
    v_smfmac_f32_16x16x64_bf16 v[60:63], v[20:23], a[224:231], v3
    s_add_u32 s28, s36, 11264
    s_add_u32 m0, s43, 57856
    s_nop 0
    buffer_load_dwordx4 v2, s[8:11], s28 offen offset:0 sc1 lds
    s_waitcnt lgkmcnt(2)
    v_smfmac_f32_16x16x64_bf16 v[60:63], v[24:27], a[232:239], v3
    buffer_load_dwordx4 v2, s[8:11], s28 offen offset:1024 sc1 lds
    s_waitcnt lgkmcnt(0)
    v_smfmac_f32_16x16x64_bf16 v[60:63], v[28:31], a[240:247], v3
    buffer_load_dwordx4 v2, s[8:11], s28 offen offset:2048 sc1 lds
    s_nop 7
    v_cvt_pk_bf16_f32 v68, v48, v49
    v_cvt_pk_bf16_f32 v69, v50, v51
    v_cvt_pk_bf16_f32 v76, v52, v53
    v_cvt_pk_bf16_f32 v77, v54, v55
    v_cvt_pk_bf16_f32 v84, v56, v57
    v_cvt_pk_bf16_f32 v85, v58, v59
    v_cvt_pk_bf16_f32 v92, v60, v61
    v_cvt_pk_bf16_f32 v93, v62, v63
    s_waitcnt lgkmcnt(0)
    s_barrier
    ds_read_b128 v[96:99], v137
    v_lshlrev_b32 v116, 2, v1
    s_waitcnt lgkmcnt(0)
    v_smfmac_f32_16x16x64_bf16 v[32:35], v[96:99], v[64:71], v3
    v_smfmac_f32_16x16x64_bf16 v[36:39], v[96:99], v[72:79], v3
    v_smfmac_f32_16x16x64_bf16 v[40:43], v[96:99], v[80:87], v3
    v_smfmac_f32_16x16x64_bf16 v[44:47], v[96:99], v[88:95], v3
    s_nop 1
    v_permlane32_swap_b32 v32, v33
    v_permlane32_swap_b32 v34, v35
    s_add_u32 s27, s49, 12288
    v_add_f32 v32, v32, v33
    v_add_f32 v33, v34, v35
    v_cvt_pk_bf16_f32 v32, v32, v33
    buffer_store_dword v32, v116, s[8:11], s27 offen sc1
    v_permlane32_swap_b32 v36, v37
    v_permlane32_swap_b32 v38, v39
    s_add_u32 s27, s49, 28672
    v_add_f32 v36, v36, v37
    v_add_f32 v37, v38, v39
    v_cvt_pk_bf16_f32 v36, v36, v37
    buffer_store_dword v36, v116, s[8:11], s27 offen sc1
    v_permlane32_swap_b32 v40, v41
    v_permlane32_swap_b32 v42, v43
    s_add_u32 s27, s49, 45056
    v_add_f32 v40, v40, v41
    v_add_f32 v41, v42, v43
    v_cvt_pk_bf16_f32 v40, v40, v41
    buffer_store_dword v40, v116, s[8:11], s27 offen sc1
    s_nop 3
    v_permlane32_swap_b32 v44, v45
    v_permlane32_swap_b32 v46, v47
    s_add_u32 s27, s49, 53248
    v_add_f32 v44, v44, v45
    v_add_f32 v45, v46, v47
    v_cvt_pk_bf16_f32 v44, v44, v45
    buffer_store_dword v44, v116, s[8:11], s27 offen sc1
    s_add_u32 s30, s30, 8192
    s_add_u32 s35, s35, 229376
    s_add_u32 s6, s6, 256
    s_add_u32 s15, s15, 1
    s_cmp_lt_u32 s15, 63
    s_cselect_b32 s27, 458752, 0
    s_cselect_b32 s28, 28672, 0
    s_add_u32 s36, s36, s27
    s_add_u32 s37, s37, s28
    s_mov_b32 s27, s42
    s_mov_b32 s42, s43
    s_mov_b32 s43, s27
    s_and_b32 s44, s15, 3
    s_lshl_b32 s45, s44, 16
    s_mul_i32 s46, s44, 114688
    s_add_u32 s47, s31, s45
    s_add_u32 s48, s32, s45
    s_add_u32 s49, s33, s46
    s_add_u32 s50, s34, s46
    s_add_u32 s52, s50, 4096
    s_add_u32 s51, s30, 4096
    s_add_u32 s54, s15, 1
    s_add_u32 s59, s15, 3
    s_and_b32 s59, s59, 3
    s_mul_i32 s59, s59, 114688
    s_add_u32 s59, s59, s34
    v_add_u32 v130, s42, v2
    v_mov_b32 v32, 0
    v_mov_b32 v33, 0
    v_mov_b32 v34, 0
    v_mov_b32 v35, 0
    v_mov_b32 v36, 0
    v_mov_b32 v37, 0
    v_mov_b32 v38, 0
    v_mov_b32 v39, 0
    v_mov_b32 v40, 0
    v_mov_b32 v41, 0
    v_mov_b32 v42, 0
    v_mov_b32 v43, 0
    v_mov_b32 v44, 0
    v_mov_b32 v45, 0
    v_mov_b32 v46, 0
    v_mov_b32 v47, 0
    v_mov_b32 v48, 0
    v_mov_b32 v49, 0
    v_mov_b32 v50, 0
    v_mov_b32 v51, 0
    v_mov_b32 v52, 0
    v_mov_b32 v53, 0
    v_mov_b32 v54, 0
    v_mov_b32 v55, 0
    v_mov_b32 v56, 0
    v_mov_b32 v57, 0
    v_mov_b32 v58, 0
    v_mov_b32 v59, 0
    v_mov_b32 v60, 0
    v_mov_b32 v61, 0
    v_mov_b32 v62, 0
    v_mov_b32 v63, 0
    s_cmp_lt_u32 s15, 64
    s_cbranch_scc1 K3_LOOPS3
    s_waitcnt vmcnt(0) lgkmcnt(0)
    s_endpgm
K3_HELP:
    v_lshlrev_b32 v5, 4, v1
    s_mov_b32 s62, s16
    s_mov_b32 s63, s17
    s_sub_u32 s64, s12, 0x100
    s_mov_b32 s66, 0
    s_branch K3_DISPATCH
K3_TASK:
    s_mov_b32 s16, s62
    s_mov_b32 s17, s63
    s_and_b32 s17, s17, 0xffff
    s_mov_b32 s18, 256
    s_mov_b32 s19, 0x00020000
    s_cmp_eq_u32 s66, 0
    s_cbranch_scc0 K3_CHKD
    s_mov_b32 s66, 1
    s_cmp_eq_u32 s20, 0
    s_cbranch_scc0 K3_FBW
    v_mov_b32 v12, 0
    v_mov_b32 v13, 64
    s_mov_b32 s60, 0
K3_FBP:
    buffer_load_dword v11, v13, s[16:19], 0 offen sc1
    s_waitcnt vmcnt(0)
    buffer_load_dword v10, v12, s[16:19], 0 offen sc1
    s_add_u32 s60, s60, 1
    s_waitcnt vmcnt(0)
    v_readfirstlane_b32 s27, v10
    v_readfirstlane_b32 s28, v11
    s_nop 3
    s_mov_b32 s7, 0xffff
    s_cmp_ge_u32 s27, 32
    s_cbranch_scc1 K3_FBOUT
    s_cmp_ge_u32 s28, 256
    s_cbranch_scc1 K3_FBTAKE
    s_sleep 8
    s_cmp_lt_u32 s60, 32768
    s_cbranch_scc1 K3_FBP
    s_branch K3_FBOUT
K3_FBTAKE:
    s_mov_b64 exec, 1
    v_mov_b32 v12, 1
    v_mov_b32 v13, 192
    buffer_atomic_add v12, v13, s[16:19], 0 offen sc0
    s_waitcnt vmcnt(0)
    v_readfirstlane_b32 s6, v12
    s_mov_b64 exec, -1
    s_add_u32 s6, s6, s27
    s_cmp_lt_u32 s6, 32
    s_cselect_b32 s7, s6, s7
K3_FBOUT:
    v_mov_b32 v12, s7
    v_mov_b32 v13, 131072
    ds_write_b32 v13, v12
    s_waitcnt lgkmcnt(0)
K3_FBW:
    s_barrier
    v_mov_b32 v13, 131072
    ds_read_b32 v12, v13
    s_waitcnt lgkmcnt(0)
    v_readfirstlane_b32 s12, v12
    s_barrier
    s_cmp_lt_u32 s12, 32
    s_cbranch_scc1 K3_MEMBER
K3_CHKD:
    s_cmp_eq_u32 s20, 0
    s_cbranch_scc0 K3_TKW
    s_mov_b64 exec, 1
    v_mov_b32 v12, 1
    v_mov_b32 v13, 128
    buffer_atomic_add v12, v13, s[16:19], 0 offen sc0
    s_waitcnt vmcnt(0)
    v_mov_b32 v13, 131072
    ds_write_b32 v13, v12
    s_mov_b64 exec, -1
    s_waitcnt lgkmcnt(0)
K3_TKW:
    s_barrier
    v_mov_b32 v13, 131072
    ds_read_b32 v12, v13
    s_waitcnt lgkmcnt(0)
    v_readfirstlane_b32 s64, v12
    s_barrier
K3_DISPATCH:
    s_cmp_lt_u32 s64, 64
    s_cbranch_scc1 K3_TQ
    s_cmp_lt_u32 s64, 96
    s_cbranch_scc1 K3_TU1
    s_cmp_lt_u32 s64, 293
    s_cbranch_scc1 K3_TR
    s_cmp_lt_u32 s64, 613
    s_cbranch_scc0 K3_POST
    v_lshlrev_b32 v12, 2, v1
    s_mov_b32 s27, 93001728
    s_mov_b32 s60, 0
K3_GW:
    buffer_load_dword v13, v12, s[8:11], s27 offen sc1
    s_add_u32 s60, s60, 1
    s_waitcnt vmcnt(0)
    v_cmp_eq_u32 vcc, 0, v13
    s_cbranch_vccz K3_GWD
    s_sleep 20
    s_cmp_lt_u32 s60, 32768
    s_cbranch_scc1 K3_GW
K3_GWD:
    s_cmp_lt_u32 s64, 485
    s_cbranch_scc0 K3_TG
    s_sub_u32 s64, s64, 197
K3_TU1:
    s_sub_u32 s64, s64, 32
    s_lshr_b32 s22, s64, 5
    s_bfe_u32 s21, s64, 0x40001
    s_and_b32 s23, s64, 1
    s_mul_i32 s23, s23, 6
    s_mov_b32 s43, 4
    s_lshl_b32 s44, s64, 2
    s_add_u32 s44, s44, 92999680
    s_branch K3_TUGO
K3_TQ:
    s_mov_b32 s22, 0
    s_lshr_b32 s21, s64, 2
    s_and_b32 s23, s64, 3
    s_lshr_b32 s27, s23, 1
    s_mul_i32 s23, s23, 3
    s_add_u32 s23, s23, s27
    s_mov_b32 s43, 2
    s_lshl_b32 s44, s64, 2
    s_add_u32 s44, s44, 93001728
K3_TUGO:
    s_lshl_b32 s24, s22, 3
    s_lshl_b32 s33, s20, 1
    s_add_u32 s24, s24, s33
    s_mul_i32 s25, s24, 28672
    s_add_u32 s25, s25, 0
    s_add_u32 s26, s21, 16
    s_mul_i32 s26, s26, 401408
    s_add_u32 s26, s26, 4194304
    s_mul_i32 s27, s20, 7168
    s_add_u32 s26, s26, s27
    s_mul_i32 s28, s23, 28672
    s_add_u32 s26, s26, s28
    s_add_u32 s28, s25, 0
    buffer_load_dwordx4 a[0:3], v5, s[8:11], s28 offen offset:0
    buffer_load_dwordx4 a[4:7], v5, s[8:11], s28 offen offset:1024
    buffer_load_dwordx4 a[8:11], v5, s[8:11], s28 offen offset:2048
    buffer_load_dwordx4 a[12:15], v5, s[8:11], s28 offen offset:3072
    s_add_u32 s28, s25, 4096
    buffer_load_dwordx4 a[16:19], v5, s[8:11], s28 offen offset:0
    buffer_load_dwordx4 a[20:23], v5, s[8:11], s28 offen offset:1024
    buffer_load_dwordx4 a[24:27], v5, s[8:11], s28 offen offset:2048
    buffer_load_dwordx4 a[28:31], v5, s[8:11], s28 offen offset:3072
    s_add_u32 s28, s25, 8192
    buffer_load_dwordx4 a[32:35], v5, s[8:11], s28 offen offset:0
    buffer_load_dwordx4 a[36:39], v5, s[8:11], s28 offen offset:1024
    buffer_load_dwordx4 a[40:43], v5, s[8:11], s28 offen offset:2048
    buffer_load_dwordx4 a[44:47], v5, s[8:11], s28 offen offset:3072
    s_add_u32 s28, s25, 12288
    buffer_load_dwordx4 a[48:51], v5, s[8:11], s28 offen offset:0
    buffer_load_dwordx4 a[52:55], v5, s[8:11], s28 offen offset:1024
    s_add_u32 s28, s25, 14336
    buffer_load_dwordx4 a[56:59], v5, s[8:11], s28 offen offset:0
    buffer_load_dwordx4 a[60:63], v5, s[8:11], s28 offen offset:1024
    buffer_load_dwordx4 a[64:67], v5, s[8:11], s28 offen offset:2048
    buffer_load_dwordx4 a[68:71], v5, s[8:11], s28 offen offset:3072
    s_add_u32 s28, s25, 18432
    buffer_load_dwordx4 a[72:75], v5, s[8:11], s28 offen offset:0
    buffer_load_dwordx4 a[76:79], v5, s[8:11], s28 offen offset:1024
    buffer_load_dwordx4 a[80:83], v5, s[8:11], s28 offen offset:2048
    buffer_load_dwordx4 a[84:87], v5, s[8:11], s28 offen offset:3072
    s_add_u32 s28, s25, 22528
    buffer_load_dwordx4 a[88:91], v5, s[8:11], s28 offen offset:0
    buffer_load_dwordx4 a[92:95], v5, s[8:11], s28 offen offset:1024
    buffer_load_dwordx4 a[96:99], v5, s[8:11], s28 offen offset:2048
    buffer_load_dwordx4 a[100:103], v5, s[8:11], s28 offen offset:3072
    s_add_u32 s28, s25, 26624
    buffer_load_dwordx4 a[104:107], v5, s[8:11], s28 offen offset:0
    buffer_load_dwordx4 a[108:111], v5, s[8:11], s28 offen offset:1024
    s_add_u32 s28, s25, 28672
    buffer_load_dwordx4 a[112:115], v5, s[8:11], s28 offen offset:0
    buffer_load_dwordx4 a[116:119], v5, s[8:11], s28 offen offset:1024
    buffer_load_dwordx4 a[120:123], v5, s[8:11], s28 offen offset:2048
    buffer_load_dwordx4 a[124:127], v5, s[8:11], s28 offen offset:3072
    s_add_u32 s28, s25, 32768
    buffer_load_dwordx4 a[128:131], v5, s[8:11], s28 offen offset:0
    buffer_load_dwordx4 a[132:135], v5, s[8:11], s28 offen offset:1024
    buffer_load_dwordx4 a[136:139], v5, s[8:11], s28 offen offset:2048
    buffer_load_dwordx4 a[140:143], v5, s[8:11], s28 offen offset:3072
    s_add_u32 s28, s25, 36864
    buffer_load_dwordx4 a[144:147], v5, s[8:11], s28 offen offset:0
    buffer_load_dwordx4 a[148:151], v5, s[8:11], s28 offen offset:1024
    buffer_load_dwordx4 a[152:155], v5, s[8:11], s28 offen offset:2048
    buffer_load_dwordx4 a[156:159], v5, s[8:11], s28 offen offset:3072
    s_add_u32 s28, s25, 40960
    buffer_load_dwordx4 a[160:163], v5, s[8:11], s28 offen offset:0
    buffer_load_dwordx4 a[164:167], v5, s[8:11], s28 offen offset:1024
    s_add_u32 s28, s25, 43008
    buffer_load_dwordx4 a[168:171], v5, s[8:11], s28 offen offset:0
    buffer_load_dwordx4 a[172:175], v5, s[8:11], s28 offen offset:1024
    buffer_load_dwordx4 a[176:179], v5, s[8:11], s28 offen offset:2048
    buffer_load_dwordx4 a[180:183], v5, s[8:11], s28 offen offset:3072
    s_add_u32 s28, s25, 47104
    buffer_load_dwordx4 a[184:187], v5, s[8:11], s28 offen offset:0
    buffer_load_dwordx4 a[188:191], v5, s[8:11], s28 offen offset:1024
    buffer_load_dwordx4 a[192:195], v5, s[8:11], s28 offen offset:2048
    buffer_load_dwordx4 a[196:199], v5, s[8:11], s28 offen offset:3072
    s_add_u32 s28, s25, 51200
    buffer_load_dwordx4 a[200:203], v5, s[8:11], s28 offen offset:0
    buffer_load_dwordx4 a[204:207], v5, s[8:11], s28 offen offset:1024
    buffer_load_dwordx4 a[208:211], v5, s[8:11], s28 offen offset:2048
    buffer_load_dwordx4 a[212:215], v5, s[8:11], s28 offen offset:3072
    s_add_u32 s28, s25, 55296
    buffer_load_dwordx4 a[216:219], v5, s[8:11], s28 offen offset:0
    buffer_load_dwordx4 a[220:223], v5, s[8:11], s28 offen offset:1024
    s_mov_b32 s36, s27
    s_add_u32 s37, s27, 28672
    s_add_u32 s38, s27, 57344
    s_add_u32 s39, s27, 86016
    s_nop 0
    s_mov_b32 m0, s36
    s_add_u32 s29, s26, 4096
    buffer_load_dwordx4 v5, s[8:11], s26 offen offset:0 lds
    buffer_load_dwordx4 v5, s[8:11], s26 offen offset:1024 lds
    buffer_load_dwordx4 v5, s[8:11], s26 offen offset:2048 lds
    buffer_load_dwordx4 v5, s[8:11], s26 offen offset:3072 lds
    s_add_u32 m0, s36, 4096
    s_nop 0
    buffer_load_dwordx4 v5, s[8:11], s29 offen offset:0 lds
    buffer_load_dwordx4 v5, s[8:11], s29 offen offset:1024 lds
    buffer_load_dwordx4 v5, s[8:11], s29 offen offset:2048 lds
    s_add_u32 s26, s26, 28672
    s_mov_b32 m0, s37
    s_add_u32 s29, s26, 4096
    buffer_load_dwordx4 v5, s[8:11], s26 offen offset:0 lds
    buffer_load_dwordx4 v5, s[8:11], s26 offen offset:1024 lds
    buffer_load_dwordx4 v5, s[8:11], s26 offen offset:2048 lds
    buffer_load_dwordx4 v5, s[8:11], s26 offen offset:3072 lds
    s_add_u32 m0, s37, 4096
    s_nop 0
    buffer_load_dwordx4 v5, s[8:11], s29 offen offset:0 lds
    buffer_load_dwordx4 v5, s[8:11], s29 offen offset:1024 lds
    buffer_load_dwordx4 v5, s[8:11], s29 offen offset:2048 lds
    s_add_u32 s26, s26, 28672
    s_mov_b32 m0, s38
    s_add_u32 s29, s26, 4096
    buffer_load_dwordx4 v5, s[8:11], s26 offen offset:0 lds
    buffer_load_dwordx4 v5, s[8:11], s26 offen offset:1024 lds
    buffer_load_dwordx4 v5, s[8:11], s26 offen offset:2048 lds
    buffer_load_dwordx4 v5, s[8:11], s26 offen offset:3072 lds
    s_add_u32 m0, s38, 4096
    s_nop 0
    buffer_load_dwordx4 v5, s[8:11], s29 offen offset:0 lds
    buffer_load_dwordx4 v5, s[8:11], s29 offen offset:1024 lds
    buffer_load_dwordx4 v5, s[8:11], s29 offen offset:2048 lds
    s_add_u32 s26, s26, 28672
    s_lshl_b32 s34, s24, 4
    s_add_u32 s34, s34, s21
    s_mul_i32 s34, s34, 28672
    s_add_u32 s34, s34, 47185920
    s_add_u32 s35, s34, 458752
    s_lshl_b32 s28, s23, 11
    s_add_u32 s34, s34, s28
    s_add_u32 s35, s35, s28
    s_lshl_b32 s30, s2, 2
    s_add_u32 s30, s30, s20
    s_lshl_b32 s30, s30, 11
    s_add_u32 s30, s30, 115343360
    s_mov_b32 s31, s30
    v_mov_b32 v9, v5
    v_add_u32 v10, 57344, v5
    s_waitcnt vmcnt(14)
    s_barrier
    ds_read_b128 v[80:83], v9 offset:0
    ds_read_b128 v[84:87], v9 offset:14336
    ds_read_b128 v[88:91], v9 offset:1024
    ds_read_b128 v[92:95], v9 offset:15360
    ds_read_b128 v[96:99], v9 offset:2048
    ds_read_b128 v[100:103], v9 offset:16384
    s_mov_b32 s40, 0
GT_U_LOOP:
    s_waitcnt lgkmcnt(5)
    ds_read_b128 v[104:107], v9 offset:3072
    v_mfma_f32_16x16x32_bf16 v[16:19], a[0:3], v[80:83], 0
    v_mfma_f32_16x16x32_bf16 v[20:23], a[56:59], v[80:83], 0
    v_mfma_f32_16x16x32_bf16 v[24:27], a[112:115], v[80:83], 0
    v_mfma_f32_16x16x32_bf16 v[28:31], a[168:171], v[80:83], 0
    s_waitcnt lgkmcnt(5)
    ds_read_b128 v[108:111], v9 offset:17408
    v_mfma_f32_16x16x32_bf16 v[32:35], a[0:3], v[84:87], 0
    v_mfma_f32_16x16x32_bf16 v[36:39], a[56:59], v[84:87], 0
    v_mfma_f32_16x16x32_bf16 v[40:43], a[112:115], v[84:87], 0
    v_mfma_f32_16x16x32_bf16 v[44:47], a[168:171], v[84:87], 0
    s_waitcnt lgkmcnt(5)
    ds_read_b128 v[80:83], v9 offset:4096
    v_mfma_f32_16x16x32_bf16 v[16:19], a[4:7], v[88:91], v[16:19]
    v_cvt_pk_bf16_f32 v112, v48, v49
    v_mfma_f32_16x16x32_bf16 v[20:23], a[60:63], v[88:91], v[20:23]
    v_cvt_pk_bf16_f32 v113, v50, v51
    v_mfma_f32_16x16x32_bf16 v[24:27], a[116:119], v[88:91], v[24:27]
    v_cvt_pk_bf16_f32 v114, v52, v53
    v_mfma_f32_16x16x32_bf16 v[28:31], a[172:175], v[88:91], v[28:31]
    v_cvt_pk_bf16_f32 v115, v54, v55
    s_waitcnt lgkmcnt(5)
    ds_read_b128 v[84:87], v9 offset:18432
    v_mfma_f32_16x16x32_bf16 v[32:35], a[4:7], v[92:95], v[32:35]
    buffer_store_dwordx4 v[112:115], v5, s[8:11], s30 offen offset:0 sc1
    v_mfma_f32_16x16x32_bf16 v[36:39], a[60:63], v[92:95], v[36:39]
    v_cvt_pk_bf16_f32 v116, v56, v57
    v_mfma_f32_16x16x32_bf16 v[40:43], a[116:119], v[92:95], v[40:43]
    v_cvt_pk_bf16_f32 v117, v58, v59
    v_mfma_f32_16x16x32_bf16 v[44:47], a[172:175], v[92:95], v[44:47]
    v_cvt_pk_bf16_f32 v118, v60, v61
    s_waitcnt lgkmcnt(5)
    ds_read_b128 v[88:91], v9 offset:5120
    v_mfma_f32_16x16x32_bf16 v[16:19], a[8:11], v[96:99], v[16:19]
    v_cvt_pk_bf16_f32 v119, v62, v63
    v_mfma_f32_16x16x32_bf16 v[20:23], a[64:67], v[96:99], v[20:23]
    buffer_store_dwordx4 v[116:119], v5, s[8:11], s31 offen offset:0 sc1
    v_mfma_f32_16x16x32_bf16 v[24:27], a[120:123], v[96:99], v[24:27]
    v_cvt_pk_bf16_f32 v120, v64, v65
    v_mfma_f32_16x16x32_bf16 v[28:31], a[176:179], v[96:99], v[28:31]
    v_cvt_pk_bf16_f32 v121, v66, v67
    s_waitcnt lgkmcnt(5)
    ds_read_b128 v[92:95], v9 offset:19456
    v_mfma_f32_16x16x32_bf16 v[32:35], a[8:11], v[100:103], v[32:35]
    v_cvt_pk_bf16_f32 v122, v68, v69
    v_mfma_f32_16x16x32_bf16 v[36:39], a[64:67], v[100:103], v[36:39]
    v_cvt_pk_bf16_f32 v123, v70, v71
    v_mfma_f32_16x16x32_bf16 v[40:43], a[120:123], v[100:103], v[40:43]
    buffer_store_dwordx4 v[120:123], v5, s[8:11], s30 offen offset:1024 sc1
    v_mfma_f32_16x16x32_bf16 v[44:47], a[176:179], v[100:103], v[44:47]
    v_cvt_pk_bf16_f32 v124, v72, v73
    s_waitcnt lgkmcnt(5)
    ds_read_b128 v[96:99], v9 offset:6144
    v_mfma_f32_16x16x32_bf16 v[16:19], a[12:15], v[104:107], v[16:19]
    v_cvt_pk_bf16_f32 v125, v74, v75
    v_mfma_f32_16x16x32_bf16 v[20:23], a[68:71], v[104:107], v[20:23]
    v_cvt_pk_bf16_f32 v126, v76, v77
    v_mfma_f32_16x16x32_bf16 v[24:27], a[124:127], v[104:107], v[24:27]
    v_cvt_pk_bf16_f32 v127, v78, v79
    v_mfma_f32_16x16x32_bf16 v[28:31], a[180:183], v[104:107], v[28:31]
    buffer_store_dwordx4 v[124:127], v5, s[8:11], s31 offen offset:1024 sc1
    s_waitcnt lgkmcnt(5)
    ds_read_b128 v[100:103], v9 offset:20480
    v_mfma_f32_16x16x32_bf16 v[32:35], a[12:15], v[108:111], v[32:35]
    v_mfma_f32_16x16x32_bf16 v[36:39], a[68:71], v[108:111], v[36:39]
    v_mfma_f32_16x16x32_bf16 v[40:43], a[124:127], v[108:111], v[40:43]
    v_mfma_f32_16x16x32_bf16 v[44:47], a[180:183], v[108:111], v[44:47]
    s_waitcnt lgkmcnt(5)
    ds_read_b128 v[104:107], v9 offset:7168
    v_mfma_f32_16x16x32_bf16 v[16:19], a[16:19], v[80:83], v[16:19]
    v_mfma_f32_16x16x32_bf16 v[20:23], a[72:75], v[80:83], v[20:23]
    v_mfma_f32_16x16x32_bf16 v[24:27], a[128:131], v[80:83], v[24:27]
    v_mfma_f32_16x16x32_bf16 v[28:31], a[184:187], v[80:83], v[28:31]
    s_add_u32 s30, s30, 2048
    s_add_u32 s31, s31, 2048
    s_cmp_eq_u32 s40, 0
    s_cselect_b32 s30, s34, s30
    s_cselect_b32 s31, s35, s31
    s_waitcnt lgkmcnt(5)
    ds_read_b128 v[108:111], v9 offset:21504
    v_mfma_f32_16x16x32_bf16 v[32:35], a[16:19], v[84:87], v[32:35]
    v_mfma_f32_16x16x32_bf16 v[36:39], a[72:75], v[84:87], v[36:39]
    v_mfma_f32_16x16x32_bf16 v[40:43], a[128:131], v[84:87], v[40:43]
    v_mfma_f32_16x16x32_bf16 v[44:47], a[184:187], v[84:87], v[44:47]
    s_waitcnt lgkmcnt(5)
    ds_read_b128 v[80:83], v9 offset:8192
    v_mfma_f32_16x16x32_bf16 v[16:19], a[20:23], v[88:91], v[16:19]
    v_mfma_f32_16x16x32_bf16 v[20:23], a[76:79], v[88:91], v[20:23]
    v_mfma_f32_16x16x32_bf16 v[24:27], a[132:135], v[88:91], v[24:27]
    v_mfma_f32_16x16x32_bf16 v[28:31], a[188:191], v[88:91], v[28:31]
    s_waitcnt lgkmcnt(5)
    ds_read_b128 v[84:87], v9 offset:22528
    v_mfma_f32_16x16x32_bf16 v[32:35], a[20:23], v[92:95], v[32:35]
    v_mfma_f32_16x16x32_bf16 v[36:39], a[76:79], v[92:95], v[36:39]
    v_mfma_f32_16x16x32_bf16 v[40:43], a[132:135], v[92:95], v[40:43]
    v_mfma_f32_16x16x32_bf16 v[44:47], a[188:191], v[92:95], v[44:47]
    s_waitcnt vmcnt(11)
    s_barrier
    s_mov_b32 m0, s39
    s_add_u32 s29, s26, 4096
    buffer_load_dwordx4 v5, s[8:11], s26 offen offset:0 lds
    buffer_load_dwordx4 v5, s[8:11], s26 offen offset:1024 lds
    buffer_load_dwordx4 v5, s[8:11], s26 offen offset:2048 lds
    buffer_load_dwordx4 v5, s[8:11], s26 offen offset:3072 lds
    s_add_u32 m0, s39, 4096
    s_nop 0
    buffer_load_dwordx4 v5, s[8:11], s29 offen offset:0 lds
    buffer_load_dwordx4 v5, s[8:11], s29 offen offset:1024 lds
    buffer_load_dwordx4 v5, s[8:11], s29 offen offset:2048 lds
    s_add_u32 s26, s26, 28672
    s_waitcnt lgkmcnt(5)
    ds_read_b128 v[88:91], v9 offset:9216
    v_mfma_f32_16x16x32_bf16 v[16:19], a[24:27], v[96:99], v[16:19]
    v_mfma_f32_16x16x32_bf16 v[20:23], a[80:83], v[96:99], v[20:23]
    v_mfma_f32_16x16x32_bf16 v[24:27], a[136:139], v[96:99], v[24:27]
    v_mfma_f32_16x16x32_bf16 v[28:31], a[192:195], v[96:99], v[28:31]
    s_waitcnt lgkmcnt(5)
    ds_read_b128 v[92:95], v9 offset:23552
    v_mfma_f32_16x16x32_bf16 v[32:35], a[24:27], v[100:103], v[32:35]
    v_mfma_f32_16x16x32_bf16 v[36:39], a[80:83], v[100:103], v[36:39]
    v_mfma_f32_16x16x32_bf16 v[40:43], a[136:139], v[100:103], v[40:43]
    v_mfma_f32_16x16x32_bf16 v[44:47], a[192:195], v[100:103], v[44:47]
    s_waitcnt lgkmcnt(5)
    ds_read_b128 v[96:99], v9 offset:10240
    v_mfma_f32_16x16x32_bf16 v[16:19], a[28:31], v[104:107], v[16:19]
    v_mfma_f32_16x16x32_bf16 v[20:23], a[84:87], v[104:107], v[20:23]
    v_mfma_f32_16x16x32_bf16 v[24:27], a[140:143], v[104:107], v[24:27]
    v_mfma_f32_16x16x32_bf16 v[28:31], a[196:199], v[104:107], v[28:31]
    s_waitcnt lgkmcnt(5)
    ds_read_b128 v[100:103], v9 offset:24576
    v_mfma_f32_16x16x32_bf16 v[32:35], a[28:31], v[108:111], v[32:35]
    v_mfma_f32_16x16x32_bf16 v[36:39], a[84:87], v[108:111], v[36:39]
    v_mfma_f32_16x16x32_bf16 v[40:43], a[140:143], v[108:111], v[40:43]
    v_mfma_f32_16x16x32_bf16 v[44:47], a[196:199], v[108:111], v[44:47]
    s_waitcnt lgkmcnt(5)
    ds_read_b128 v[104:107], v9 offset:11264
    v_mfma_f32_16x16x32_bf16 v[16:19], a[32:35], v[80:83], v[16:19]
    v_mfma_f32_16x16x32_bf16 v[20:23], a[88:91], v[80:83], v[20:23]
    v_mfma_f32_16x16x32_bf16 v[24:27], a[144:147], v[80:83], v[24:27]
    v_mfma_f32_16x16x32_bf16 v[28:31], a[200:203], v[80:83], v[28:31]
    s_waitcnt lgkmcnt(5)
    ds_read_b128 v[108:111], v9 offset:25600
    v_mfma_f32_16x16x32_bf16 v[32:35], a[32:35], v[84:87], v[32:35]
    v_mfma_f32_16x16x32_bf16 v[36:39], a[88:91], v[84:87], v[36:39]
    v_mfma_f32_16x16x32_bf16 v[40:43], a[144:147], v[84:87], v[40:43]
    v_mfma_f32_16x16x32_bf16 v[44:47], a[200:203], v[84:87], v[44:47]
    s_waitcnt lgkmcnt(5)
    ds_read_b128 v[80:83], v9 offset:12288
    v_mfma_f32_16x16x32_bf16 v[16:19], a[36:39], v[88:91], v[16:19]
    v_mfma_f32_16x16x32_bf16 v[20:23], a[92:95], v[88:91], v[20:23]
    v_mfma_f32_16x16x32_bf16 v[24:27], a[148:151], v[88:91], v[24:27]
    v_mfma_f32_16x16x32_bf16 v[28:31], a[204:207], v[88:91], v[28:31]
    s_waitcnt lgkmcnt(5)
    ds_read_b128 v[84:87], v9 offset:26624
    v_mfma_f32_16x16x32_bf16 v[32:35], a[36:39], v[92:95], v[32:35]
    v_mfma_f32_16x16x32_bf16 v[36:39], a[92:95], v[92:95], v[36:39]
    v_mfma_f32_16x16x32_bf16 v[40:43], a[148:151], v[92:95], v[40:43]
    v_mfma_f32_16x16x32_bf16 v[44:47], a[204:207], v[92:95], v[44:47]
    s_waitcnt lgkmcnt(5)
    ds_read_b128 v[88:91], v9 offset:13312
    v_mfma_f32_16x16x32_bf16 v[16:19], a[40:43], v[96:99], v[16:19]
    v_mfma_f32_16x16x32_bf16 v[20:23], a[96:99], v[96:99], v[20:23]
    v_mfma_f32_16x16x32_bf16 v[24:27], a[152:155], v[96:99], v[24:27]
    v_mfma_f32_16x16x32_bf16 v[28:31], a[208:211], v[96:99], v[28:31]
    s_waitcnt lgkmcnt(5)
    ds_read_b128 v[92:95], v9 offset:27648
    v_mfma_f32_16x16x32_bf16 v[32:35], a[40:43], v[100:103], v[32:35]
    v_mfma_f32_16x16x32_bf16 v[36:39], a[96:99], v[100:103], v[36:39]
    v_mfma_f32_16x16x32_bf16 v[40:43], a[152:155], v[100:103], v[40:43]
    v_mfma_f32_16x16x32_bf16 v[44:47], a[208:211], v[100:103], v[44:47]
    s_waitcnt lgkmcnt(5)
    ds_read_b128 v[96:99], v9 offset:28672
    v_mfma_f32_16x16x32_bf16 v[16:19], a[44:47], v[104:107], v[16:19]
    v_mfma_f32_16x16x32_bf16 v[20:23], a[100:103], v[104:107], v[20:23]
    v_mfma_f32_16x16x32_bf16 v[24:27], a[156:159], v[104:107], v[24:27]
    v_mfma_f32_16x16x32_bf16 v[28:31], a[212:215], v[104:107], v[28:31]
    s_waitcnt lgkmcnt(5)
    ds_read_b128 v[100:103], v9 offset:43008
    v_mfma_f32_16x16x32_bf16 v[32:35], a[44:47], v[108:111], v[32:35]
    v_mfma_f32_16x16x32_bf16 v[36:39], a[100:103], v[108:111], v[36:39]
    v_mfma_f32_16x16x32_bf16 v[40:43], a[156:159], v[108:111], v[40:43]
    v_mfma_f32_16x16x32_bf16 v[44:47], a[212:215], v[108:111], v[44:47]
    s_waitcnt lgkmcnt(5)
    ds_read_b128 v[104:107], v9 offset:29696
    v_mfma_f32_16x16x32_bf16 v[16:19], a[48:51], v[80:83], v[16:19]
    v_mfma_f32_16x16x32_bf16 v[20:23], a[104:107], v[80:83], v[20:23]
    v_mfma_f32_16x16x32_bf16 v[24:27], a[160:163], v[80:83], v[24:27]
    v_mfma_f32_16x16x32_bf16 v[28:31], a[216:219], v[80:83], v[28:31]
    s_waitcnt lgkmcnt(5)
    ds_read_b128 v[108:111], v9 offset:44032
    v_mfma_f32_16x16x32_bf16 v[32:35], a[48:51], v[84:87], v[32:35]
    v_mfma_f32_16x16x32_bf16 v[36:39], a[104:107], v[84:87], v[36:39]
    v_mfma_f32_16x16x32_bf16 v[40:43], a[160:163], v[84:87], v[40:43]
    v_mfma_f32_16x16x32_bf16 v[44:47], a[216:219], v[84:87], v[44:47]
    s_waitcnt lgkmcnt(5)
    ds_read_b128 v[80:83], v9 offset:30720
    v_mfma_f32_16x16x32_bf16 v[16:19], a[52:55], v[88:91], v[16:19]
    v_mfma_f32_16x16x32_bf16 v[20:23], a[108:111], v[88:91], v[20:23]
    v_mfma_f32_16x16x32_bf16 v[24:27], a[164:167], v[88:91], v[24:27]
    v_mfma_f32_16x16x32_bf16 v[28:31], a[220:223], v[88:91], v[28:31]
    s_waitcnt lgkmcnt(5)
    ds_read_b128 v[84:87], v9 offset:45056
    v_mfma_f32_16x16x32_bf16 v[32:35], a[52:55], v[92:95], v[32:35]
    v_mfma_f32_16x16x32_bf16 v[36:39], a[108:111], v[92:95], v[36:39]
    v_mfma_f32_16x16x32_bf16 v[40:43], a[164:167], v[92:95], v[40:43]
    v_mfma_f32_16x16x32_bf16 v[44:47], a[220:223], v[92:95], v[44:47]
    s_waitcnt lgkmcnt(5)
    ds_read_b128 v[88:91], v9 offset:31744
    v_mfma_f32_16x16x32_bf16 v[48:51], a[0:3], v[96:99], 0
    v_mfma_f32_16x16x32_bf16 v[52:55], a[56:59], v[96:99], 0
    v_mfma_f32_16x16x32_bf16 v[56:59], a[112:115], v[96:99], 0
    v_mfma_f32_16x16x32_bf16 v[60:63], a[168:171], v[96:99], 0
    s_waitcnt lgkmcnt(5)
    ds_read_b128 v[92:95], v9 offset:46080
    v_mfma_f32_16x16x32_bf16 v[64:67], a[0:3], v[100:103], 0
    v_mfma_f32_16x16x32_bf16 v[68:71], a[56:59], v[100:103], 0
    v_mfma_f32_16x16x32_bf16 v[72:75], a[112:115], v[100:103], 0
    v_mfma_f32_16x16x32_bf16 v[76:79], a[168:171], v[100:103], 0
    s_waitcnt lgkmcnt(5)
    ds_read_b128 v[96:99], v9 offset:32768
    v_mfma_f32_16x16x32_bf16 v[48:51], a[4:7], v[104:107], v[48:51]
    v_cvt_pk_bf16_f32 v112, v16, v17
    v_mfma_f32_16x16x32_bf16 v[52:55], a[60:63], v[104:107], v[52:55]
    v_cvt_pk_bf16_f32 v113, v18, v19
    v_mfma_f32_16x16x32_bf16 v[56:59], a[116:119], v[104:107], v[56:59]
    v_cvt_pk_bf16_f32 v114, v20, v21
    v_mfma_f32_16x16x32_bf16 v[60:63], a[172:175], v[104:107], v[60:63]
    v_cvt_pk_bf16_f32 v115, v22, v23
    s_waitcnt lgkmcnt(5)
    ds_read_b128 v[100:103], v9 offset:47104
    v_mfma_f32_16x16x32_bf16 v[64:67], a[4:7], v[108:111], v[64:67]
    buffer_store_dwordx4 v[112:115], v5, s[8:11], s30 offen offset:0 sc1
    v_mfma_f32_16x16x32_bf16 v[68:71], a[60:63], v[108:111], v[68:71]
    v_cvt_pk_bf16_f32 v116, v24, v25
    v_mfma_f32_16x16x32_bf16 v[72:75], a[116:119], v[108:111], v[72:75]
    v_cvt_pk_bf16_f32 v117, v26, v27
    v_mfma_f32_16x16x32_bf16 v[76:79], a[172:175], v[108:111], v[76:79]
    v_cvt_pk_bf16_f32 v118, v28, v29
    s_waitcnt lgkmcnt(5)
    ds_read_b128 v[104:107], v9 offset:33792
    v_mfma_f32_16x16x32_bf16 v[48:51], a[8:11], v[80:83], v[48:51]
    v_cvt_pk_bf16_f32 v119, v30, v31
    v_mfma_f32_16x16x32_bf16 v[52:55], a[64:67], v[80:83], v[52:55]
    buffer_store_dwordx4 v[116:119], v5, s[8:11], s31 offen offset:0 sc1
    v_mfma_f32_16x16x32_bf16 v[56:59], a[120:123], v[80:83], v[56:59]
    v_cvt_pk_bf16_f32 v120, v32, v33
    v_mfma_f32_16x16x32_bf16 v[60:63], a[176:179], v[80:83], v[60:63]
    v_cvt_pk_bf16_f32 v121, v34, v35
    s_waitcnt lgkmcnt(5)
    ds_read_b128 v[108:111], v9 offset:48128
    v_mfma_f32_16x16x32_bf16 v[64:67], a[8:11], v[84:87], v[64:67]
    v_cvt_pk_bf16_f32 v122, v36, v37
    v_mfma_f32_16x16x32_bf16 v[68:71], a[64:67], v[84:87], v[68:71]
    v_cvt_pk_bf16_f32 v123, v38, v39
    v_mfma_f32_16x16x32_bf16 v[72:75], a[120:123], v[84:87], v[72:75]
    buffer_store_dwordx4 v[120:123], v5, s[8:11], s30 offen offset:1024 sc1
    v_mfma_f32_16x16x32_bf16 v[76:79], a[176:179], v[84:87], v[76:79]
    v_cvt_pk_bf16_f32 v124, v40, v41
    s_waitcnt lgkmcnt(5)
    ds_read_b128 v[80:83], v9 offset:34816
    v_mfma_f32_16x16x32_bf16 v[48:51], a[12:15], v[88:91], v[48:51]
    v_cvt_pk_bf16_f32 v125, v42, v43
    v_mfma_f32_16x16x32_bf16 v[52:55], a[68:71], v[88:91], v[52:55]
    v_cvt_pk_bf16_f32 v126, v44, v45
    v_mfma_f32_16x16x32_bf16 v[56:59], a[124:127], v[88:91], v[56:59]
    v_cvt_pk_bf16_f32 v127, v46, v47
    v_mfma_f32_16x16x32_bf16 v[60:63], a[180:183], v[88:91], v[60:63]
    buffer_store_dwordx4 v[124:127], v5, s[8:11], s31 offen offset:1024 sc1
    s_waitcnt lgkmcnt(5)
    ds_read_b128 v[84:87], v9 offset:49152
    v_mfma_f32_16x16x32_bf16 v[64:67], a[12:15], v[92:95], v[64:67]
    v_mfma_f32_16x16x32_bf16 v[68:71], a[68:71], v[92:95], v[68:71]
    v_mfma_f32_16x16x32_bf16 v[72:75], a[124:127], v[92:95], v[72:75]
    v_mfma_f32_16x16x32_bf16 v[76:79], a[180:183], v[92:95], v[76:79]
    s_waitcnt lgkmcnt(5)
    ds_read_b128 v[88:91], v9 offset:35840
    v_mfma_f32_16x16x32_bf16 v[48:51], a[16:19], v[96:99], v[48:51]
    v_mfma_f32_16x16x32_bf16 v[52:55], a[72:75], v[96:99], v[52:55]
    v_mfma_f32_16x16x32_bf16 v[56:59], a[128:131], v[96:99], v[56:59]
    v_mfma_f32_16x16x32_bf16 v[60:63], a[184:187], v[96:99], v[60:63]
    s_add_u32 s30, s30, 2048
    s_add_u32 s31, s31, 2048
    s_waitcnt lgkmcnt(5)
    ds_read_b128 v[92:95], v9 offset:50176
    v_mfma_f32_16x16x32_bf16 v[64:67], a[16:19], v[100:103], v[64:67]
    v_mfma_f32_16x16x32_bf16 v[68:71], a[72:75], v[100:103], v[68:71]
    v_mfma_f32_16x16x32_bf16 v[72:75], a[128:131], v[100:103], v[72:75]
    v_mfma_f32_16x16x32_bf16 v[76:79], a[184:187], v[100:103], v[76:79]
    s_waitcnt lgkmcnt(5)
    ds_read_b128 v[96:99], v9 offset:36864
    v_mfma_f32_16x16x32_bf16 v[48:51], a[20:23], v[104:107], v[48:51]
    v_mfma_f32_16x16x32_bf16 v[52:55], a[76:79], v[104:107], v[52:55]
    v_mfma_f32_16x16x32_bf16 v[56:59], a[132:135], v[104:107], v[56:59]
    v_mfma_f32_16x16x32_bf16 v[60:63], a[188:191], v[104:107], v[60:63]
    s_waitcnt lgkmcnt(5)
    ds_read_b128 v[100:103], v9 offset:51200
    v_mfma_f32_16x16x32_bf16 v[64:67], a[20:23], v[108:111], v[64:67]
    v_mfma_f32_16x16x32_bf16 v[68:71], a[76:79], v[108:111], v[68:71]
    v_mfma_f32_16x16x32_bf16 v[72:75], a[132:135], v[108:111], v[72:75]
    v_mfma_f32_16x16x32_bf16 v[76:79], a[188:191], v[108:111], v[76:79]
    s_waitcnt vmcnt(11)
    s_barrier
    s_mov_b32 m0, s36
    s_add_u32 s29, s26, 4096
    buffer_load_dwordx4 v5, s[8:11], s26 offen offset:0 lds
    buffer_load_dwordx4 v5, s[8:11], s26 offen offset:1024 lds
    buffer_load_dwordx4 v5, s[8:11], s26 offen offset:2048 lds
    buffer_load_dwordx4 v5, s[8:11], s26 offen offset:3072 lds
    s_add_u32 m0, s36, 4096
    s_nop 0
    buffer_load_dwordx4 v5, s[8:11], s29 offen offset:0 lds
    buffer_load_dwordx4 v5, s[8:11], s29 offen offset:1024 lds
    buffer_load_dwordx4 v5, s[8:11], s29 offen offset:2048 lds
    s_add_u32 s26, s26, 28672
    s_waitcnt lgkmcnt(5)
    ds_read_b128 v[104:107], v9 offset:37888
    v_mfma_f32_16x16x32_bf16 v[48:51], a[24:27], v[80:83], v[48:51]
    v_mfma_f32_16x16x32_bf16 v[52:55], a[80:83], v[80:83], v[52:55]
    v_mfma_f32_16x16x32_bf16 v[56:59], a[136:139], v[80:83], v[56:59]
    v_mfma_f32_16x16x32_bf16 v[60:63], a[192:195], v[80:83], v[60:63]
    s_waitcnt lgkmcnt(5)
    ds_read_b128 v[108:111], v9 offset:52224
    v_mfma_f32_16x16x32_bf16 v[64:67], a[24:27], v[84:87], v[64:67]
    v_mfma_f32_16x16x32_bf16 v[68:71], a[80:83], v[84:87], v[68:71]
    v_mfma_f32_16x16x32_bf16 v[72:75], a[136:139], v[84:87], v[72:75]
    v_mfma_f32_16x16x32_bf16 v[76:79], a[192:195], v[84:87], v[76:79]
    s_waitcnt lgkmcnt(5)
    ds_read_b128 v[80:83], v9 offset:38912
    v_mfma_f32_16x16x32_bf16 v[48:51], a[28:31], v[88:91], v[48:51]
    v_mfma_f32_16x16x32_bf16 v[52:55], a[84:87], v[88:91], v[52:55]
    v_mfma_f32_16x16x32_bf16 v[56:59], a[140:143], v[88:91], v[56:59]
    v_mfma_f32_16x16x32_bf16 v[60:63], a[196:199], v[88:91], v[60:63]
    s_waitcnt lgkmcnt(5)
    ds_read_b128 v[84:87], v9 offset:53248
    v_mfma_f32_16x16x32_bf16 v[64:67], a[28:31], v[92:95], v[64:67]
    v_mfma_f32_16x16x32_bf16 v[68:71], a[84:87], v[92:95], v[68:71]
    v_mfma_f32_16x16x32_bf16 v[72:75], a[140:143], v[92:95], v[72:75]
    v_mfma_f32_16x16x32_bf16 v[76:79], a[196:199], v[92:95], v[76:79]
    s_waitcnt lgkmcnt(5)
    ds_read_b128 v[88:91], v9 offset:39936
    v_mfma_f32_16x16x32_bf16 v[48:51], a[32:35], v[96:99], v[48:51]
    v_mfma_f32_16x16x32_bf16 v[52:55], a[88:91], v[96:99], v[52:55]
    v_mfma_f32_16x16x32_bf16 v[56:59], a[144:147], v[96:99], v[56:59]
    v_mfma_f32_16x16x32_bf16 v[60:63], a[200:203], v[96:99], v[60:63]
    s_waitcnt lgkmcnt(5)
    ds_read_b128 v[92:95], v9 offset:54272
    v_mfma_f32_16x16x32_bf16 v[64:67], a[32:35], v[100:103], v[64:67]
    v_mfma_f32_16x16x32_bf16 v[68:71], a[88:91], v[100:103], v[68:71]
    v_mfma_f32_16x16x32_bf16 v[72:75], a[144:147], v[100:103], v[72:75]
    v_mfma_f32_16x16x32_bf16 v[76:79], a[200:203], v[100:103], v[76:79]
    s_waitcnt lgkmcnt(5)
    ds_read_b128 v[96:99], v9 offset:40960
    v_mfma_f32_16x16x32_bf16 v[48:51], a[36:39], v[104:107], v[48:51]
    v_mfma_f32_16x16x32_bf16 v[52:55], a[92:95], v[104:107], v[52:55]
    v_mfma_f32_16x16x32_bf16 v[56:59], a[148:151], v[104:107], v[56:59]
    v_mfma_f32_16x16x32_bf16 v[60:63], a[204:207], v[104:107], v[60:63]
    s_waitcnt lgkmcnt(5)
    ds_read_b128 v[100:103], v9 offset:55296
    v_mfma_f32_16x16x32_bf16 v[64:67], a[36:39], v[108:111], v[64:67]
    v_mfma_f32_16x16x32_bf16 v[68:71], a[92:95], v[108:111], v[68:71]
    v_mfma_f32_16x16x32_bf16 v[72:75], a[148:151], v[108:111], v[72:75]
    v_mfma_f32_16x16x32_bf16 v[76:79], a[204:207], v[108:111], v[76:79]
    s_waitcnt lgkmcnt(5)
    ds_read_b128 v[104:107], v9 offset:41984
    v_mfma_f32_16x16x32_bf16 v[48:51], a[40:43], v[80:83], v[48:51]
    v_mfma_f32_16x16x32_bf16 v[52:55], a[96:99], v[80:83], v[52:55]
    v_mfma_f32_16x16x32_bf16 v[56:59], a[152:155], v[80:83], v[56:59]
    v_mfma_f32_16x16x32_bf16 v[60:63], a[208:211], v[80:83], v[60:63]
    s_waitcnt lgkmcnt(5)
    ds_read_b128 v[108:111], v9 offset:56320
    v_mfma_f32_16x16x32_bf16 v[64:67], a[40:43], v[84:87], v[64:67]
    v_mfma_f32_16x16x32_bf16 v[68:71], a[96:99], v[84:87], v[68:71]
    v_mfma_f32_16x16x32_bf16 v[72:75], a[152:155], v[84:87], v[72:75]
    v_mfma_f32_16x16x32_bf16 v[76:79], a[208:211], v[84:87], v[76:79]
    s_waitcnt lgkmcnt(5)
    ds_read_b128 v[80:83], v10 offset:0
    v_mfma_f32_16x16x32_bf16 v[48:51], a[44:47], v[88:91], v[48:51]
    v_mfma_f32_16x16x32_bf16 v[52:55], a[100:103], v[88:91], v[52:55]
    v_mfma_f32_16x16x32_bf16 v[56:59], a[156:159], v[88:91], v[56:59]
    v_mfma_f32_16x16x32_bf16 v[60:63], a[212:215], v[88:91], v[60:63]
    s_waitcnt lgkmcnt(5)
    ds_read_b128 v[84:87], v10 offset:14336
    v_mfma_f32_16x16x32_bf16 v[64:67], a[44:47], v[92:95], v[64:67]
    v_mfma_f32_16x16x32_bf16 v[68:71], a[100:103], v[92:95], v[68:71]
    v_mfma_f32_16x16x32_bf16 v[72:75], a[156:159], v[92:95], v[72:75]
    v_mfma_f32_16x16x32_bf16 v[76:79], a[212:215], v[92:95], v[76:79]
    s_waitcnt lgkmcnt(5)
    ds_read_b128 v[88:91], v10 offset:1024
    v_mfma_f32_16x16x32_bf16 v[48:51], a[48:51], v[96:99], v[48:51]
    v_mfma_f32_16x16x32_bf16 v[52:55], a[104:107], v[96:99], v[52:55]
    v_mfma_f32_16x16x32_bf16 v[56:59], a[160:163], v[96:99], v[56:59]
    v_mfma_f32_16x16x32_bf16 v[60:63], a[216:219], v[96:99], v[60:63]
    s_waitcnt lgkmcnt(5)
    ds_read_b128 v[92:95], v10 offset:15360
    v_mfma_f32_16x16x32_bf16 v[64:67], a[48:51], v[100:103], v[64:67]
    v_mfma_f32_16x16x32_bf16 v[68:71], a[104:107], v[100:103], v[68:71]
    v_mfma_f32_16x16x32_bf16 v[72:75], a[160:163], v[100:103], v[72:75]
    v_mfma_f32_16x16x32_bf16 v[76:79], a[216:219], v[100:103], v[76:79]
    s_waitcnt lgkmcnt(5)
    ds_read_b128 v[96:99], v10 offset:2048
    v_mfma_f32_16x16x32_bf16 v[48:51], a[52:55], v[104:107], v[48:51]
    v_mfma_f32_16x16x32_bf16 v[52:55], a[108:111], v[104:107], v[52:55]
    v_mfma_f32_16x16x32_bf16 v[56:59], a[164:167], v[104:107], v[56:59]
    v_mfma_f32_16x16x32_bf16 v[60:63], a[220:223], v[104:107], v[60:63]
    s_waitcnt lgkmcnt(5)
    ds_read_b128 v[100:103], v10 offset:16384
    v_mfma_f32_16x16x32_bf16 v[64:67], a[52:55], v[108:111], v[64:67]
    v_mfma_f32_16x16x32_bf16 v[68:71], a[108:111], v[108:111], v[68:71]
    v_mfma_f32_16x16x32_bf16 v[72:75], a[164:167], v[108:111], v[72:75]
    v_mfma_f32_16x16x32_bf16 v[76:79], a[220:223], v[108:111], v[76:79]
    v_mov_b32 v11, v9
    v_mov_b32 v9, v10
    v_mov_b32 v10, v11
    s_mov_b32 s41, s36
    s_mov_b32 s36, s38
    s_mov_b32 s38, s41
    s_mov_b32 s41, s37
    s_mov_b32 s37, s39
    s_mov_b32 s39, s41
    s_add_u32 s40, s40, 1
    s_cmp_lt_u32 s40, s43
    s_cbranch_scc1 GT_U_LOOP
    s_nop 7
    s_nop 7
    v_cvt_pk_bf16_f32 v112, v48, v49
    v_cvt_pk_bf16_f32 v113, v50, v51
    v_cvt_pk_bf16_f32 v114, v52, v53
    v_cvt_pk_bf16_f32 v115, v54, v55
    buffer_store_dwordx4 v[112:115], v5, s[8:11], s30 offen offset:0 sc1
    v_cvt_pk_bf16_f32 v116, v56, v57
    v_cvt_pk_bf16_f32 v117, v58, v59
    v_cvt_pk_bf16_f32 v118, v60, v61
    v_cvt_pk_bf16_f32 v119, v62, v63
    buffer_store_dwordx4 v[116:119], v5, s[8:11], s31 offen offset:0 sc1
    v_cvt_pk_bf16_f32 v120, v64, v65
    v_cvt_pk_bf16_f32 v121, v66, v67
    v_cvt_pk_bf16_f32 v122, v68, v69
    v_cvt_pk_bf16_f32 v123, v70, v71
    buffer_store_dwordx4 v[120:123], v5, s[8:11], s30 offen offset:1024 sc1
    v_cvt_pk_bf16_f32 v124, v72, v73
    v_cvt_pk_bf16_f32 v125, v74, v75
    v_cvt_pk_bf16_f32 v126, v76, v77
    v_cvt_pk_bf16_f32 v127, v78, v79
    buffer_store_dwordx4 v[124:127], v5, s[8:11], s31 offen offset:1024 sc1
    s_waitcnt vmcnt(0) lgkmcnt(0)
    s_barrier
    s_branch K3_TUD
K3_TUD:
    s_cmp_eq_u32 s20, 0
    s_cbranch_scc0 K3_TASK
    v_mov_b32 v12, 1
    v_mov_b32 v13, 0
    s_mov_b64 exec, 1
    buffer_store_dword v12, v13, s[8:11], s44 offen sc1
    s_mov_b64 exec, -1
    s_branch K3_PRED0
K3_TG:
    s_sub_u32 s64, s64, 485
    s_and_b32 s21, s64, 15
    s_lshr_b32 s22, s64, 4
    s_mov_b32 s23, 0
    s_mov_b32 s43, 7
    s_lshl_b32 s24, s22, 3
    s_lshl_b32 s33, s20, 1
    s_add_u32 s24, s24, s33
    s_mul_i32 s25, s24, 28672
    s_add_u32 s25, s25, 0
    s_add_u32 s26, s21, 0
    s_mul_i32 s26, s26, 401408
    s_add_u32 s26, s26, 4194304
    s_mul_i32 s27, s20, 7168
    s_add_u32 s26, s26, s27
    s_mul_i32 s28, s23, 28672
    s_add_u32 s26, s26, s28
    s_add_u32 s28, s25, 0
    buffer_load_dwordx4 a[0:3], v5, s[8:11], s28 offen offset:0
    buffer_load_dwordx4 a[4:7], v5, s[8:11], s28 offen offset:1024
    buffer_load_dwordx4 a[8:11], v5, s[8:11], s28 offen offset:2048
    buffer_load_dwordx4 a[12:15], v5, s[8:11], s28 offen offset:3072
    s_add_u32 s28, s25, 4096
    buffer_load_dwordx4 a[16:19], v5, s[8:11], s28 offen offset:0
    buffer_load_dwordx4 a[20:23], v5, s[8:11], s28 offen offset:1024
    buffer_load_dwordx4 a[24:27], v5, s[8:11], s28 offen offset:2048
    buffer_load_dwordx4 a[28:31], v5, s[8:11], s28 offen offset:3072
    s_add_u32 s28, s25, 8192
    buffer_load_dwordx4 a[32:35], v5, s[8:11], s28 offen offset:0
    buffer_load_dwordx4 a[36:39], v5, s[8:11], s28 offen offset:1024
    buffer_load_dwordx4 a[40:43], v5, s[8:11], s28 offen offset:2048
    buffer_load_dwordx4 a[44:47], v5, s[8:11], s28 offen offset:3072
    s_add_u32 s28, s25, 12288
    buffer_load_dwordx4 a[48:51], v5, s[8:11], s28 offen offset:0
    buffer_load_dwordx4 a[52:55], v5, s[8:11], s28 offen offset:1024
    s_add_u32 s28, s25, 14336
    buffer_load_dwordx4 a[56:59], v5, s[8:11], s28 offen offset:0
    buffer_load_dwordx4 a[60:63], v5, s[8:11], s28 offen offset:1024
    buffer_load_dwordx4 a[64:67], v5, s[8:11], s28 offen offset:2048
    buffer_load_dwordx4 a[68:71], v5, s[8:11], s28 offen offset:3072
    s_add_u32 s28, s25, 18432
    buffer_load_dwordx4 a[72:75], v5, s[8:11], s28 offen offset:0
    buffer_load_dwordx4 a[76:79], v5, s[8:11], s28 offen offset:1024
    buffer_load_dwordx4 a[80:83], v5, s[8:11], s28 offen offset:2048
    buffer_load_dwordx4 a[84:87], v5, s[8:11], s28 offen offset:3072
    s_add_u32 s28, s25, 22528
    buffer_load_dwordx4 a[88:91], v5, s[8:11], s28 offen offset:0
    buffer_load_dwordx4 a[92:95], v5, s[8:11], s28 offen offset:1024
    buffer_load_dwordx4 a[96:99], v5, s[8:11], s28 offen offset:2048
    buffer_load_dwordx4 a[100:103], v5, s[8:11], s28 offen offset:3072
    s_add_u32 s28, s25, 26624
    buffer_load_dwordx4 a[104:107], v5, s[8:11], s28 offen offset:0
    buffer_load_dwordx4 a[108:111], v5, s[8:11], s28 offen offset:1024
    s_add_u32 s28, s25, 28672
    buffer_load_dwordx4 a[112:115], v5, s[8:11], s28 offen offset:0
    buffer_load_dwordx4 a[116:119], v5, s[8:11], s28 offen offset:1024
    buffer_load_dwordx4 a[120:123], v5, s[8:11], s28 offen offset:2048
    buffer_load_dwordx4 a[124:127], v5, s[8:11], s28 offen offset:3072
    s_add_u32 s28, s25, 32768
    buffer_load_dwordx4 a[128:131], v5, s[8:11], s28 offen offset:0
    buffer_load_dwordx4 a[132:135], v5, s[8:11], s28 offen offset:1024
    buffer_load_dwordx4 a[136:139], v5, s[8:11], s28 offen offset:2048
    buffer_load_dwordx4 a[140:143], v5, s[8:11], s28 offen offset:3072
    s_add_u32 s28, s25, 36864
    buffer_load_dwordx4 a[144:147], v5, s[8:11], s28 offen offset:0
    buffer_load_dwordx4 a[148:151], v5, s[8:11], s28 offen offset:1024
    buffer_load_dwordx4 a[152:155], v5, s[8:11], s28 offen offset:2048
    buffer_load_dwordx4 a[156:159], v5, s[8:11], s28 offen offset:3072
    s_add_u32 s28, s25, 40960
    buffer_load_dwordx4 a[160:163], v5, s[8:11], s28 offen offset:0
    buffer_load_dwordx4 a[164:167], v5, s[8:11], s28 offen offset:1024
    s_add_u32 s28, s25, 43008
    buffer_load_dwordx4 a[168:171], v5, s[8:11], s28 offen offset:0
    buffer_load_dwordx4 a[172:175], v5, s[8:11], s28 offen offset:1024
    buffer_load_dwordx4 a[176:179], v5, s[8:11], s28 offen offset:2048
    buffer_load_dwordx4 a[180:183], v5, s[8:11], s28 offen offset:3072
    s_add_u32 s28, s25, 47104
    buffer_load_dwordx4 a[184:187], v5, s[8:11], s28 offen offset:0
    buffer_load_dwordx4 a[188:191], v5, s[8:11], s28 offen offset:1024
    buffer_load_dwordx4 a[192:195], v5, s[8:11], s28 offen offset:2048
    buffer_load_dwordx4 a[196:199], v5, s[8:11], s28 offen offset:3072
    s_add_u32 s28, s25, 51200
    buffer_load_dwordx4 a[200:203], v5, s[8:11], s28 offen offset:0
    buffer_load_dwordx4 a[204:207], v5, s[8:11], s28 offen offset:1024
    buffer_load_dwordx4 a[208:211], v5, s[8:11], s28 offen offset:2048
    buffer_load_dwordx4 a[212:215], v5, s[8:11], s28 offen offset:3072
    s_add_u32 s28, s25, 55296
    buffer_load_dwordx4 a[216:219], v5, s[8:11], s28 offen offset:0
    buffer_load_dwordx4 a[220:223], v5, s[8:11], s28 offen offset:1024
    s_mov_b32 s36, s27
    s_add_u32 s37, s27, 28672
    s_add_u32 s38, s27, 57344
    s_add_u32 s39, s27, 86016
    s_nop 0
    s_mov_b32 m0, s36
    s_add_u32 s29, s26, 4096
    buffer_load_dwordx4 v5, s[8:11], s26 offen offset:0 lds
    buffer_load_dwordx4 v5, s[8:11], s26 offen offset:1024 lds
    buffer_load_dwordx4 v5, s[8:11], s26 offen offset:2048 lds
    buffer_load_dwordx4 v5, s[8:11], s26 offen offset:3072 lds
    s_add_u32 m0, s36, 4096
    s_nop 0
    buffer_load_dwordx4 v5, s[8:11], s29 offen offset:0 lds
    buffer_load_dwordx4 v5, s[8:11], s29 offen offset:1024 lds
    buffer_load_dwordx4 v5, s[8:11], s29 offen offset:2048 lds
    s_add_u32 s26, s26, 28672
    s_mov_b32 m0, s37
    s_add_u32 s29, s26, 4096
    buffer_load_dwordx4 v5, s[8:11], s26 offen offset:0 lds
    buffer_load_dwordx4 v5, s[8:11], s26 offen offset:1024 lds
    buffer_load_dwordx4 v5, s[8:11], s26 offen offset:2048 lds
    buffer_load_dwordx4 v5, s[8:11], s26 offen offset:3072 lds
    s_add_u32 m0, s37, 4096
    s_nop 0
    buffer_load_dwordx4 v5, s[8:11], s29 offen offset:0 lds
    buffer_load_dwordx4 v5, s[8:11], s29 offen offset:1024 lds
    buffer_load_dwordx4 v5, s[8:11], s29 offen offset:2048 lds
    s_add_u32 s26, s26, 28672
    s_mov_b32 m0, s38
    s_add_u32 s29, s26, 4096
    buffer_load_dwordx4 v5, s[8:11], s26 offen offset:0 lds
    buffer_load_dwordx4 v5, s[8:11], s26 offen offset:1024 lds
    buffer_load_dwordx4 v5, s[8:11], s26 offen offset:2048 lds
    buffer_load_dwordx4 v5, s[8:11], s26 offen offset:3072 lds
    s_add_u32 m0, s38, 4096
    s_nop 0
    buffer_load_dwordx4 v5, s[8:11], s29 offen offset:0 lds
    buffer_load_dwordx4 v5, s[8:11], s29 offen offset:1024 lds
    buffer_load_dwordx4 v5, s[8:11], s29 offen offset:2048 lds
    s_add_u32 s26, s26, 28672
    s_lshl_b32 s34, s24, 4
    s_add_u32 s34, s34, s21
    s_mul_i32 s34, s34, 28672
    s_add_u32 s34, s34, 17825792
    s_add_u32 s35, s34, 458752
    s_lshl_b32 s28, s23, 11
    s_add_u32 s34, s34, s28
    s_add_u32 s35, s35, s28
    s_lshl_b32 s30, s2, 2
    s_add_u32 s30, s30, s20
    s_lshl_b32 s30, s30, 11
    s_add_u32 s30, s30, 115343360
    s_mov_b32 s31, s30
    v_mov_b32 v9, v5
    v_add_u32 v10, 57344, v5
    s_waitcnt vmcnt(14)
    s_barrier
    ds_read_b128 v[80:83], v9 offset:0
    ds_read_b128 v[84:87], v9 offset:14336
    ds_read_b128 v[88:91], v9 offset:1024
    ds_read_b128 v[92:95], v9 offset:15360
    ds_read_b128 v[96:99], v9 offset:2048
    ds_read_b128 v[100:103], v9 offset:16384
    s_mov_b32 s40, 0
GT_Q_LOOP:
    s_waitcnt lgkmcnt(5)
    ds_read_b128 v[104:107], v9 offset:3072
    v_mfma_f32_16x16x32_bf16 v[16:19], v[80:83], a[0:3], 0
    v_mfma_f32_16x16x32_bf16 v[20:23], v[80:83], a[56:59], 0
    v_mfma_f32_16x16x32_bf16 v[24:27], v[80:83], a[112:115], 0
    v_mfma_f32_16x16x32_bf16 v[28:31], v[80:83], a[168:171], 0
    s_waitcnt lgkmcnt(5)
    ds_read_b128 v[108:111], v9 offset:17408
    v_mfma_f32_16x16x32_bf16 v[32:35], v[84:87], a[0:3], 0
    v_mfma_f32_16x16x32_bf16 v[36:39], v[84:87], a[56:59], 0
    v_mfma_f32_16x16x32_bf16 v[40:43], v[84:87], a[112:115], 0
    v_mfma_f32_16x16x32_bf16 v[44:47], v[84:87], a[168:171], 0
    s_waitcnt lgkmcnt(5)
    ds_read_b128 v[80:83], v9 offset:4096
    v_mfma_f32_16x16x32_bf16 v[16:19], v[88:91], a[4:7], v[16:19]
    v_cvt_pk_bf16_f32 v112, v48, v49
    v_mfma_f32_16x16x32_bf16 v[20:23], v[88:91], a[60:63], v[20:23]
    v_cvt_pk_bf16_f32 v113, v50, v51
    v_mfma_f32_16x16x32_bf16 v[24:27], v[88:91], a[116:119], v[24:27]
    v_cvt_pk_bf16_f32 v114, v64, v65
    v_mfma_f32_16x16x32_bf16 v[28:31], v[88:91], a[172:175], v[28:31]
    v_cvt_pk_bf16_f32 v115, v66, v67
    s_waitcnt lgkmcnt(5)
    ds_read_b128 v[84:87], v9 offset:18432
    v_mfma_f32_16x16x32_bf16 v[32:35], v[92:95], a[4:7], v[32:35]
    buffer_store_dwordx4 v[112:115], v5, s[8:11], s30 offen offset:0 sc1
    v_mfma_f32_16x16x32_bf16 v[36:39], v[92:95], a[60:63], v[36:39]
    v_cvt_pk_bf16_f32 v116, v52, v53
    v_mfma_f32_16x16x32_bf16 v[40:43], v[92:95], a[116:119], v[40:43]
    v_cvt_pk_bf16_f32 v117, v54, v55
    v_mfma_f32_16x16x32_bf16 v[44:47], v[92:95], a[172:175], v[44:47]
    v_cvt_pk_bf16_f32 v118, v68, v69
    s_waitcnt lgkmcnt(5)
    ds_read_b128 v[88:91], v9 offset:5120
    v_mfma_f32_16x16x32_bf16 v[16:19], v[96:99], a[8:11], v[16:19]
    v_cvt_pk_bf16_f32 v119, v70, v71
    v_mfma_f32_16x16x32_bf16 v[20:23], v[96:99], a[64:67], v[20:23]
    buffer_store_dwordx4 v[116:119], v5, s[8:11], s30 offen offset:1024 sc1
    v_mfma_f32_16x16x32_bf16 v[24:27], v[96:99], a[120:123], v[24:27]
    v_cvt_pk_bf16_f32 v120, v56, v57
    v_mfma_f32_16x16x32_bf16 v[28:31], v[96:99], a[176:179], v[28:31]
    v_cvt_pk_bf16_f32 v121, v58, v59
    s_waitcnt lgkmcnt(5)
    ds_read_b128 v[92:95], v9 offset:19456
    v_mfma_f32_16x16x32_bf16 v[32:35], v[100:103], a[8:11], v[32:35]
    v_cvt_pk_bf16_f32 v122, v72, v73
    v_mfma_f32_16x16x32_bf16 v[36:39], v[100:103], a[64:67], v[36:39]
    v_cvt_pk_bf16_f32 v123, v74, v75
    v_mfma_f32_16x16x32_bf16 v[40:43], v[100:103], a[120:123], v[40:43]
    buffer_store_dwordx4 v[120:123], v5, s[8:11], s31 offen offset:0 sc1
    v_mfma_f32_16x16x32_bf16 v[44:47], v[100:103], a[176:179], v[44:47]
    v_cvt_pk_bf16_f32 v124, v60, v61
    s_waitcnt lgkmcnt(5)
    ds_read_b128 v[96:99], v9 offset:6144
    v_mfma_f32_16x16x32_bf16 v[16:19], v[104:107], a[12:15], v[16:19]
    v_cvt_pk_bf16_f32 v125, v62, v63
    v_mfma_f32_16x16x32_bf16 v[20:23], v[104:107], a[68:71], v[20:23]
    v_cvt_pk_bf16_f32 v126, v76, v77
    v_mfma_f32_16x16x32_bf16 v[24:27], v[104:107], a[124:127], v[24:27]
    v_cvt_pk_bf16_f32 v127, v78, v79
    v_mfma_f32_16x16x32_bf16 v[28:31], v[104:107], a[180:183], v[28:31]
    buffer_store_dwordx4 v[124:127], v5, s[8:11], s31 offen offset:1024 sc1
    s_waitcnt lgkmcnt(5)
    ds_read_b128 v[100:103], v9 offset:20480
    v_mfma_f32_16x16x32_bf16 v[32:35], v[108:111], a[12:15], v[32:35]
    v_mfma_f32_16x16x32_bf16 v[36:39], v[108:111], a[68:71], v[36:39]
    v_mfma_f32_16x16x32_bf16 v[40:43], v[108:111], a[124:127], v[40:43]
    v_mfma_f32_16x16x32_bf16 v[44:47], v[108:111], a[180:183], v[44:47]
    s_waitcnt lgkmcnt(5)
    ds_read_b128 v[104:107], v9 offset:7168
    v_mfma_f32_16x16x32_bf16 v[16:19], v[80:83], a[16:19], v[16:19]
    v_mfma_f32_16x16x32_bf16 v[20:23], v[80:83], a[72:75], v[20:23]
    v_mfma_f32_16x16x32_bf16 v[24:27], v[80:83], a[128:131], v[24:27]
    v_mfma_f32_16x16x32_bf16 v[28:31], v[80:83], a[184:187], v[28:31]
    s_add_u32 s30, s30, 2048
    s_add_u32 s31, s31, 2048
    s_cmp_eq_u32 s40, 0
    s_cselect_b32 s30, s34, s30
    s_cselect_b32 s31, s35, s31
    s_waitcnt lgkmcnt(5)
    ds_read_b128 v[108:111], v9 offset:21504
    v_mfma_f32_16x16x32_bf16 v[32:35], v[84:87], a[16:19], v[32:35]
    v_mfma_f32_16x16x32_bf16 v[36:39], v[84:87], a[72:75], v[36:39]
    v_mfma_f32_16x16x32_bf16 v[40:43], v[84:87], a[128:131], v[40:43]
    v_mfma_f32_16x16x32_bf16 v[44:47], v[84:87], a[184:187], v[44:47]
    s_waitcnt lgkmcnt(5)
    ds_read_b128 v[80:83], v9 offset:8192
    v_mfma_f32_16x16x32_bf16 v[16:19], v[88:91], a[20:23], v[16:19]
    v_mfma_f32_16x16x32_bf16 v[20:23], v[88:91], a[76:79], v[20:23]
    v_mfma_f32_16x16x32_bf16 v[24:27], v[88:91], a[132:135], v[24:27]
    v_mfma_f32_16x16x32_bf16 v[28:31], v[88:91], a[188:191], v[28:31]
    s_waitcnt lgkmcnt(5)
    ds_read_b128 v[84:87], v9 offset:22528
    v_mfma_f32_16x16x32_bf16 v[32:35], v[92:95], a[20:23], v[32:35]
    v_mfma_f32_16x16x32_bf16 v[36:39], v[92:95], a[76:79], v[36:39]
    v_mfma_f32_16x16x32_bf16 v[40:43], v[92:95], a[132:135], v[40:43]
    v_mfma_f32_16x16x32_bf16 v[44:47], v[92:95], a[188:191], v[44:47]
    s_waitcnt vmcnt(11)
    s_barrier
    s_mov_b32 m0, s39
    s_add_u32 s29, s26, 4096
    buffer_load_dwordx4 v5, s[8:11], s26 offen offset:0 lds
    buffer_load_dwordx4 v5, s[8:11], s26 offen offset:1024 lds
    buffer_load_dwordx4 v5, s[8:11], s26 offen offset:2048 lds
    buffer_load_dwordx4 v5, s[8:11], s26 offen offset:3072 lds
    s_add_u32 m0, s39, 4096
    s_nop 0
    buffer_load_dwordx4 v5, s[8:11], s29 offen offset:0 lds
    buffer_load_dwordx4 v5, s[8:11], s29 offen offset:1024 lds
    buffer_load_dwordx4 v5, s[8:11], s29 offen offset:2048 lds
    s_add_u32 s26, s26, 28672
    s_waitcnt lgkmcnt(5)
    ds_read_b128 v[88:91], v9 offset:9216
    v_mfma_f32_16x16x32_bf16 v[16:19], v[96:99], a[24:27], v[16:19]
    v_mfma_f32_16x16x32_bf16 v[20:23], v[96:99], a[80:83], v[20:23]
    v_mfma_f32_16x16x32_bf16 v[24:27], v[96:99], a[136:139], v[24:27]
    v_mfma_f32_16x16x32_bf16 v[28:31], v[96:99], a[192:195], v[28:31]
    s_waitcnt lgkmcnt(5)
    ds_read_b128 v[92:95], v9 offset:23552
    v_mfma_f32_16x16x32_bf16 v[32:35], v[100:103], a[24:27], v[32:35]
    v_mfma_f32_16x16x32_bf16 v[36:39], v[100:103], a[80:83], v[36:39]
    v_mfma_f32_16x16x32_bf16 v[40:43], v[100:103], a[136:139], v[40:43]
    v_mfma_f32_16x16x32_bf16 v[44:47], v[100:103], a[192:195], v[44:47]
    s_waitcnt lgkmcnt(5)
    ds_read_b128 v[96:99], v9 offset:10240
    v_mfma_f32_16x16x32_bf16 v[16:19], v[104:107], a[28:31], v[16:19]
    v_mfma_f32_16x16x32_bf16 v[20:23], v[104:107], a[84:87], v[20:23]
    v_mfma_f32_16x16x32_bf16 v[24:27], v[104:107], a[140:143], v[24:27]
    v_mfma_f32_16x16x32_bf16 v[28:31], v[104:107], a[196:199], v[28:31]
    s_waitcnt lgkmcnt(5)
    ds_read_b128 v[100:103], v9 offset:24576
    v_mfma_f32_16x16x32_bf16 v[32:35], v[108:111], a[28:31], v[32:35]
    v_mfma_f32_16x16x32_bf16 v[36:39], v[108:111], a[84:87], v[36:39]
    v_mfma_f32_16x16x32_bf16 v[40:43], v[108:111], a[140:143], v[40:43]
    v_mfma_f32_16x16x32_bf16 v[44:47], v[108:111], a[196:199], v[44:47]
    s_waitcnt lgkmcnt(5)
    ds_read_b128 v[104:107], v9 offset:11264
    v_mfma_f32_16x16x32_bf16 v[16:19], v[80:83], a[32:35], v[16:19]
    v_mfma_f32_16x16x32_bf16 v[20:23], v[80:83], a[88:91], v[20:23]
    v_mfma_f32_16x16x32_bf16 v[24:27], v[80:83], a[144:147], v[24:27]
    v_mfma_f32_16x16x32_bf16 v[28:31], v[80:83], a[200:203], v[28:31]
    s_waitcnt lgkmcnt(5)
    ds_read_b128 v[108:111], v9 offset:25600
    v_mfma_f32_16x16x32_bf16 v[32:35], v[84:87], a[32:35], v[32:35]
    v_mfma_f32_16x16x32_bf16 v[36:39], v[84:87], a[88:91], v[36:39]
    v_mfma_f32_16x16x32_bf16 v[40:43], v[84:87], a[144:147], v[40:43]
    v_mfma_f32_16x16x32_bf16 v[44:47], v[84:87], a[200:203], v[44:47]
    s_waitcnt lgkmcnt(5)
    ds_read_b128 v[80:83], v9 offset:12288
    v_mfma_f32_16x16x32_bf16 v[16:19], v[88:91], a[36:39], v[16:19]
    v_mfma_f32_16x16x32_bf16 v[20:23], v[88:91], a[92:95], v[20:23]
    v_mfma_f32_16x16x32_bf16 v[24:27], v[88:91], a[148:151], v[24:27]
    v_mfma_f32_16x16x32_bf16 v[28:31], v[88:91], a[204:207], v[28:31]
    s_waitcnt lgkmcnt(5)
    ds_read_b128 v[84:87], v9 offset:26624
    v_mfma_f32_16x16x32_bf16 v[32:35], v[92:95], a[36:39], v[32:35]
    v_mfma_f32_16x16x32_bf16 v[36:39], v[92:95], a[92:95], v[36:39]
    v_mfma_f32_16x16x32_bf16 v[40:43], v[92:95], a[148:151], v[40:43]
    v_mfma_f32_16x16x32_bf16 v[44:47], v[92:95], a[204:207], v[44:47]
    s_waitcnt lgkmcnt(5)
    ds_read_b128 v[88:91], v9 offset:13312
    v_mfma_f32_16x16x32_bf16 v[16:19], v[96:99], a[40:43], v[16:19]
    v_mfma_f32_16x16x32_bf16 v[20:23], v[96:99], a[96:99], v[20:23]
    v_mfma_f32_16x16x32_bf16 v[24:27], v[96:99], a[152:155], v[24:27]
    v_mfma_f32_16x16x32_bf16 v[28:31], v[96:99], a[208:211], v[28:31]
    s_waitcnt lgkmcnt(5)
    ds_read_b128 v[92:95], v9 offset:27648
    v_mfma_f32_16x16x32_bf16 v[32:35], v[100:103], a[40:43], v[32:35]
    v_mfma_f32_16x16x32_bf16 v[36:39], v[100:103], a[96:99], v[36:39]
    v_mfma_f32_16x16x32_bf16 v[40:43], v[100:103], a[152:155], v[40:43]
    v_mfma_f32_16x16x32_bf16 v[44:47], v[100:103], a[208:211], v[44:47]
    s_waitcnt lgkmcnt(5)
    ds_read_b128 v[96:99], v9 offset:28672
    v_mfma_f32_16x16x32_bf16 v[16:19], v[104:107], a[44:47], v[16:19]
    v_mfma_f32_16x16x32_bf16 v[20:23], v[104:107], a[100:103], v[20:23]
    v_mfma_f32_16x16x32_bf16 v[24:27], v[104:107], a[156:159], v[24:27]
    v_mfma_f32_16x16x32_bf16 v[28:31], v[104:107], a[212:215], v[28:31]
    s_waitcnt lgkmcnt(5)
    ds_read_b128 v[100:103], v9 offset:43008
    v_mfma_f32_16x16x32_bf16 v[32:35], v[108:111], a[44:47], v[32:35]
    v_mfma_f32_16x16x32_bf16 v[36:39], v[108:111], a[100:103], v[36:39]
    v_mfma_f32_16x16x32_bf16 v[40:43], v[108:111], a[156:159], v[40:43]
    v_mfma_f32_16x16x32_bf16 v[44:47], v[108:111], a[212:215], v[44:47]
    s_waitcnt lgkmcnt(5)
    ds_read_b128 v[104:107], v9 offset:29696
    v_mfma_f32_16x16x32_bf16 v[16:19], v[80:83], a[48:51], v[16:19]
    v_mfma_f32_16x16x32_bf16 v[20:23], v[80:83], a[104:107], v[20:23]
    v_mfma_f32_16x16x32_bf16 v[24:27], v[80:83], a[160:163], v[24:27]
    v_mfma_f32_16x16x32_bf16 v[28:31], v[80:83], a[216:219], v[28:31]
    s_waitcnt lgkmcnt(5)
    ds_read_b128 v[108:111], v9 offset:44032
    v_mfma_f32_16x16x32_bf16 v[32:35], v[84:87], a[48:51], v[32:35]
    v_mfma_f32_16x16x32_bf16 v[36:39], v[84:87], a[104:107], v[36:39]
    v_mfma_f32_16x16x32_bf16 v[40:43], v[84:87], a[160:163], v[40:43]
    v_mfma_f32_16x16x32_bf16 v[44:47], v[84:87], a[216:219], v[44:47]
    s_waitcnt lgkmcnt(5)
    ds_read_b128 v[80:83], v9 offset:30720
    v_mfma_f32_16x16x32_bf16 v[16:19], v[88:91], a[52:55], v[16:19]
    v_mfma_f32_16x16x32_bf16 v[20:23], v[88:91], a[108:111], v[20:23]
    v_mfma_f32_16x16x32_bf16 v[24:27], v[88:91], a[164:167], v[24:27]
    v_mfma_f32_16x16x32_bf16 v[28:31], v[88:91], a[220:223], v[28:31]
    s_waitcnt lgkmcnt(5)
    ds_read_b128 v[84:87], v9 offset:45056
    v_mfma_f32_16x16x32_bf16 v[32:35], v[92:95], a[52:55], v[32:35]
    v_mfma_f32_16x16x32_bf16 v[36:39], v[92:95], a[108:111], v[36:39]
    v_mfma_f32_16x16x32_bf16 v[40:43], v[92:95], a[164:167], v[40:43]
    v_mfma_f32_16x16x32_bf16 v[44:47], v[92:95], a[220:223], v[44:47]
    s_waitcnt lgkmcnt(5)
    ds_read_b128 v[88:91], v9 offset:31744
    v_mfma_f32_16x16x32_bf16 v[48:51], v[96:99], a[0:3], 0
    v_mfma_f32_16x16x32_bf16 v[52:55], v[96:99], a[56:59], 0
    v_mfma_f32_16x16x32_bf16 v[56:59], v[96:99], a[112:115], 0
    v_mfma_f32_16x16x32_bf16 v[60:63], v[96:99], a[168:171], 0
    s_waitcnt lgkmcnt(5)
    ds_read_b128 v[92:95], v9 offset:46080
    v_mfma_f32_16x16x32_bf16 v[64:67], v[100:103], a[0:3], 0
    v_mfma_f32_16x16x32_bf16 v[68:71], v[100:103], a[56:59], 0
    v_mfma_f32_16x16x32_bf16 v[72:75], v[100:103], a[112:115], 0
    v_mfma_f32_16x16x32_bf16 v[76:79], v[100:103], a[168:171], 0
    s_waitcnt lgkmcnt(5)
    ds_read_b128 v[96:99], v9 offset:32768
    v_mfma_f32_16x16x32_bf16 v[48:51], v[104:107], a[4:7], v[48:51]
    v_cvt_pk_bf16_f32 v112, v16, v17
    v_mfma_f32_16x16x32_bf16 v[52:55], v[104:107], a[60:63], v[52:55]
    v_cvt_pk_bf16_f32 v113, v18, v19
    v_mfma_f32_16x16x32_bf16 v[56:59], v[104:107], a[116:119], v[56:59]
    v_cvt_pk_bf16_f32 v114, v32, v33
    v_mfma_f32_16x16x32_bf16 v[60:63], v[104:107], a[172:175], v[60:63]
    v_cvt_pk_bf16_f32 v115, v34, v35
    s_waitcnt lgkmcnt(5)
    ds_read_b128 v[100:103], v9 offset:47104
    v_mfma_f32_16x16x32_bf16 v[64:67], v[108:111], a[4:7], v[64:67]
    buffer_store_dwordx4 v[112:115], v5, s[8:11], s30 offen offset:0 sc1
    v_mfma_f32_16x16x32_bf16 v[68:71], v[108:111], a[60:63], v[68:71]
    v_cvt_pk_bf16_f32 v116, v20, v21
    v_mfma_f32_16x16x32_bf16 v[72:75], v[108:111], a[116:119], v[72:75]
    v_cvt_pk_bf16_f32 v117, v22, v23
    v_mfma_f32_16x16x32_bf16 v[76:79], v[108:111], a[172:175], v[76:79]
    v_cvt_pk_bf16_f32 v118, v36, v37
    s_waitcnt lgkmcnt(5)
    ds_read_b128 v[104:107], v9 offset:33792
    v_mfma_f32_16x16x32_bf16 v[48:51], v[80:83], a[8:11], v[48:51]
    v_cvt_pk_bf16_f32 v119, v38, v39
    v_mfma_f32_16x16x32_bf16 v[52:55], v[80:83], a[64:67], v[52:55]
    buffer_store_dwordx4 v[116:119], v5, s[8:11], s30 offen offset:1024 sc1
    v_mfma_f32_16x16x32_bf16 v[56:59], v[80:83], a[120:123], v[56:59]
    v_cvt_pk_bf16_f32 v120, v24, v25
    v_mfma_f32_16x16x32_bf16 v[60:63], v[80:83], a[176:179], v[60:63]
    v_cvt_pk_bf16_f32 v121, v26, v27
    s_waitcnt lgkmcnt(5)
    ds_read_b128 v[108:111], v9 offset:48128
    v_mfma_f32_16x16x32_bf16 v[64:67], v[84:87], a[8:11], v[64:67]
    v_cvt_pk_bf16_f32 v122, v40, v41
    v_mfma_f32_16x16x32_bf16 v[68:71], v[84:87], a[64:67], v[68:71]
    v_cvt_pk_bf16_f32 v123, v42, v43
    v_mfma_f32_16x16x32_bf16 v[72:75], v[84:87], a[120:123], v[72:75]
    buffer_store_dwordx4 v[120:123], v5, s[8:11], s31 offen offset:0 sc1
    v_mfma_f32_16x16x32_bf16 v[76:79], v[84:87], a[176:179], v[76:79]
    v_cvt_pk_bf16_f32 v124, v28, v29
    s_waitcnt lgkmcnt(5)
    ds_read_b128 v[80:83], v9 offset:34816
    v_mfma_f32_16x16x32_bf16 v[48:51], v[88:91], a[12:15], v[48:51]
    v_cvt_pk_bf16_f32 v125, v30, v31
    v_mfma_f32_16x16x32_bf16 v[52:55], v[88:91], a[68:71], v[52:55]
    v_cvt_pk_bf16_f32 v126, v44, v45
    v_mfma_f32_16x16x32_bf16 v[56:59], v[88:91], a[124:127], v[56:59]
    v_cvt_pk_bf16_f32 v127, v46, v47
    v_mfma_f32_16x16x32_bf16 v[60:63], v[88:91], a[180:183], v[60:63]
    buffer_store_dwordx4 v[124:127], v5, s[8:11], s31 offen offset:1024 sc1
    s_waitcnt lgkmcnt(5)
    ds_read_b128 v[84:87], v9 offset:49152
    v_mfma_f32_16x16x32_bf16 v[64:67], v[92:95], a[12:15], v[64:67]
    v_mfma_f32_16x16x32_bf16 v[68:71], v[92:95], a[68:71], v[68:71]
    v_mfma_f32_16x16x32_bf16 v[72:75], v[92:95], a[124:127], v[72:75]
    v_mfma_f32_16x16x32_bf16 v[76:79], v[92:95], a[180:183], v[76:79]
    s_waitcnt lgkmcnt(5)
    ds_read_b128 v[88:91], v9 offset:35840
    v_mfma_f32_16x16x32_bf16 v[48:51], v[96:99], a[16:19], v[48:51]
    v_mfma_f32_16x16x32_bf16 v[52:55], v[96:99], a[72:75], v[52:55]
    v_mfma_f32_16x16x32_bf16 v[56:59], v[96:99], a[128:131], v[56:59]
    v_mfma_f32_16x16x32_bf16 v[60:63], v[96:99], a[184:187], v[60:63]
    s_add_u32 s30, s30, 2048
    s_add_u32 s31, s31, 2048
    s_waitcnt lgkmcnt(5)
    ds_read_b128 v[92:95], v9 offset:50176
    v_mfma_f32_16x16x32_bf16 v[64:67], v[100:103], a[16:19], v[64:67]
    v_mfma_f32_16x16x32_bf16 v[68:71], v[100:103], a[72:75], v[68:71]
    v_mfma_f32_16x16x32_bf16 v[72:75], v[100:103], a[128:131], v[72:75]
    v_mfma_f32_16x16x32_bf16 v[76:79], v[100:103], a[184:187], v[76:79]
    s_waitcnt lgkmcnt(5)
    ds_read_b128 v[96:99], v9 offset:36864
    v_mfma_f32_16x16x32_bf16 v[48:51], v[104:107], a[20:23], v[48:51]
    v_mfma_f32_16x16x32_bf16 v[52:55], v[104:107], a[76:79], v[52:55]
    v_mfma_f32_16x16x32_bf16 v[56:59], v[104:107], a[132:135], v[56:59]
    v_mfma_f32_16x16x32_bf16 v[60:63], v[104:107], a[188:191], v[60:63]
    s_waitcnt lgkmcnt(5)
    ds_read_b128 v[100:103], v9 offset:51200
    v_mfma_f32_16x16x32_bf16 v[64:67], v[108:111], a[20:23], v[64:67]
    v_mfma_f32_16x16x32_bf16 v[68:71], v[108:111], a[76:79], v[68:71]
    v_mfma_f32_16x16x32_bf16 v[72:75], v[108:111], a[132:135], v[72:75]
    v_mfma_f32_16x16x32_bf16 v[76:79], v[108:111], a[188:191], v[76:79]
    s_waitcnt vmcnt(11)
    s_barrier
    s_mov_b32 m0, s36
    s_add_u32 s29, s26, 4096
    buffer_load_dwordx4 v5, s[8:11], s26 offen offset:0 lds
    buffer_load_dwordx4 v5, s[8:11], s26 offen offset:1024 lds
    buffer_load_dwordx4 v5, s[8:11], s26 offen offset:2048 lds
    buffer_load_dwordx4 v5, s[8:11], s26 offen offset:3072 lds
    s_add_u32 m0, s36, 4096
    s_nop 0
    buffer_load_dwordx4 v5, s[8:11], s29 offen offset:0 lds
    buffer_load_dwordx4 v5, s[8:11], s29 offen offset:1024 lds
    buffer_load_dwordx4 v5, s[8:11], s29 offen offset:2048 lds
    s_add_u32 s26, s26, 28672
    s_waitcnt lgkmcnt(5)
    ds_read_b128 v[104:107], v9 offset:37888
    v_mfma_f32_16x16x32_bf16 v[48:51], v[80:83], a[24:27], v[48:51]
    v_mfma_f32_16x16x32_bf16 v[52:55], v[80:83], a[80:83], v[52:55]
    v_mfma_f32_16x16x32_bf16 v[56:59], v[80:83], a[136:139], v[56:59]
    v_mfma_f32_16x16x32_bf16 v[60:63], v[80:83], a[192:195], v[60:63]
    s_waitcnt lgkmcnt(5)
    ds_read_b128 v[108:111], v9 offset:52224
    v_mfma_f32_16x16x32_bf16 v[64:67], v[84:87], a[24:27], v[64:67]
    v_mfma_f32_16x16x32_bf16 v[68:71], v[84:87], a[80:83], v[68:71]
    v_mfma_f32_16x16x32_bf16 v[72:75], v[84:87], a[136:139], v[72:75]
    v_mfma_f32_16x16x32_bf16 v[76:79], v[84:87], a[192:195], v[76:79]
    s_waitcnt lgkmcnt(5)
    ds_read_b128 v[80:83], v9 offset:38912
    v_mfma_f32_16x16x32_bf16 v[48:51], v[88:91], a[28:31], v[48:51]
    v_mfma_f32_16x16x32_bf16 v[52:55], v[88:91], a[84:87], v[52:55]
    v_mfma_f32_16x16x32_bf16 v[56:59], v[88:91], a[140:143], v[56:59]
    v_mfma_f32_16x16x32_bf16 v[60:63], v[88:91], a[196:199], v[60:63]
    s_waitcnt lgkmcnt(5)
    ds_read_b128 v[84:87], v9 offset:53248
    v_mfma_f32_16x16x32_bf16 v[64:67], v[92:95], a[28:31], v[64:67]
    v_mfma_f32_16x16x32_bf16 v[68:71], v[92:95], a[84:87], v[68:71]
    v_mfma_f32_16x16x32_bf16 v[72:75], v[92:95], a[140:143], v[72:75]
    v_mfma_f32_16x16x32_bf16 v[76:79], v[92:95], a[196:199], v[76:79]
    s_waitcnt lgkmcnt(5)
    ds_read_b128 v[88:91], v9 offset:39936
    v_mfma_f32_16x16x32_bf16 v[48:51], v[96:99], a[32:35], v[48:51]
    v_mfma_f32_16x16x32_bf16 v[52:55], v[96:99], a[88:91], v[52:55]
    v_mfma_f32_16x16x32_bf16 v[56:59], v[96:99], a[144:147], v[56:59]
    v_mfma_f32_16x16x32_bf16 v[60:63], v[96:99], a[200:203], v[60:63]
    s_waitcnt lgkmcnt(5)
    ds_read_b128 v[92:95], v9 offset:54272
    v_mfma_f32_16x16x32_bf16 v[64:67], v[100:103], a[32:35], v[64:67]
    v_mfma_f32_16x16x32_bf16 v[68:71], v[100:103], a[88:91], v[68:71]
    v_mfma_f32_16x16x32_bf16 v[72:75], v[100:103], a[144:147], v[72:75]
    v_mfma_f32_16x16x32_bf16 v[76:79], v[100:103], a[200:203], v[76:79]
    s_waitcnt lgkmcnt(5)
    ds_read_b128 v[96:99], v9 offset:40960
    v_mfma_f32_16x16x32_bf16 v[48:51], v[104:107], a[36:39], v[48:51]
    v_mfma_f32_16x16x32_bf16 v[52:55], v[104:107], a[92:95], v[52:55]
    v_mfma_f32_16x16x32_bf16 v[56:59], v[104:107], a[148:151], v[56:59]
    v_mfma_f32_16x16x32_bf16 v[60:63], v[104:107], a[204:207], v[60:63]
    s_waitcnt lgkmcnt(5)
    ds_read_b128 v[100:103], v9 offset:55296
    v_mfma_f32_16x16x32_bf16 v[64:67], v[108:111], a[36:39], v[64:67]
    v_mfma_f32_16x16x32_bf16 v[68:71], v[108:111], a[92:95], v[68:71]
    v_mfma_f32_16x16x32_bf16 v[72:75], v[108:111], a[148:151], v[72:75]
    v_mfma_f32_16x16x32_bf16 v[76:79], v[108:111], a[204:207], v[76:79]
    s_waitcnt lgkmcnt(5)
    ds_read_b128 v[104:107], v9 offset:41984
    v_mfma_f32_16x16x32_bf16 v[48:51], v[80:83], a[40:43], v[48:51]
    v_mfma_f32_16x16x32_bf16 v[52:55], v[80:83], a[96:99], v[52:55]
    v_mfma_f32_16x16x32_bf16 v[56:59], v[80:83], a[152:155], v[56:59]
    v_mfma_f32_16x16x32_bf16 v[60:63], v[80:83], a[208:211], v[60:63]
    s_waitcnt lgkmcnt(5)
    ds_read_b128 v[108:111], v9 offset:56320
    v_mfma_f32_16x16x32_bf16 v[64:67], v[84:87], a[40:43], v[64:67]
    v_mfma_f32_16x16x32_bf16 v[68:71], v[84:87], a[96:99], v[68:71]
    v_mfma_f32_16x16x32_bf16 v[72:75], v[84:87], a[152:155], v[72:75]
    v_mfma_f32_16x16x32_bf16 v[76:79], v[84:87], a[208:211], v[76:79]
    s_waitcnt lgkmcnt(5)
    ds_read_b128 v[80:83], v10 offset:0
    v_mfma_f32_16x16x32_bf16 v[48:51], v[88:91], a[44:47], v[48:51]
    v_mfma_f32_16x16x32_bf16 v[52:55], v[88:91], a[100:103], v[52:55]
    v_mfma_f32_16x16x32_bf16 v[56:59], v[88:91], a[156:159], v[56:59]
    v_mfma_f32_16x16x32_bf16 v[60:63], v[88:91], a[212:215], v[60:63]
    s_waitcnt lgkmcnt(5)
    ds_read_b128 v[84:87], v10 offset:14336
    v_mfma_f32_16x16x32_bf16 v[64:67], v[92:95], a[44:47], v[64:67]
    v_mfma_f32_16x16x32_bf16 v[68:71], v[92:95], a[100:103], v[68:71]
    v_mfma_f32_16x16x32_bf16 v[72:75], v[92:95], a[156:159], v[72:75]
    v_mfma_f32_16x16x32_bf16 v[76:79], v[92:95], a[212:215], v[76:79]
    s_waitcnt lgkmcnt(5)
    ds_read_b128 v[88:91], v10 offset:1024
    v_mfma_f32_16x16x32_bf16 v[48:51], v[96:99], a[48:51], v[48:51]
    v_mfma_f32_16x16x32_bf16 v[52:55], v[96:99], a[104:107], v[52:55]
    v_mfma_f32_16x16x32_bf16 v[56:59], v[96:99], a[160:163], v[56:59]
    v_mfma_f32_16x16x32_bf16 v[60:63], v[96:99], a[216:219], v[60:63]
    s_waitcnt lgkmcnt(5)
    ds_read_b128 v[92:95], v10 offset:15360
    v_mfma_f32_16x16x32_bf16 v[64:67], v[100:103], a[48:51], v[64:67]
    v_mfma_f32_16x16x32_bf16 v[68:71], v[100:103], a[104:107], v[68:71]
    v_mfma_f32_16x16x32_bf16 v[72:75], v[100:103], a[160:163], v[72:75]
    v_mfma_f32_16x16x32_bf16 v[76:79], v[100:103], a[216:219], v[76:79]
    s_waitcnt lgkmcnt(5)
    ds_read_b128 v[96:99], v10 offset:2048
    v_mfma_f32_16x16x32_bf16 v[48:51], v[104:107], a[52:55], v[48:51]
    v_mfma_f32_16x16x32_bf16 v[52:55], v[104:107], a[108:111], v[52:55]
    v_mfma_f32_16x16x32_bf16 v[56:59], v[104:107], a[164:167], v[56:59]
    v_mfma_f32_16x16x32_bf16 v[60:63], v[104:107], a[220:223], v[60:63]
    s_waitcnt lgkmcnt(5)
    ds_read_b128 v[100:103], v10 offset:16384
    v_mfma_f32_16x16x32_bf16 v[64:67], v[108:111], a[52:55], v[64:67]
    v_mfma_f32_16x16x32_bf16 v[68:71], v[108:111], a[108:111], v[68:71]
    v_mfma_f32_16x16x32_bf16 v[72:75], v[108:111], a[164:167], v[72:75]
    v_mfma_f32_16x16x32_bf16 v[76:79], v[108:111], a[220:223], v[76:79]
    v_mov_b32 v11, v9
    v_mov_b32 v9, v10
    v_mov_b32 v10, v11
    s_mov_b32 s41, s36
    s_mov_b32 s36, s38
    s_mov_b32 s38, s41
    s_mov_b32 s41, s37
    s_mov_b32 s37, s39
    s_mov_b32 s39, s41
    s_add_u32 s40, s40, 1
    s_cmp_lt_u32 s40, s43
    s_cbranch_scc1 GT_Q_LOOP
    s_nop 7
    s_nop 7
    v_cvt_pk_bf16_f32 v112, v48, v49
    v_cvt_pk_bf16_f32 v113, v50, v51
    v_cvt_pk_bf16_f32 v114, v64, v65
    v_cvt_pk_bf16_f32 v115, v66, v67
    buffer_store_dwordx4 v[112:115], v5, s[8:11], s30 offen offset:0 sc1
    v_cvt_pk_bf16_f32 v116, v52, v53
    v_cvt_pk_bf16_f32 v117, v54, v55
    v_cvt_pk_bf16_f32 v118, v68, v69
    v_cvt_pk_bf16_f32 v119, v70, v71
    buffer_store_dwordx4 v[116:119], v5, s[8:11], s30 offen offset:1024 sc1
    v_cvt_pk_bf16_f32 v120, v56, v57
    v_cvt_pk_bf16_f32 v121, v58, v59
    v_cvt_pk_bf16_f32 v122, v72, v73
    v_cvt_pk_bf16_f32 v123, v74, v75
    buffer_store_dwordx4 v[120:123], v5, s[8:11], s31 offen offset:0 sc1
    v_cvt_pk_bf16_f32 v124, v60, v61
    v_cvt_pk_bf16_f32 v125, v62, v63
    v_cvt_pk_bf16_f32 v126, v76, v77
    v_cvt_pk_bf16_f32 v127, v78, v79
    buffer_store_dwordx4 v[124:127], v5, s[8:11], s31 offen offset:1024 sc1
    s_waitcnt vmcnt(0) lgkmcnt(0)
    s_barrier
    s_branch K3_PRED
K3_TR:
    s_sub_u32 s21, s64, 96
    s_lshl_b32 s21, s21, 2
    s_add_u32 s21, s21, s20
    s_mul_i32 s22, s20, 4608
    s_load_dwordx2 s[12:13], s[0:1], 64
    s_load_dwordx2 s[16:17], s[0:1], 80
    s_load_dwordx2 s[40:41], s[0:1], 72
    s_load_dwordx2 s[44:45], s[0:1], 88
    s_waitcnt lgkmcnt(0)
    s_and_b32 s13, s13, 0xffff
    s_mov_b32 s14, 1605632
    s_mov_b32 s15, 0x00020000
    s_and_b32 s17, s17, 0xffff
    s_mov_b32 s18, 1605632
    s_mov_b32 s19, 0x00020000
    s_cmp_ge_u32 s21, 784
    s_cbranch_scc1 RP_BIAS
    s_cmp_ge_u32 s21, 392
    s_cbranch_scc1 RP_W2
    s_mul_i32 s36, s21, 2341
    s_lshr_b32 s36, s36, 16
    s_mul_i32 s37, s36, 28
    s_sub_u32 s37, s21, s37
    s_mul_i32 s38, s36, 114688
    s_lshl_b32 s39, s37, 7
    s_add_u32 s38, s38, s39
    s_mov_b32 s46, 3584
    s_lshl_b32 s47, s37, 2
    s_mul_i32 s47, s47, 14
    s_add_u32 s47, s47, s36
    s_lshl_b32 s47, s47, 10
    s_add_u32 s47, s47, 101711872
    s_mov_b32 s48, 14336
    s_mov_b32 s49, 8
    s_mov_b32 s50, 4
    s_branch RP_GO
RP_W2:
    s_sub_u32 s35, s21, 392
    s_mul_i32 s36, s35, 9363
    s_lshr_b32 s36, s36, 16
    s_mul_i32 s37, s36, 7
    s_sub_u32 s37, s35, s37
    s_mul_i32 s38, s36, 28672
    s_lshl_b32 s39, s37, 7
    s_add_u32 s38, s38, s39
    s_mov_b32 s46, 896
    s_lshl_b32 s47, s37, 2
    s_mul_i32 s47, s47, 56
    s_add_u32 s47, s47, s36
    s_lshl_b32 s47, s47, 10
    s_add_u32 s47, s47, 103809024
    s_mov_b32 s48, 57344
    s_mov_b32 s49, 4
    s_mov_b32 s50, 16
    s_mov_b32 s12, s16
    s_mov_b32 s13, s17
RP_GO:
    v_lshrrev_b32 v6, 3, v1
    v_and_b32 v7, 7, v1
    v_mul_lo_u32 v8, v6, s46
    v_lshl_add_u32 v8, v7, 4, v8
    s_lshl_b32 s39, s46, 3
    buffer_load_dwordx4 v[16:19], v8, s[12:15], s38 offen
    s_add_u32 s38, s38, s39
    buffer_load_dwordx4 v[20:23], v8, s[12:15], s38 offen
    s_add_u32 s38, s38, s39
    buffer_load_dwordx4 v[24:27], v8, s[12:15], s38 offen
    s_add_u32 s38, s38, s39
    buffer_load_dwordx4 v[28:31], v8, s[12:15], s38 offen
    s_add_u32 s38, s38, s39
    v_mul_u32_u24 v9, 144, v6
    v_lshl_add_u32 v9, v7, 4, v9
    v_add_u32 v9, s22, v9
    s_waitcnt vmcnt(0)
    ds_write_b128 v9, v[16:19] offset:0
    ds_write_b128 v9, v[20:23] offset:1152
    ds_write_b128 v9, v[24:27] offset:2304
    ds_write_b128 v9, v[28:31] offset:3456
    v_lshrrev_b32 v10, 4, v1
    v_mul_lo_u32 v10, v10, s49
    v_bfe_u32 v11, v1, 2, 2
    v_add_u32 v10, v10, v11
    v_mul_u32_u24 v10, 144, v10
    v_and_b32 v11, 3, v1
    v_lshl_add_u32 v10, v11, 3, v10
    v_add_u32 v10, s22, v10
    s_mul_i32 s39, s50, 144
    v_add_u32 v11, s39, v10
    s_waitcnt lgkmcnt(0)
    ds_read_b64_tr_b16 v[32:33], v10 offset:0
    ds_read_b64_tr_b16 v[34:35], v11 offset:0
    ds_read_b64_tr_b16 v[36:37], v10 offset:32
    ds_read_b64_tr_b16 v[38:39], v11 offset:32
    ds_read_b64_tr_b16 v[40:41], v10 offset:64
    ds_read_b64_tr_b16 v[42:43], v11 offset:64
    ds_read_b64_tr_b16 v[44:45], v10 offset:96
    ds_read_b64_tr_b16 v[46:47], v11 offset:96
    s_waitcnt lgkmcnt(0)
    buffer_store_dwordx4 v[32:35], v5, s[8:11], s47 offen sc1
    s_add_u32 s47, s47, s48
    buffer_store_dwordx4 v[36:39], v5, s[8:11], s47 offen sc1
    s_add_u32 s47, s47, s48
    buffer_store_dwordx4 v[40:43], v5, s[8:11], s47 offen sc1
    s_add_u32 s47, s47, s48
    buffer_store_dwordx4 v[44:47], v5, s[8:11], s47 offen sc1
    s_add_u32 s47, s47, s48
    s_branch K3_HDONE
RP_BIAS:
    s_cmp_eq_u32 s21, 784
    s_cbranch_scc0 K3_HDONE
    s_mov_b32 s12, s40
    s_mov_b32 s13, s41
    s_and_b32 s13, s13, 0xffff
    s_mov_b32 s14, 3584
    s_mov_b32 s15, 0x00020000
    s_mov_b32 s16, s44
    s_mov_b32 s17, s45
    s_and_b32 s17, s17, 0xffff
    s_mov_b32 s18, 896
    s_mov_b32 s19, 0x00020000
    v_lshlrev_b32 v6, 2, v1
    v_lshlrev_b32 v7, 3, v1
    buffer_load_dword v16, v6, s[12:15], 0 offen offset:0
    buffer_load_dword v17, v6, s[12:15], 0 offen offset:256
    buffer_load_dword v18, v6, s[12:15], 0 offen offset:512
    buffer_load_dword v19, v6, s[12:15], 0 offen offset:768
    buffer_load_dword v20, v6, s[12:15], 0 offen offset:1024
    buffer_load_dword v21, v6, s[12:15], 0 offen offset:1280
    buffer_load_dword v22, v6, s[12:15], 0 offen offset:1536
    buffer_load_dword v23, v6, s[12:15], 0 offen offset:1792
    buffer_load_dword v24, v6, s[12:15], 0 offen offset:2048
    buffer_load_dword v25, v6, s[12:15], 0 offen offset:2304
    buffer_load_dword v26, v6, s[12:15], 0 offen offset:2560
    buffer_load_dword v27, v6, s[12:15], 0 offen offset:2816
    buffer_load_dword v28, v6, s[12:15], 0 offen offset:3072
    buffer_load_dword v29, v6, s[12:15], 0 offen offset:3328
    buffer_load_dword v30, v6, s[16:19], 0 offen offset:0
    buffer_load_dword v31, v6, s[16:19], 0 offen offset:256
    buffer_load_dword v32, v6, s[16:19], 0 offen offset:512
    buffer_load_dword v33, v6, s[16:19], 0 offen offset:768
    s_waitcnt vmcnt(0)
    v_lshlrev_b32 v40, 16, v16
    v_and_b32 v41, 0xffff0000, v16
    v_lshlrev_b32 v42, 16, v17
    v_and_b32 v43, 0xffff0000, v17
    v_lshlrev_b32 v44, 16, v18
    v_and_b32 v45, 0xffff0000, v18
    v_lshlrev_b32 v46, 16, v19
    v_and_b32 v47, 0xffff0000, v19
    v_lshlrev_b32 v48, 16, v20
    v_and_b32 v49, 0xffff0000, v20
    v_lshlrev_b32 v50, 16, v21
    v_and_b32 v51, 0xffff0000, v21
    v_lshlrev_b32 v52, 16, v22
    v_and_b32 v53, 0xffff0000, v22
    v_lshlrev_b32 v54, 16, v23
    v_and_b32 v55, 0xffff0000, v23
    v_lshlrev_b32 v56, 16, v24
    v_and_b32 v57, 0xffff0000, v24
    v_lshlrev_b32 v58, 16, v25
    v_and_b32 v59, 0xffff0000, v25
    v_lshlrev_b32 v60, 16, v26
    v_and_b32 v61, 0xffff0000, v26
    v_lshlrev_b32 v62, 16, v27
    v_and_b32 v63, 0xffff0000, v27
    v_lshlrev_b32 v64, 16, v28
    v_and_b32 v65, 0xffff0000, v28
    v_lshlrev_b32 v66, 16, v29
    v_and_b32 v67, 0xffff0000, v29
    v_lshlrev_b32 v68, 16, v30
    v_and_b32 v69, 0xffff0000, v30
    v_lshlrev_b32 v70, 16, v31
    v_and_b32 v71, 0xffff0000, v31
    v_lshlrev_b32 v72, 16, v32
    v_and_b32 v73, 0xffff0000, v32
    v_lshlrev_b32 v74, 16, v33
    v_and_b32 v75, 0xffff0000, v33
    s_mov_b32 s36, 105906176
    buffer_store_dwordx2 v[40:41], v7, s[8:11], s36 offen sc1
    s_mov_b32 s36, 105906688
    buffer_store_dwordx2 v[42:43], v7, s[8:11], s36 offen sc1
    s_mov_b32 s36, 105907200
    buffer_store_dwordx2 v[44:45], v7, s[8:11], s36 offen sc1
    s_mov_b32 s36, 105907712
    buffer_store_dwordx2 v[46:47], v7, s[8:11], s36 offen sc1
    s_mov_b32 s36, 105908224
    buffer_store_dwordx2 v[48:49], v7, s[8:11], s36 offen sc1
    s_mov_b32 s36, 105908736
    buffer_store_dwordx2 v[50:51], v7, s[8:11], s36 offen sc1
    s_mov_b32 s36, 105909248
    buffer_store_dwordx2 v[52:53], v7, s[8:11], s36 offen sc1
    s_mov_b32 s36, 105909760
    buffer_store_dwordx2 v[54:55], v7, s[8:11], s36 offen sc1
    s_mov_b32 s36, 105910272
    buffer_store_dwordx2 v[56:57], v7, s[8:11], s36 offen sc1
    s_mov_b32 s36, 105910784
    buffer_store_dwordx2 v[58:59], v7, s[8:11], s36 offen sc1
    s_mov_b32 s36, 105911296
    buffer_store_dwordx2 v[60:61], v7, s[8:11], s36 offen sc1
    s_mov_b32 s36, 105911808
    buffer_store_dwordx2 v[62:63], v7, s[8:11], s36 offen sc1
    s_mov_b32 s36, 105912320
    buffer_store_dwordx2 v[64:65], v7, s[8:11], s36 offen sc1
    s_mov_b32 s36, 105912832
    buffer_store_dwordx2 v[66:67], v7, s[8:11], s36 offen sc1
    s_mov_b32 s36, 105914368
    buffer_store_dwordx2 v[68:69], v7, s[8:11], s36 offen sc1
    s_mov_b32 s36, 105914880
    buffer_store_dwordx2 v[70:71], v7, s[8:11], s36 offen sc1
    s_mov_b32 s36, 105915392
    buffer_store_dwordx2 v[72:73], v7, s[8:11], s36 offen sc1
    s_mov_b32 s36, 105915904
    buffer_store_dwordx2 v[74:75], v7, s[8:11], s36 offen sc1
    s_branch K3_HDONE
K3_HDONE:
    s_waitcnt vmcnt(0)
    s_barrier
K3_PRED:
    s_cmp_eq_u32 s20, 0
    s_cbranch_scc0 K3_TASK
K3_PRED0:
    s_mov_b32 s16, s62
    s_mov_b32 s17, s63
    s_and_b32 s17, s17, 0xffff
    s_mov_b32 s18, 256
    s_mov_b32 s19, 0x00020000
    v_mov_b32 v12, 1
    v_mov_b32 v13, 224
    s_mov_b64 exec, 1
    buffer_atomic_add v12, v13, s[16:19], 0 offen
    s_mov_b64 exec, -1
    s_branch K3_TASK
K3_POST:
    s_cmp_lt_u32 s64, 2283
    s_cbranch_scc0 K3_TEND
    s_cmp_eq_u32 s20, 0
    s_cbranch_scc0 L_wpx_11_b
    v_mov_b32 v12, 224
    s_mov_b32 s60, 0
L_wpx_11:
    buffer_load_dword v13, v12, s[16:19], 0 offen sc1
    s_add_u32 s60, s60, 1
    s_waitcnt vmcnt(0)
    v_cmp_gt_u32 vcc, 613, v13
    s_cbranch_vccz L_wpx_11_b
    s_sleep 16
    s_cmp_lt_u32 s60, 65536
    s_cbranch_scc1 L_wpx_11
L_wpx_11_b:
    s_barrier
    s_cmp_lt_u32 s64, 677
    s_cbranch_scc0 K3_PSEG
    s_sub_u32 s23, s64, 613
    s_lshr_b32 s30, s23, 5
    s_and_b32 s23, s23, 31
    s_lshr_b32 s22, s23, 1
    s_and_b32 s24, s23, 1
    s_mov_b32 s21, 4290772927
    v_and_b32 v4, 15, v1
    v_mov_b32 v3, 0x4444
    v_mov_b32 v6, 0xeeee
    v_cmp_lt_u32 vcc, 7, v4
    s_nop 1
    v_cndmask_b32 v3, v3, v6, vcc
    v_lshlrev_b32 v2, 3, v1
    s_mul_i32 s25, s20, 3
    s_cmp_ge_u32 s20, 1
    s_cselect_b32 s26, 1, 0
    s_add_u32 s25, s25, s26
    s_mul_i32 s26, s24, 14
    s_add_u32 s25, s25, s26
    s_add_u32 s27, s22, 16
    s_mul_i32 s27, s27, 28
    s_add_u32 s28, s27, s25
    s_mul_i32 s28, s28, 14336
    s_add_u32 s28, s28, 4194304
    buffer_load_dwordx4 a[0:3], v5, s[8:11], s28 offen offset:0 sc1
    buffer_load_dwordx4 a[4:7], v5, s[8:11], s28 offen offset:1024 sc1
    buffer_load_dwordx4 a[8:11], v5, s[8:11], s28 offen offset:2048 sc1
    buffer_load_dwordx4 a[12:15], v5, s[8:11], s28 offen offset:3072 sc1
    s_add_u32 s28, s28, 4096
    buffer_load_dwordx4 a[16:19], v5, s[8:11], s28 offen offset:0 sc1
    buffer_load_dwordx4 a[20:23], v5, s[8:11], s28 offen offset:1024 sc1
    buffer_load_dwordx4 a[24:27], v5, s[8:11], s28 offen offset:2048 sc1
    buffer_load_dwordx4 a[28:31], v5, s[8:11], s28 offen offset:3072 sc1
    s_add_u32 s28, s28, 4096
    buffer_load_dwordx4 a[32:35], v5, s[8:11], s28 offen offset:0 sc1
    buffer_load_dwordx4 a[36:39], v5, s[8:11], s28 offen offset:1024 sc1
    buffer_load_dwordx4 a[40:43], v5, s[8:11], s28 offen offset:2048 sc1
    buffer_load_dwordx4 a[44:47], v5, s[8:11], s28 offen offset:3072 sc1
    s_add_u32 s28, s28, 4096
    buffer_load_dwordx4 a[48:51], v5, s[8:11], s28 offen offset:0 sc1
    buffer_load_dwordx4 a[52:55], v5, s[8:11], s28 offen offset:1024 sc1
    buffer_load_dwordx4 a[56:59], v5, s[8:11], s28 offen offset:2048 sc1
    buffer_load_dwordx4 a[60:63], v5, s[8:11], s28 offen offset:3072 sc1
    s_add_u32 s28, s28, 4096
    buffer_load_dwordx4 a[64:67], v5, s[8:11], s28 offen offset:0 sc1
    buffer_load_dwordx4 a[68:71], v5, s[8:11], s28 offen offset:1024 sc1
    buffer_load_dwordx4 a[72:75], v5, s[8:11], s28 offen offset:2048 sc1
    buffer_load_dwordx4 a[76:79], v5, s[8:11], s28 offen offset:3072 sc1
    s_add_u32 s28, s28, 4096
    buffer_load_dwordx4 a[80:83], v5, s[8:11], s28 offen offset:0 sc1
    buffer_load_dwordx4 a[84:87], v5, s[8:11], s28 offen offset:1024 sc1
    buffer_load_dwordx4 a[88:91], v5, s[8:11], s28 offen offset:2048 sc1
    buffer_load_dwordx4 a[92:95], v5, s[8:11], s28 offen offset:3072 sc1
    s_add_u32 s28, s28, 4096
    buffer_load_dwordx4 a[96:99], v5, s[8:11], s28 offen offset:0 sc1
    buffer_load_dwordx4 a[100:103], v5, s[8:11], s28 offen offset:1024 sc1
    buffer_load_dwordx4 a[104:107], v5, s[8:11], s28 offen offset:2048 sc1
    buffer_load_dwordx4 a[108:111], v5, s[8:11], s28 offen offset:3072 sc1
    s_add_u32 s28, s28, 4096
    buffer_load_dwordx4 a[112:115], v5, s[8:11], s28 offen offset:0 sc1
    buffer_load_dwordx4 a[116:119], v5, s[8:11], s28 offen offset:1024 sc1
    buffer_load_dwordx4 a[120:123], v5, s[8:11], s28 offen offset:2048 sc1
    buffer_load_dwordx4 a[124:127], v5, s[8:11], s28 offen offset:3072 sc1
    s_add_u32 s28, s28, 4096
    buffer_load_dwordx4 a[128:131], v5, s[8:11], s28 offen offset:0 sc1
    buffer_load_dwordx4 a[132:135], v5, s[8:11], s28 offen offset:1024 sc1
    buffer_load_dwordx4 a[136:139], v5, s[8:11], s28 offen offset:2048 sc1
    buffer_load_dwordx4 a[140:143], v5, s[8:11], s28 offen offset:3072 sc1
    s_add_u32 s28, s28, 4096
    buffer_load_dwordx4 a[144:147], v5, s[8:11], s28 offen offset:0 sc1
    buffer_load_dwordx4 a[148:151], v5, s[8:11], s28 offen offset:1024 sc1
    buffer_load_dwordx4 a[152:155], v5, s[8:11], s28 offen offset:2048 sc1
    buffer_load_dwordx4 a[156:159], v5, s[8:11], s28 offen offset:3072 sc1
    s_add_u32 s28, s28, 4096
    buffer_load_dwordx4 a[160:163], v5, s[8:11], s28 offen offset:0 sc1
    buffer_load_dwordx4 a[164:167], v5, s[8:11], s28 offen offset:1024 sc1
    buffer_load_dwordx4 a[168:171], v5, s[8:11], s28 offen offset:2048 sc1
    buffer_load_dwordx4 a[172:175], v5, s[8:11], s28 offen offset:3072 sc1
    s_add_u32 s28, s28, 4096
    buffer_load_dwordx4 a[176:179], v5, s[8:11], s28 offen offset:0 sc1
    buffer_load_dwordx4 a[180:183], v5, s[8:11], s28 offen offset:1024 sc1
    buffer_load_dwordx4 a[184:187], v5, s[8:11], s28 offen offset:2048 sc1
    buffer_load_dwordx4 a[188:191], v5, s[8:11], s28 offen offset:3072 sc1
    s_add_u32 s28, s28, 4096
    buffer_load_dwordx4 a[192:195], v5, s[8:11], s28 offen offset:0 sc1
    buffer_load_dwordx4 a[196:199], v5, s[8:11], s28 offen offset:1024 sc1
    buffer_load_dwordx4 a[200:203], v5, s[8:11], s28 offen offset:2048 sc1
    buffer_load_dwordx4 a[204:207], v5, s[8:11], s28 offen offset:3072 sc1
    s_add_u32 s28, s28, 4096
    buffer_load_dwordx4 a[208:211], v5, s[8:11], s28 offen offset:0 sc1
    buffer_load_dwordx4 a[212:215], v5, s[8:11], s28 offen offset:1024 sc1
    buffer_load_dwordx4 a[216:219], v5, s[8:11], s28 offen offset:2048 sc1
    buffer_load_dwordx4 a[220:223], v5, s[8:11], s28 offen offset:3072 sc1
PT2_LOOP:
    s_cmp_eq_u32 s20, 0
    s_cbranch_scc0 L_wmt2_12_b
    v_min_u32 v12, 27, v1
    v_lshlrev_b32 v12, 8, v12
    s_lshl_b32 s61, s30, 13
    s_add_u32 s61, s61, 93585408
    s_mov_b32 s59, 4290772927
    s_mov_b32 s60, 0
L_wmt2_12:
    buffer_load_dword v13, v12, s[8:11], s61 offen sc1
    s_add_u32 s60, s60, 1
    s_waitcnt vmcnt(0)
    v_cmp_eq_u32 vcc, s59, v13
    s_cbranch_vccz L_wmt2_12_b
    s_sleep 2
    s_cmp_lt_u32 s60, 65536
    s_cbranch_scc1 L_wmt2_12
L_wmt2_12_b:
    s_barrier
    s_lshl_b32 s32, s30, 13
    s_add_u32 s32, s32, 93585408
    s_add_u32 s33, s32, 4096
    s_mov_b32 s60, 0
PT2_LD:
    buffer_load_dwordx4 v[16:19], v5, s[8:11], s32 offen offset:0 sc1
    buffer_load_dwordx4 v[20:23], v5, s[8:11], s32 offen offset:1024 sc1
    buffer_load_dwordx4 v[24:27], v5, s[8:11], s32 offen offset:2048 sc1
    buffer_load_dwordx4 v[28:31], v5, s[8:11], s32 offen offset:3072 sc1
    buffer_load_dwordx4 v[32:35], v5, s[8:11], s33 offen offset:0 sc1
    buffer_load_dwordx4 v[36:39], v5, s[8:11], s33 offen offset:1024 sc1
    buffer_load_dwordx4 v[40:43], v5, s[8:11], s33 offen offset:2048 sc1
    v_mov_b32 v48, 0
    v_mov_b32 v49, 0
    v_mov_b32 v50, 0
    v_mov_b32 v51, 0
    v_mov_b32 v52, 0
    v_mov_b32 v53, 0
    v_mov_b32 v54, 0
    v_mov_b32 v55, 0
    v_mov_b32 v56, 0
    v_mov_b32 v57, 0
    v_mov_b32 v58, 0
    v_mov_b32 v59, 0
    v_mov_b32 v60, 0
    v_mov_b32 v61, 0
    v_mov_b32 v62, 0
    v_mov_b32 v63, 0
    s_add_u32 s60, s60, 1
    s_waitcnt vmcnt(0)
    v_max3_u32 v80, v16, v17, v18
    v_max3_u32 v80, v80, v19, v20
    v_max3_u32 v80, v80, v21, v22
    v_max3_u32 v80, v80, v23, v24
    v_max3_u32 v80, v80, v25, v26
    v_max3_u32 v80, v80, v27, v28
    v_max3_u32 v80, v80, v29, v30
    v_max3_u32 v80, v80, v31, v32
    v_max3_u32 v80, v80, v33, v34
    v_max3_u32 v80, v80, v35, v36
    v_max3_u32 v80, v80, v37, v38
    v_max3_u32 v80, v80, v39, v40
    v_max3_u32 v80, v80, v41, v42
    v_max_u32 v80, v80, v43
    v_cmp_eq_u32 vcc, s21, v80
    s_cbranch_vccz PT2_OK
    s_cmp_lt_u32 s60, 65536
    s_cbranch_scc1 PT2_LD
PT2_OK:
    s_lshl_b32 s34, s30, 4
    s_add_u32 s34, s34, s22
    s_mul_i32 s34, s34, 28
    s_add_u32 s35, s34, s25
    s_lshl_b32 s35, s35, 9
    s_add_u32 s35, s35, 76546048
    v_smfmac_f32_16x16x64_bf16 v[48:51], v[16:19], a[0:7], v3
    v_smfmac_f32_16x16x64_bf16 v[52:55], v[16:19], a[56:63], v3
    v_smfmac_f32_16x16x64_bf16 v[56:59], v[16:19], a[112:119], v3
    v_smfmac_f32_16x16x64_bf16 v[60:63], v[16:19], a[168:175], v3
    v_smfmac_f32_16x16x64_bf16 v[48:51], v[20:23], a[8:15], v3
    v_smfmac_f32_16x16x64_bf16 v[52:55], v[20:23], a[64:71], v3
    v_smfmac_f32_16x16x64_bf16 v[56:59], v[20:23], a[120:127], v3
    v_smfmac_f32_16x16x64_bf16 v[60:63], v[20:23], a[176:183], v3
    v_smfmac_f32_16x16x64_bf16 v[48:51], v[24:27], a[16:23], v3
    v_smfmac_f32_16x16x64_bf16 v[52:55], v[24:27], a[72:79], v3
    v_smfmac_f32_16x16x64_bf16 v[56:59], v[24:27], a[128:135], v3
    v_smfmac_f32_16x16x64_bf16 v[60:63], v[24:27], a[184:191], v3
    v_smfmac_f32_16x16x64_bf16 v[48:51], v[28:31], a[24:31], v3
    v_smfmac_f32_16x16x64_bf16 v[52:55], v[28:31], a[80:87], v3
    v_smfmac_f32_16x16x64_bf16 v[56:59], v[28:31], a[136:143], v3
    v_smfmac_f32_16x16x64_bf16 v[60:63], v[28:31], a[192:199], v3
    v_smfmac_f32_16x16x64_bf16 v[48:51], v[32:35], a[32:39], v3
    v_smfmac_f32_16x16x64_bf16 v[52:55], v[32:35], a[88:95], v3
    v_smfmac_f32_16x16x64_bf16 v[56:59], v[32:35], a[144:151], v3
    v_smfmac_f32_16x16x64_bf16 v[60:63], v[32:35], a[200:207], v3
    v_smfmac_f32_16x16x64_bf16 v[48:51], v[36:39], a[40:47], v3
    v_smfmac_f32_16x16x64_bf16 v[52:55], v[36:39], a[96:103], v3
    v_smfmac_f32_16x16x64_bf16 v[56:59], v[36:39], a[152:159], v3
    v_smfmac_f32_16x16x64_bf16 v[60:63], v[36:39], a[208:215], v3
    v_smfmac_f32_16x16x64_bf16 v[48:51], v[40:43], a[48:55], v3
    v_smfmac_f32_16x16x64_bf16 v[52:55], v[40:43], a[104:111], v3
    v_smfmac_f32_16x16x64_bf16 v[56:59], v[40:43], a[160:167], v3
    v_smfmac_f32_16x16x64_bf16 v[60:63], v[40:43], a[216:223], v3
    s_nop 7
    v_cvt_pk_bf16_f32 v64, v48, v49
    v_cvt_pk_bf16_f32 v65, v50, v51
    buffer_store_dwordx2 v[64:65], v2, s[8:11], s35 offen offset:0 sc1
    v_cvt_pk_bf16_f32 v66, v52, v53
    v_cvt_pk_bf16_f32 v67, v54, v55
    buffer_store_dwordx2 v[66:67], v2, s[8:11], s35 offen offset:512 sc1
    v_cvt_pk_bf16_f32 v68, v56, v57
    v_cvt_pk_bf16_f32 v69, v58, v59
    buffer_store_dwordx2 v[68:69], v2, s[8:11], s35 offen offset:1024 sc1
    v_cvt_pk_bf16_f32 v70, v60, v61
    v_cvt_pk_bf16_f32 v71, v62, v63
    buffer_store_dwordx2 v[70:71], v2, s[8:11], s35 offen offset:1536 sc1
    s_lshl_b32 s37, s30, 8
    s_lshl_b32 s38, s23, 2
    s_add_u32 s37, s37, s38
    s_add_u32 s37, s37, 94175232
    s_waitcnt vmcnt(0)
    s_barrier
    s_cmp_eq_u32 s20, 0
    s_cbranch_scc0 L_sf_13
    v_mov_b32 v12, 1
    v_mov_b32 v13, 0
    s_mov_b64 exec, 1
    buffer_store_dword v12, v13, s[8:11], s37 offen sc1
    s_mov_b64 exec, -1
L_sf_13:
    s_add_u32 s30, s30, 2
    s_cmp_lt_u32 s30, 64
    s_cbranch_scc1 PT2_LOOP
    s_branch K3_TASK
K3_PSEG:
    s_sub_u32 s64, s64, 677
    s_mul_i32 s22, s64, 2979
    s_lshr_b32 s22, s22, 16
    s_mul_i32 s23, s22, 22
    s_sub_u32 s23, s64, s23
    s_cmp_lt_u32 s23, 4
    s_cbranch_scc1 K3_PP
    s_sub_u32 s22, s22, 3
    s_cmp_lt_u32 s23, 8
    s_cbranch_scc1 K3_PO
    s_sub_u32 s22, s22, 3
    s_cmp_lt_u32 s23, 15
    s_cbranch_scc1 K3_PM1
    s_sub_u32 s22, s22, 3
    s_sub_u32 s23, s23, 15
    s_cmp_lt_u32 s22, 64
    s_cbranch_scc0 K3_TASK
    s_load_dwordx2 s[12:13], s[0:1], 96
    s_waitcnt lgkmcnt(0)
    s_and_b32 s13, s13, 0xffff
    s_mov_b32 s14, 1835008
    s_mov_b32 s15, 0x00020000
    s_lshl_b32 s26, s23, 2
    s_add_u32 s26, s26, 0
    s_mul_i32 s26, s26, 56
    s_mul_i32 s25, s20, 14
    s_add_u32 s26, s26, s25
    s_lshl_b32 s26, s26, 10
    s_add_u32 s26, s26, 103809024
    buffer_load_dwordx4 a[0:3], v5, s[8:11], s26 offen offset:0 sc1
    buffer_load_dwordx4 a[4:7], v5, s[8:11], s26 offen offset:1024 sc1
    buffer_load_dwordx4 a[8:11], v5, s[8:11], s26 offen offset:2048 sc1
    buffer_load_dwordx4 a[12:15], v5, s[8:11], s26 offen offset:3072 sc1
    s_add_u32 s26, s26, 4096
    buffer_load_dwordx4 a[16:19], v5, s[8:11], s26 offen offset:0 sc1
    buffer_load_dwordx4 a[20:23], v5, s[8:11], s26 offen offset:1024 sc1
    buffer_load_dwordx4 a[24:27], v5, s[8:11], s26 offen offset:2048 sc1
    buffer_load_dwordx4 a[28:31], v5, s[8:11], s26 offen offset:3072 sc1
    s_add_u32 s26, s26, 4096
    buffer_load_dwordx4 a[32:35], v5, s[8:11], s26 offen offset:0 sc1
    buffer_load_dwordx4 a[36:39], v5, s[8:11], s26 offen offset:1024 sc1
    buffer_load_dwordx4 a[40:43], v5, s[8:11], s26 offen offset:2048 sc1
    buffer_load_dwordx4 a[44:47], v5, s[8:11], s26 offen offset:3072 sc1
    s_add_u32 s26, s26, 4096
    buffer_load_dwordx4 a[48:51], v5, s[8:11], s26 offen offset:0 sc1
    buffer_load_dwordx4 a[52:55], v5, s[8:11], s26 offen offset:1024 sc1
    s_lshl_b32 s26, s23, 2
    s_add_u32 s26, s26, 1
    s_mul_i32 s26, s26, 56
    s_mul_i32 s25, s20, 14
    s_add_u32 s26, s26, s25
    s_lshl_b32 s26, s26, 10
    s_add_u32 s26, s26, 103809024
    buffer_load_dwordx4 a[56:59], v5, s[8:11], s26 offen offset:0 sc1
    buffer_load_dwordx4 a[60:63], v5, s[8:11], s26 offen offset:1024 sc1
    buffer_load_dwordx4 a[64:67], v5, s[8:11], s26 offen offset:2048 sc1
    buffer_load_dwordx4 a[68:71], v5, s[8:11], s26 offen offset:3072 sc1
    s_add_u32 s26, s26, 4096
    buffer_load_dwordx4 a[72:75], v5, s[8:11], s26 offen offset:0 sc1
    buffer_load_dwordx4 a[76:79], v5, s[8:11], s26 offen offset:1024 sc1
    buffer_load_dwordx4 a[80:83], v5, s[8:11], s26 offen offset:2048 sc1
    buffer_load_dwordx4 a[84:87], v5, s[8:11], s26 offen offset:3072 sc1
    s_add_u32 s26, s26, 4096
    buffer_load_dwordx4 a[88:91], v5, s[8:11], s26 offen offset:0 sc1
    buffer_load_dwordx4 a[92:95], v5, s[8:11], s26 offen offset:1024 sc1
    buffer_load_dwordx4 a[96:99], v5, s[8:11], s26 offen offset:2048 sc1
    buffer_load_dwordx4 a[100:103], v5, s[8:11], s26 offen offset:3072 sc1
    s_add_u32 s26, s26, 4096
    buffer_load_dwordx4 a[104:107], v5, s[8:11], s26 offen offset:0 sc1
    buffer_load_dwordx4 a[108:111], v5, s[8:11], s26 offen offset:1024 sc1
    s_lshl_b32 s26, s23, 2
    s_add_u32 s26, s26, 2
    s_mul_i32 s26, s26, 56
    s_mul_i32 s25, s20, 14
    s_add_u32 s26, s26, s25
    s_lshl_b32 s26, s26, 10
    s_add_u32 s26, s26, 103809024
    buffer_load_dwordx4 a[112:115], v5, s[8:11], s26 offen offset:0 sc1
    buffer_load_dwordx4 a[116:119], v5, s[8:11], s26 offen offset:1024 sc1
    buffer_load_dwordx4 a[120:123], v5, s[8:11], s26 offen offset:2048 sc1
    buffer_load_dwordx4 a[124:127], v5, s[8:11], s26 offen offset:3072 sc1
    s_add_u32 s26, s26, 4096
    buffer_load_dwordx4 a[128:131], v5, s[8:11], s26 offen offset:0 sc1
    buffer_load_dwordx4 a[132:135], v5, s[8:11], s26 offen offset:1024 sc1
    buffer_load_dwordx4 a[136:139], v5, s[8:11], s26 offen offset:2048 sc1
    buffer_load_dwordx4 a[140:143], v5, s[8:11], s26 offen offset:3072 sc1
    s_add_u32 s26, s26, 4096
    buffer_load_dwordx4 a[144:147], v5, s[8:11], s26 offen offset:0 sc1
    buffer_load_dwordx4 a[148:151], v5, s[8:11], s26 offen offset:1024 sc1
    buffer_load_dwordx4 a[152:155], v5, s[8:11], s26 offen offset:2048 sc1
    buffer_load_dwordx4 a[156:159], v5, s[8:11], s26 offen offset:3072 sc1
    s_add_u32 s26, s26, 4096
    buffer_load_dwordx4 a[160:163], v5, s[8:11], s26 offen offset:0 sc1
    buffer_load_dwordx4 a[164:167], v5, s[8:11], s26 offen offset:1024 sc1
    s_lshl_b32 s26, s23, 2
    s_add_u32 s26, s26, 3
    s_mul_i32 s26, s26, 56
    s_mul_i32 s25, s20, 14
    s_add_u32 s26, s26, s25
    s_lshl_b32 s26, s26, 10
    s_add_u32 s26, s26, 103809024
    buffer_load_dwordx4 a[168:171], v5, s[8:11], s26 offen offset:0 sc1
    buffer_load_dwordx4 a[172:175], v5, s[8:11], s26 offen offset:1024 sc1
    buffer_load_dwordx4 a[176:179], v5, s[8:11], s26 offen offset:2048 sc1
    buffer_load_dwordx4 a[180:183], v5, s[8:11], s26 offen offset:3072 sc1
    s_add_u32 s26, s26, 4096
    buffer_load_dwordx4 a[184:187], v5, s[8:11], s26 offen offset:0 sc1
    buffer_load_dwordx4 a[188:191], v5, s[8:11], s26 offen offset:1024 sc1
    buffer_load_dwordx4 a[192:195], v5, s[8:11], s26 offen offset:2048 sc1
    buffer_load_dwordx4 a[196:199], v5, s[8:11], s26 offen offset:3072 sc1
    s_add_u32 s26, s26, 4096
    buffer_load_dwordx4 a[200:203], v5, s[8:11], s26 offen offset:0 sc1
    buffer_load_dwordx4 a[204:207], v5, s[8:11], s26 offen offset:1024 sc1
    buffer_load_dwordx4 a[208:211], v5, s[8:11], s26 offen offset:2048 sc1
    buffer_load_dwordx4 a[212:215], v5, s[8:11], s26 offen offset:3072 sc1
    s_add_u32 s26, s26, 4096
    buffer_load_dwordx4 a[216:219], v5, s[8:11], s26 offen offset:0 sc1
    buffer_load_dwordx4 a[220:223], v5, s[8:11], s26 offen offset:1024 sc1
    v_and_b32 v7, 15, v1
    v_lshrrev_b32 v8, 4, v1
    v_mul_u32_u24 v9, 896, v7
    v_lshl_add_u32 v9, v8, 3, v9
    v_lshlrev_b32 v10, 4, v8
    s_lshl_b32 s37, s22, 6
    s_add_u32 s37, s37, 94191616
    s_cmp_eq_u32 s20, 0
    s_cbranch_scc0 L_wfm2_14_b
    v_min_u32 v12, 6, v1
    v_mul_u32_u24 v12, 1, v12
    v_add_u32 v12, 8, v12
    v_lshlrev_b32 v12, 2, v12
    s_mov_b32 s60, 0
L_wfm2_14:
    buffer_load_dword v13, v12, s[8:11], s37 offen sc1
    s_add_u32 s60, s60, 1
    s_waitcnt vmcnt(0)
    v_cmp_eq_u32 vcc, 0, v13
    s_cbranch_vccz L_wfm2_14_b
    s_sleep 2
    s_cmp_lt_u32 s60, 65536
    s_cbranch_scc1 L_wfm2_14
L_wfm2_14_b:
    s_barrier
    s_lshl_b32 s24, s22, 1
    s_add_u32 s24, s24, 0
    s_mul_i32 s24, s24, 56
    s_mul_i32 s25, s20, 14
    s_add_u32 s24, s24, s25
    s_lshl_b32 s24, s24, 10
    s_add_u32 s24, s24, 106954752
    buffer_load_dwordx4 v[128:131], v5, s[8:11], s24 offen offset:0 sc1
    buffer_load_dwordx4 v[132:135], v5, s[8:11], s24 offen offset:1024 sc1
    buffer_load_dwordx4 v[136:139], v5, s[8:11], s24 offen offset:2048 sc1
    buffer_load_dwordx4 v[140:143], v5, s[8:11], s24 offen offset:3072 sc1
    s_add_u32 s24, s24, 4096
    buffer_load_dwordx4 v[144:147], v5, s[8:11], s24 offen offset:0 sc1
    buffer_load_dwordx4 v[148:151], v5, s[8:11], s24 offen offset:1024 sc1
    buffer_load_dwordx4 v[152:155], v5, s[8:11], s24 offen offset:2048 sc1
    buffer_load_dwordx4 v[156:159], v5, s[8:11], s24 offen offset:3072 sc1
    s_add_u32 s24, s24, 4096
    buffer_load_dwordx4 v[160:163], v5, s[8:11], s24 offen offset:0 sc1
    buffer_load_dwordx4 v[164:167], v5, s[8:11], s24 offen offset:1024 sc1
    buffer_load_dwordx4 v[168:171], v5, s[8:11], s24 offen offset:2048 sc1
    buffer_load_dwordx4 v[172:175], v5, s[8:11], s24 offen offset:3072 sc1
    s_add_u32 s24, s24, 4096
    buffer_load_dwordx4 v[176:179], v5, s[8:11], s24 offen offset:0 sc1
    buffer_load_dwordx4 v[180:183], v5, s[8:11], s24 offen offset:1024 sc1
    s_lshl_b32 s24, s22, 1
    s_add_u32 s24, s24, 1
    s_mul_i32 s24, s24, 56
    s_mul_i32 s25, s20, 14
    s_add_u32 s24, s24, s25
    s_lshl_b32 s24, s24, 10
    s_add_u32 s24, s24, 106954752
    buffer_load_dwordx4 v[184:187], v5, s[8:11], s24 offen offset:0 sc1
    buffer_load_dwordx4 v[188:191], v5, s[8:11], s24 offen offset:1024 sc1
    buffer_load_dwordx4 v[192:195], v5, s[8:11], s24 offen offset:2048 sc1
    buffer_load_dwordx4 v[196:199], v5, s[8:11], s24 offen offset:3072 sc1
    s_add_u32 s24, s24, 4096
    buffer_load_dwordx4 v[200:203], v5, s[8:11], s24 offen offset:0 sc1
    buffer_load_dwordx4 v[204:207], v5, s[8:11], s24 offen offset:1024 sc1
    buffer_load_dwordx4 v[208:211], v5, s[8:11], s24 offen offset:2048 sc1
    buffer_load_dwordx4 v[212:215], v5, s[8:11], s24 offen offset:3072 sc1
    s_add_u32 s24, s24, 4096
    buffer_load_dwordx4 v[216:219], v5, s[8:11], s24 offen offset:0 sc1
    buffer_load_dwordx4 v[220:223], v5, s[8:11], s24 offen offset:1024 sc1
    buffer_load_dwordx4 v[224:227], v5, s[8:11], s24 offen offset:2048 sc1
    buffer_load_dwordx4 v[228:231], v5, s[8:11], s24 offen offset:3072 sc1
    s_add_u32 s24, s24, 4096
    buffer_load_dwordx4 v[232:235], v5, s[8:11], s24 offen offset:0 sc1
    buffer_load_dwordx4 v[236:239], v5, s[8:11], s24 offen offset:1024 sc1
    s_add_u32 s25, s20, 0
    s_lshr_b32 s26, s25, 1
    s_and_b32 s27, s25, 1
    s_lshl_b32 s28, s23, 2
    s_add_u32 s28, s28, s26
    s_lshl_b32 s30, s28, 6
    s_add_u32 s30, s30, 105914368
    s_lshl_b32 s28, s28, 5
    s_lshl_b32 s29, s22, 1
    s_add_u32 s29, s29, s27
    s_mul_i32 s29, s29, 14336
    s_add_u32 s40, s29, s28
    s_add_u32 s31, s40, 97517568
    buffer_load_dwordx2 v[72:73], v9, s[8:11], s31 offen sc1
    buffer_load_dwordx4 v[96:99], v10, s[8:11], s30 offen sc1
    s_add_u32 s25, s20, 4
    s_lshr_b32 s26, s25, 1
    s_and_b32 s27, s25, 1
    s_lshl_b32 s28, s23, 2
    s_add_u32 s28, s28, s26
    s_lshl_b32 s30, s28, 6
    s_add_u32 s30, s30, 105914368
    s_lshl_b32 s28, s28, 5
    s_lshl_b32 s29, s22, 1
    s_add_u32 s29, s29, s27
    s_mul_i32 s29, s29, 14336
    s_add_u32 s41, s29, s28
    s_add_u32 s31, s41, 97517568
    buffer_load_dwordx2 v[74:75], v9, s[8:11], s31 offen sc1
    buffer_load_dwordx4 v[100:103], v10, s[8:11], s30 offen sc1
    s_waitcnt vmcnt(0)
    v_mfma_f32_16x16x32_bf16 v[16:19], a[0:3], v[128:131], 0
    v_mfma_f32_16x16x32_bf16 v[20:23], a[0:3], v[184:187], 0
    v_mfma_f32_16x16x32_bf16 v[24:27], a[56:59], v[128:131], 0
    v_mfma_f32_16x16x32_bf16 v[28:31], a[56:59], v[184:187], 0
    v_mfma_f32_16x16x32_bf16 v[32:35], a[112:115], v[128:131], 0
    v_mfma_f32_16x16x32_bf16 v[36:39], a[112:115], v[184:187], 0
    v_mfma_f32_16x16x32_bf16 v[40:43], a[168:171], v[128:131], 0
    v_mfma_f32_16x16x32_bf16 v[44:47], a[168:171], v[184:187], 0
    v_mfma_f32_16x16x32_bf16 v[16:19], a[4:7], v[132:135], v[16:19]
    v_mfma_f32_16x16x32_bf16 v[20:23], a[4:7], v[188:191], v[20:23]
    v_mfma_f32_16x16x32_bf16 v[24:27], a[60:63], v[132:135], v[24:27]
    v_mfma_f32_16x16x32_bf16 v[28:31], a[60:63], v[188:191], v[28:31]
    v_mfma_f32_16x16x32_bf16 v[32:35], a[116:119], v[132:135], v[32:35]
    v_mfma_f32_16x16x32_bf16 v[36:39], a[116:119], v[188:191], v[36:39]
    v_mfma_f32_16x16x32_bf16 v[40:43], a[172:175], v[132:135], v[40:43]
    v_mfma_f32_16x16x32_bf16 v[44:47], a[172:175], v[188:191], v[44:47]
    v_mfma_f32_16x16x32_bf16 v[16:19], a[8:11], v[136:139], v[16:19]
    v_mfma_f32_16x16x32_bf16 v[20:23], a[8:11], v[192:195], v[20:23]
    v_mfma_f32_16x16x32_bf16 v[24:27], a[64:67], v[136:139], v[24:27]
    v_mfma_f32_16x16x32_bf16 v[28:31], a[64:67], v[192:195], v[28:31]
    v_mfma_f32_16x16x32_bf16 v[32:35], a[120:123], v[136:139], v[32:35]
    v_mfma_f32_16x16x32_bf16 v[36:39], a[120:123], v[192:195], v[36:39]
    v_mfma_f32_16x16x32_bf16 v[40:43], a[176:179], v[136:139], v[40:43]
    v_mfma_f32_16x16x32_bf16 v[44:47], a[176:179], v[192:195], v[44:47]
    v_mfma_f32_16x16x32_bf16 v[16:19], a[12:15], v[140:143], v[16:19]
    v_mfma_f32_16x16x32_bf16 v[20:23], a[12:15], v[196:199], v[20:23]
    v_mfma_f32_16x16x32_bf16 v[24:27], a[68:71], v[140:143], v[24:27]
    v_mfma_f32_16x16x32_bf16 v[28:31], a[68:71], v[196:199], v[28:31]
    v_mfma_f32_16x16x32_bf16 v[32:35], a[124:127], v[140:143], v[32:35]
    v_mfma_f32_16x16x32_bf16 v[36:39], a[124:127], v[196:199], v[36:39]
    v_mfma_f32_16x16x32_bf16 v[40:43], a[180:183], v[140:143], v[40:43]
    v_mfma_f32_16x16x32_bf16 v[44:47], a[180:183], v[196:199], v[44:47]
    v_mfma_f32_16x16x32_bf16 v[16:19], a[16:19], v[144:147], v[16:19]
    v_mfma_f32_16x16x32_bf16 v[20:23], a[16:19], v[200:203], v[20:23]
    v_mfma_f32_16x16x32_bf16 v[24:27], a[72:75], v[144:147], v[24:27]
    v_mfma_f32_16x16x32_bf16 v[28:31], a[72:75], v[200:203], v[28:31]
    v_mfma_f32_16x16x32_bf16 v[32:35], a[128:131], v[144:147], v[32:35]
    v_mfma_f32_16x16x32_bf16 v[36:39], a[128:131], v[200:203], v[36:39]
    v_mfma_f32_16x16x32_bf16 v[40:43], a[184:187], v[144:147], v[40:43]
    v_mfma_f32_16x16x32_bf16 v[44:47], a[184:187], v[200:203], v[44:47]
    v_mfma_f32_16x16x32_bf16 v[16:19], a[20:23], v[148:151], v[16:19]
    v_mfma_f32_16x16x32_bf16 v[20:23], a[20:23], v[204:207], v[20:23]
    v_mfma_f32_16x16x32_bf16 v[24:27], a[76:79], v[148:151], v[24:27]
    v_mfma_f32_16x16x32_bf16 v[28:31], a[76:79], v[204:207], v[28:31]
    v_mfma_f32_16x16x32_bf16 v[32:35], a[132:135], v[148:151], v[32:35]
    v_mfma_f32_16x16x32_bf16 v[36:39], a[132:135], v[204:207], v[36:39]
    v_mfma_f32_16x16x32_bf16 v[40:43], a[188:191], v[148:151], v[40:43]
    v_mfma_f32_16x16x32_bf16 v[44:47], a[188:191], v[204:207], v[44:47]
    v_mfma_f32_16x16x32_bf16 v[16:19], a[24:27], v[152:155], v[16:19]
    v_mfma_f32_16x16x32_bf16 v[20:23], a[24:27], v[208:211], v[20:23]
    v_mfma_f32_16x16x32_bf16 v[24:27], a[80:83], v[152:155], v[24:27]
    v_mfma_f32_16x16x32_bf16 v[28:31], a[80:83], v[208:211], v[28:31]
    v_mfma_f32_16x16x32_bf16 v[32:35], a[136:139], v[152:155], v[32:35]
    v_mfma_f32_16x16x32_bf16 v[36:39], a[136:139], v[208:211], v[36:39]
    v_mfma_f32_16x16x32_bf16 v[40:43], a[192:195], v[152:155], v[40:43]
    v_mfma_f32_16x16x32_bf16 v[44:47], a[192:195], v[208:211], v[44:47]
    v_mfma_f32_16x16x32_bf16 v[16:19], a[28:31], v[156:159], v[16:19]
    v_mfma_f32_16x16x32_bf16 v[20:23], a[28:31], v[212:215], v[20:23]
    v_mfma_f32_16x16x32_bf16 v[24:27], a[84:87], v[156:159], v[24:27]
    v_mfma_f32_16x16x32_bf16 v[28:31], a[84:87], v[212:215], v[28:31]
    v_mfma_f32_16x16x32_bf16 v[32:35], a[140:143], v[156:159], v[32:35]
    v_mfma_f32_16x16x32_bf16 v[36:39], a[140:143], v[212:215], v[36:39]
    v_mfma_f32_16x16x32_bf16 v[40:43], a[196:199], v[156:159], v[40:43]
    v_mfma_f32_16x16x32_bf16 v[44:47], a[196:199], v[212:215], v[44:47]
    v_mfma_f32_16x16x32_bf16 v[16:19], a[32:35], v[160:163], v[16:19]
    v_mfma_f32_16x16x32_bf16 v[20:23], a[32:35], v[216:219], v[20:23]
    v_mfma_f32_16x16x32_bf16 v[24:27], a[88:91], v[160:163], v[24:27]
    v_mfma_f32_16x16x32_bf16 v[28:31], a[88:91], v[216:219], v[28:31]
    v_mfma_f32_16x16x32_bf16 v[32:35], a[144:147], v[160:163], v[32:35]
    v_mfma_f32_16x16x32_bf16 v[36:39], a[144:147], v[216:219], v[36:39]
    v_mfma_f32_16x16x32_bf16 v[40:43], a[200:203], v[160:163], v[40:43]
    v_mfma_f32_16x16x32_bf16 v[44:47], a[200:203], v[216:219], v[44:47]
    v_mfma_f32_16x16x32_bf16 v[16:19], a[36:39], v[164:167], v[16:19]
    v_mfma_f32_16x16x32_bf16 v[20:23], a[36:39], v[220:223], v[20:23]
    v_mfma_f32_16x16x32_bf16 v[24:27], a[92:95], v[164:167], v[24:27]
    v_mfma_f32_16x16x32_bf16 v[28:31], a[92:95], v[220:223], v[28:31]
    v_mfma_f32_16x16x32_bf16 v[32:35], a[148:151], v[164:167], v[32:35]
    v_mfma_f32_16x16x32_bf16 v[36:39], a[148:151], v[220:223], v[36:39]
    v_mfma_f32_16x16x32_bf16 v[40:43], a[204:207], v[164:167], v[40:43]
    v_mfma_f32_16x16x32_bf16 v[44:47], a[204:207], v[220:223], v[44:47]
    v_mfma_f32_16x16x32_bf16 v[16:19], a[40:43], v[168:171], v[16:19]
    v_mfma_f32_16x16x32_bf16 v[20:23], a[40:43], v[224:227], v[20:23]
    v_mfma_f32_16x16x32_bf16 v[24:27], a[96:99], v[168:171], v[24:27]
    v_mfma_f32_16x16x32_bf16 v[28:31], a[96:99], v[224:227], v[28:31]
    v_mfma_f32_16x16x32_bf16 v[32:35], a[152:155], v[168:171], v[32:35]
    v_mfma_f32_16x16x32_bf16 v[36:39], a[152:155], v[224:227], v[36:39]
    v_mfma_f32_16x16x32_bf16 v[40:43], a[208:211], v[168:171], v[40:43]
    v_mfma_f32_16x16x32_bf16 v[44:47], a[208:211], v[224:227], v[44:47]
    v_mfma_f32_16x16x32_bf16 v[16:19], a[44:47], v[172:175], v[16:19]
    v_mfma_f32_16x16x32_bf16 v[20:23], a[44:47], v[228:231], v[20:23]
    v_mfma_f32_16x16x32_bf16 v[24:27], a[100:103], v[172:175], v[24:27]
    v_mfma_f32_16x16x32_bf16 v[28:31], a[100:103], v[228:231], v[28:31]
    v_mfma_f32_16x16x32_bf16 v[32:35], a[156:159], v[172:175], v[32:35]
    v_mfma_f32_16x16x32_bf16 v[36:39], a[156:159], v[228:231], v[36:39]
    v_mfma_f32_16x16x32_bf16 v[40:43], a[212:215], v[172:175], v[40:43]
    v_mfma_f32_16x16x32_bf16 v[44:47], a[212:215], v[228:231], v[44:47]
    v_mfma_f32_16x16x32_bf16 v[16:19], a[48:51], v[176:179], v[16:19]
    v_mfma_f32_16x16x32_bf16 v[20:23], a[48:51], v[232:235], v[20:23]
    v_mfma_f32_16x16x32_bf16 v[24:27], a[104:107], v[176:179], v[24:27]
    v_mfma_f32_16x16x32_bf16 v[28:31], a[104:107], v[232:235], v[28:31]
    v_mfma_f32_16x16x32_bf16 v[32:35], a[160:163], v[176:179], v[32:35]
    v_mfma_f32_16x16x32_bf16 v[36:39], a[160:163], v[232:235], v[36:39]
    v_mfma_f32_16x16x32_bf16 v[40:43], a[216:219], v[176:179], v[40:43]
    v_mfma_f32_16x16x32_bf16 v[44:47], a[216:219], v[232:235], v[44:47]
    v_mfma_f32_16x16x32_bf16 v[16:19], a[52:55], v[180:183], v[16:19]
    v_mfma_f32_16x16x32_bf16 v[20:23], a[52:55], v[236:239], v[20:23]
    v_mfma_f32_16x16x32_bf16 v[24:27], a[108:111], v[180:183], v[24:27]
    v_mfma_f32_16x16x32_bf16 v[28:31], a[108:111], v[236:239], v[28:31]
    v_mfma_f32_16x16x32_bf16 v[32:35], a[164:167], v[180:183], v[32:35]
    v_mfma_f32_16x16x32_bf16 v[36:39], a[164:167], v[236:239], v[36:39]
    v_mfma_f32_16x16x32_bf16 v[40:43], a[220:223], v[180:183], v[40:43]
    v_mfma_f32_16x16x32_bf16 v[44:47], a[220:223], v[236:239], v[44:47]
    s_nop 7
    s_nop 1
    s_lshl_b32 s24, s20, 13
    v_add_u32 v6, s24, v5
    ds_write_b128 v6, v[16:19] offset:0
    ds_write_b128 v6, v[20:23] offset:1024
    ds_write_b128 v6, v[24:27] offset:2048
    ds_write_b128 v6, v[28:31] offset:3072
    ds_write_b128 v6, v[32:35] offset:4096
    ds_write_b128 v6, v[36:39] offset:5120
    ds_write_b128 v6, v[40:43] offset:6144
    ds_write_b128 v6, v[44:47] offset:7168
    s_waitcnt lgkmcnt(0)
    s_barrier
    s_lshl_b32 s24, s20, 10
    v_add_u32 v6, s24, v5
    ds_read_b128 v[80:83], v6 offset:0
    ds_read_b128 v[84:87], v6 offset:8192
    ds_read_b128 v[88:91], v6 offset:16384
    ds_read_b128 v[92:95], v6 offset:24576
    s_waitcnt lgkmcnt(0)
    v_add_f32 v80, v80, v84
    v_add_f32 v88, v88, v92
    v_add_f32 v80, v80, v88
    v_add_f32 v81, v81, v85
    v_add_f32 v89, v89, v93
    v_add_f32 v81, v81, v89
    v_add_f32 v82, v82, v86
    v_add_f32 v90, v90, v94
    v_add_f32 v82, v82, v90
    v_add_f32 v83, v83, v87
    v_add_f32 v91, v91, v95
    v_add_f32 v83, v83, v91
    v_add_f32 v80, v80, v96
    v_add_f32 v81, v81, v97
    v_add_f32 v82, v82, v98
    v_add_f32 v83, v83, v99
    v_lshlrev_b32 v84, 16, v72
    v_and_b32 v85, 0xffff0000, v72
    v_lshlrev_b32 v86, 16, v73
    v_and_b32 v87, 0xffff0000, v73
    v_add_f32 v80, v80, v84
    v_add_f32 v81, v81, v85
    v_add_f32 v82, v82, v86
    v_add_f32 v83, v83, v87
    v_cvt_pk_bf16_f32 v104, v80, v81
    v_cvt_pk_bf16_f32 v105, v82, v83
    buffer_store_dwordx2 v[104:105], v9, s[12:15], s40 offen
    ds_read_b128 v[80:83], v6 offset:4096
    ds_read_b128 v[84:87], v6 offset:12288
    ds_read_b128 v[88:91], v6 offset:20480
    ds_read_b128 v[92:95], v6 offset:28672
    s_waitcnt lgkmcnt(0)
    v_add_f32 v80, v80, v84
    v_add_f32 v88, v88, v92
    v_add_f32 v80, v80, v88
    v_add_f32 v81, v81, v85
    v_add_f32 v89, v89, v93
    v_add_f32 v81, v81, v89
    v_add_f32 v82, v82, v86
    v_add_f32 v90, v90, v94
    v_add_f32 v82, v82, v90
    v_add_f32 v83, v83, v87
    v_add_f32 v91, v91, v95
    v_add_f32 v83, v83, v91
    v_add_f32 v80, v80, v100
    v_add_f32 v81, v81, v101
    v_add_f32 v82, v82, v102
    v_add_f32 v83, v83, v103
    v_lshlrev_b32 v84, 16, v74
    v_and_b32 v85, 0xffff0000, v74
    v_lshlrev_b32 v86, 16, v75
    v_and_b32 v87, 0xffff0000, v75
    v_add_f32 v80, v80, v84
    v_add_f32 v81, v81, v85
    v_add_f32 v82, v82, v86
    v_add_f32 v83, v83, v87
    v_cvt_pk_bf16_f32 v106, v80, v81
    v_cvt_pk_bf16_f32 v107, v82, v83
    buffer_store_dwordx2 v[106:107], v9, s[12:15], s41 offen
    s_waitcnt vmcnt(0)
    s_barrier
    s_branch K3_TASK
K3_PP:
    s_cmp_lt_u32 s22, 64
    s_cbranch_scc0 K3_TASK
    s_mov_b32 s21, 4290772927
    s_lshl_b32 s24, s23, 2
    s_add_u32 s24, s24, s20
    s_mul_i32 s25, s22, 28672
    s_mul_i32 s26, s20, 7168
    s_add_u32 s25, s25, s26
    s_add_u32 s25, s25, 2097152
    s_add_u32 s27, s25, 0
    s_add_u32 m0, s26, 0
    s_nop 0
    buffer_load_dwordx4 v5, s[8:11], s27 offen offset:0 sc1 lds
    buffer_load_dwordx4 v5, s[8:11], s27 offen offset:1024 sc1 lds
    buffer_load_dwordx4 v5, s[8:11], s27 offen offset:2048 sc1 lds
    buffer_load_dwordx4 v5, s[8:11], s27 offen offset:3072 sc1 lds
    s_add_u32 s27, s25, 4096
    s_add_u32 m0, s26, 4096
    s_nop 0
    buffer_load_dwordx4 v5, s[8:11], s27 offen offset:0 sc1 lds
    buffer_load_dwordx4 v5, s[8:11], s27 offen offset:1024 sc1 lds
    buffer_load_dwordx4 v5, s[8:11], s27 offen offset:2048 sc1 lds
    s_lshl_b32 s29, s22, 4
    s_add_u32 s29, s29, s24
    s_mul_i32 s30, s29, 28672
    s_add_u32 s30, s30, 17825792
    buffer_load_dwordx4 a[0:3], v5, s[8:11], s30 offen offset:0 sc1
    buffer_load_dwordx4 a[4:7], v5, s[8:11], s30 offen offset:1024 sc1
    buffer_load_dwordx4 a[8:11], v5, s[8:11], s30 offen offset:2048 sc1
    buffer_load_dwordx4 a[12:15], v5, s[8:11], s30 offen offset:3072 sc1
    s_add_u32 s30, s30, 4096
    buffer_load_dwordx4 a[16:19], v5, s[8:11], s30 offen offset:0 sc1
    buffer_load_dwordx4 a[20:23], v5, s[8:11], s30 offen offset:1024 sc1
    buffer_load_dwordx4 a[24:27], v5, s[8:11], s30 offen offset:2048 sc1
    buffer_load_dwordx4 a[28:31], v5, s[8:11], s30 offen offset:3072 sc1
    s_add_u32 s30, s30, 4096
    buffer_load_dwordx4 a[32:35], v5, s[8:11], s30 offen offset:0 sc1
    buffer_load_dwordx4 a[36:39], v5, s[8:11], s30 offen offset:1024 sc1
    buffer_load_dwordx4 a[40:43], v5, s[8:11], s30 offen offset:2048 sc1
    buffer_load_dwordx4 a[44:47], v5, s[8:11], s30 offen offset:3072 sc1
    s_add_u32 s30, s30, 4096
    buffer_load_dwordx4 a[48:51], v5, s[8:11], s30 offen offset:0 sc1
    buffer_load_dwordx4 a[52:55], v5, s[8:11], s30 offen offset:1024 sc1
    buffer_load_dwordx4 a[56:59], v5, s[8:11], s30 offen offset:2048 sc1
    buffer_load_dwordx4 a[60:63], v5, s[8:11], s30 offen offset:3072 sc1
    s_add_u32 s30, s30, 4096
    buffer_load_dwordx4 a[64:67], v5, s[8:11], s30 offen offset:0 sc1
    buffer_load_dwordx4 a[68:71], v5, s[8:11], s30 offen offset:1024 sc1
    buffer_load_dwordx4 a[72:75], v5, s[8:11], s30 offen offset:2048 sc1
    buffer_load_dwordx4 a[76:79], v5, s[8:11], s30 offen offset:3072 sc1
    s_add_u32 s30, s30, 4096
    buffer_load_dwordx4 a[80:83], v5, s[8:11], s30 offen offset:0 sc1
    buffer_load_dwordx4 a[84:87], v5, s[8:11], s30 offen offset:1024 sc1
    buffer_load_dwordx4 a[88:91], v5, s[8:11], s30 offen offset:2048 sc1
    buffer_load_dwordx4 a[92:95], v5, s[8:11], s30 offen offset:3072 sc1
    s_add_u32 s30, s30, 4096
    buffer_load_dwordx4 a[96:99], v5, s[8:11], s30 offen offset:0 sc1
    buffer_load_dwordx4 a[100:103], v5, s[8:11], s30 offen offset:1024 sc1
    buffer_load_dwordx4 a[104:107], v5, s[8:11], s30 offen offset:2048 sc1
    buffer_load_dwordx4 a[108:111], v5, s[8:11], s30 offen offset:3072 sc1
    s_waitcnt vmcnt(0)
    s_barrier
    ds_read_b128 v[56:59], v5 offset:0
    ds_read_b128 v[60:63], v5 offset:14336
    ds_read_b128 v[64:67], v5 offset:1024
    ds_read_b128 v[68:71], v5 offset:15360
    s_waitcnt lgkmcnt(3)
    ds_read_b128 v[72:75], v5 offset:2048
    v_mfma_f32_16x16x32_bf16 v[32:35], v[56:59], a[0:3], 0
    v_mfma_f32_16x16x32_bf16 v[36:39], v[56:59], a[4:7], 0
    s_waitcnt lgkmcnt(3)
    ds_read_b128 v[76:79], v5 offset:16384
    v_mfma_f32_16x16x32_bf16 v[40:43], v[60:63], a[0:3], 0
    v_mfma_f32_16x16x32_bf16 v[44:47], v[60:63], a[4:7], 0
    s_waitcnt lgkmcnt(3)
    ds_read_b128 v[56:59], v5 offset:3072
    v_mfma_f32_16x16x32_bf16 v[32:35], v[64:67], a[8:11], v[32:35]
    v_mfma_f32_16x16x32_bf16 v[36:39], v[64:67], a[12:15], v[36:39]
    s_waitcnt lgkmcnt(3)
    ds_read_b128 v[60:63], v5 offset:17408
    v_mfma_f32_16x16x32_bf16 v[40:43], v[68:71], a[8:11], v[40:43]
    v_mfma_f32_16x16x32_bf16 v[44:47], v[68:71], a[12:15], v[44:47]
    s_waitcnt lgkmcnt(3)
    ds_read_b128 v[64:67], v5 offset:4096
    v_mfma_f32_16x16x32_bf16 v[32:35], v[72:75], a[16:19], v[32:35]
    v_mfma_f32_16x16x32_bf16 v[36:39], v[72:75], a[20:23], v[36:39]
    s_waitcnt lgkmcnt(3)
    ds_read_b128 v[68:71], v5 offset:18432
    v_mfma_f32_16x16x32_bf16 v[40:43], v[76:79], a[16:19], v[40:43]
    v_mfma_f32_16x16x32_bf16 v[44:47], v[76:79], a[20:23], v[44:47]
    s_waitcnt lgkmcnt(3)
    ds_read_b128 v[72:75], v5 offset:5120
    v_mfma_f32_16x16x32_bf16 v[32:35], v[56:59], a[24:27], v[32:35]
    v_mfma_f32_16x16x32_bf16 v[36:39], v[56:59], a[28:31], v[36:39]
    s_waitcnt lgkmcnt(3)
    ds_read_b128 v[76:79], v5 offset:19456
    v_mfma_f32_16x16x32_bf16 v[40:43], v[60:63], a[24:27], v[40:43]
    v_mfma_f32_16x16x32_bf16 v[44:47], v[60:63], a[28:31], v[44:47]
    s_waitcnt lgkmcnt(3)
    ds_read_b128 v[56:59], v5 offset:6144
    v_mfma_f32_16x16x32_bf16 v[32:35], v[64:67], a[32:35], v[32:35]
    v_mfma_f32_16x16x32_bf16 v[36:39], v[64:67], a[36:39], v[36:39]
    s_waitcnt lgkmcnt(3)
    ds_read_b128 v[60:63], v5 offset:20480
    v_mfma_f32_16x16x32_bf16 v[40:43], v[68:71], a[32:35], v[40:43]
    v_mfma_f32_16x16x32_bf16 v[44:47], v[68:71], a[36:39], v[44:47]
    s_waitcnt lgkmcnt(3)
    ds_read_b128 v[64:67], v5 offset:7168
    v_mfma_f32_16x16x32_bf16 v[32:35], v[72:75], a[40:43], v[32:35]
    v_mfma_f32_16x16x32_bf16 v[36:39], v[72:75], a[44:47], v[36:39]
    s_waitcnt lgkmcnt(3)
    ds_read_b128 v[68:71], v5 offset:21504
    v_mfma_f32_16x16x32_bf16 v[40:43], v[76:79], a[40:43], v[40:43]
    v_mfma_f32_16x16x32_bf16 v[44:47], v[76:79], a[44:47], v[44:47]
    s_waitcnt lgkmcnt(3)
    ds_read_b128 v[72:75], v5 offset:8192
    v_mfma_f32_16x16x32_bf16 v[32:35], v[56:59], a[48:51], v[32:35]
    v_mfma_f32_16x16x32_bf16 v[36:39], v[56:59], a[52:55], v[36:39]
    s_waitcnt lgkmcnt(3)
    ds_read_b128 v[76:79], v5 offset:22528
    v_mfma_f32_16x16x32_bf16 v[40:43], v[60:63], a[48:51], v[40:43]
    v_mfma_f32_16x16x32_bf16 v[44:47], v[60:63], a[52:55], v[44:47]
    s_waitcnt lgkmcnt(3)
    ds_read_b128 v[56:59], v5 offset:9216
    v_mfma_f32_16x16x32_bf16 v[32:35], v[64:67], a[56:59], v[32:35]
    v_mfma_f32_16x16x32_bf16 v[36:39], v[64:67], a[60:63], v[36:39]
    s_waitcnt lgkmcnt(3)
    ds_read_b128 v[60:63], v5 offset:23552
    v_mfma_f32_16x16x32_bf16 v[40:43], v[68:71], a[56:59], v[40:43]
    v_mfma_f32_16x16x32_bf16 v[44:47], v[68:71], a[60:63], v[44:47]
    s_waitcnt lgkmcnt(3)
    ds_read_b128 v[64:67], v5 offset:10240
    v_mfma_f32_16x16x32_bf16 v[32:35], v[72:75], a[64:67], v[32:35]
    v_mfma_f32_16x16x32_bf16 v[36:39], v[72:75], a[68:71], v[36:39]
    s_waitcnt lgkmcnt(3)
    ds_read_b128 v[68:71], v5 offset:24576
    v_mfma_f32_16x16x32_bf16 v[40:43], v[76:79], a[64:67], v[40:43]
    v_mfma_f32_16x16x32_bf16 v[44:47], v[76:79], a[68:71], v[44:47]
    s_waitcnt lgkmcnt(3)
    ds_read_b128 v[72:75], v5 offset:11264
    v_mfma_f32_16x16x32_bf16 v[32:35], v[56:59], a[72:75], v[32:35]
    v_mfma_f32_16x16x32_bf16 v[36:39], v[56:59], a[76:79], v[36:39]
    s_waitcnt lgkmcnt(3)
    ds_read_b128 v[76:79], v5 offset:25600
    v_mfma_f32_16x16x32_bf16 v[40:43], v[60:63], a[72:75], v[40:43]
    v_mfma_f32_16x16x32_bf16 v[44:47], v[60:63], a[76:79], v[44:47]
    s_waitcnt lgkmcnt(3)
    ds_read_b128 v[56:59], v5 offset:12288
    v_mfma_f32_16x16x32_bf16 v[32:35], v[64:67], a[80:83], v[32:35]
    v_mfma_f32_16x16x32_bf16 v[36:39], v[64:67], a[84:87], v[36:39]
    s_waitcnt lgkmcnt(3)
    ds_read_b128 v[60:63], v5 offset:26624
    v_mfma_f32_16x16x32_bf16 v[40:43], v[68:71], a[80:83], v[40:43]
    v_mfma_f32_16x16x32_bf16 v[44:47], v[68:71], a[84:87], v[44:47]
    s_waitcnt lgkmcnt(3)
    ds_read_b128 v[64:67], v5 offset:13312
    v_mfma_f32_16x16x32_bf16 v[32:35], v[72:75], a[88:91], v[32:35]
    v_mfma_f32_16x16x32_bf16 v[36:39], v[72:75], a[92:95], v[36:39]
    s_waitcnt lgkmcnt(3)
    ds_read_b128 v[68:71], v5 offset:27648
    v_mfma_f32_16x16x32_bf16 v[40:43], v[76:79], a[88:91], v[40:43]
    v_mfma_f32_16x16x32_bf16 v[44:47], v[76:79], a[92:95], v[44:47]
    s_waitcnt lgkmcnt(3)
    v_mfma_f32_16x16x32_bf16 v[32:35], v[56:59], a[96:99], v[32:35]
    v_mfma_f32_16x16x32_bf16 v[36:39], v[56:59], a[100:103], v[36:39]
    s_waitcnt lgkmcnt(2)
    v_mfma_f32_16x16x32_bf16 v[40:43], v[60:63], a[96:99], v[40:43]
    v_mfma_f32_16x16x32_bf16 v[44:47], v[60:63], a[100:103], v[44:47]
    s_waitcnt lgkmcnt(1)
    v_mfma_f32_16x16x32_bf16 v[32:35], v[64:67], a[104:107], v[32:35]
    v_mfma_f32_16x16x32_bf16 v[36:39], v[64:67], a[108:111], v[36:39]
    s_waitcnt lgkmcnt(0)
    v_mfma_f32_16x16x32_bf16 v[40:43], v[68:71], a[104:107], v[40:43]
    v_mfma_f32_16x16x32_bf16 v[44:47], v[68:71], a[108:111], v[44:47]
    s_cmp_eq_u32 s20, 0
    s_cbranch_scc0 L_wmp_15_b
    v_min_u32 v12, 27, v1
    v_lshlrev_b32 v12, 8, v12
    s_lshl_b32 s61, s22, 13
    s_add_u32 s61, s61, 93585408
    s_mov_b32 s59, 4290772927
    s_mov_b32 s60, 0
L_wmp_15:
    buffer_load_dword v13, v12, s[8:11], s61 offen sc1
    s_add_u32 s60, s60, 1
    s_waitcnt vmcnt(0)
    v_cmp_eq_u32 vcc, s59, v13
    s_cbranch_vccz L_wmp_15_b
    s_sleep 2
    s_cmp_lt_u32 s60, 65536
    s_cbranch_scc1 L_wmp_15
L_wmp_15_b:
    s_barrier
    v_and_b32 v6, 7, v1
    v_lshlrev_b32 v6, 4, v6
    v_lshrrev_b32 v7, 4, v1
    v_lshl_add_u32 v6, v7, 2, v6
    s_mov_b32 s60, 0
PP_LD:
    s_lshl_b32 s27, s22, 13
    s_add_u32 s27, s27, 93585408
    s_lshl_b32 s28, s20, 9
    s_add_u32 s27, s27, s28
    buffer_load_dword v16, v6, s[8:11], s27 offen offset:0 sc1
    buffer_load_dword v17, v6, s[8:11], s27 offen offset:128 sc1
    buffer_load_dword v18, v6, s[8:11], s27 offen offset:256 sc1
    buffer_load_dword v19, v6, s[8:11], s27 offen offset:384 sc1
    s_add_u32 s27, s27, 2048
    buffer_load_dword v20, v6, s[8:11], s27 offen offset:0 sc1
    buffer_load_dword v21, v6, s[8:11], s27 offen offset:128 sc1
    buffer_load_dword v22, v6, s[8:11], s27 offen offset:256 sc1
    buffer_load_dword v23, v6, s[8:11], s27 offen offset:384 sc1
    s_add_u32 s27, s27, 2048
    buffer_load_dword v24, v6, s[8:11], s27 offen offset:0 sc1
    buffer_load_dword v25, v6, s[8:11], s27 offen offset:128 sc1
    buffer_load_dword v26, v6, s[8:11], s27 offen offset:256 sc1
    buffer_load_dword v27, v6, s[8:11], s27 offen offset:384 sc1
    s_add_u32 s27, s27, 2048
    buffer_load_dword v28, v6, s[8:11], s27 offen offset:0 sc1
    buffer_load_dword v29, v6, s[8:11], s27 offen offset:128 sc1
    buffer_load_dword v30, v6, s[8:11], s27 offen offset:256 sc1
    buffer_load_dword v31, v6, s[8:11], s27 offen offset:384 sc1
    s_add_u32 s27, s27, 2048
    s_add_u32 s60, s60, 1
    s_waitcnt vmcnt(0)
    v_max3_u32 v80, v16, v17, v18
    v_max3_u32 v80, v80, v19, v20
    v_max3_u32 v80, v80, v21, v22
    v_max3_u32 v80, v80, v23, v24
    v_max3_u32 v80, v80, v25, v26
    v_max_u32 v80, v80, v27
    v_max3_u32 v81, v28, v29, v30
    v_max_u32 v81, v81, v31
    s_cmp_ge_u32 s20, 2
    s_cselect_b32 s28, 0, -1
    v_and_b32 v81, s28, v81
    v_max_u32 v80, v80, v81
    v_cmp_eq_u32 vcc, s21, v80
    s_cbranch_vccz PP_OK
    s_cmp_lt_u32 s60, 65536
    s_cbranch_scc1 PP_LD
PP_OK:
    s_lshl_b32 s28, s20, 10
    v_add_u32 v8, s28, v5
    ds_write_b128 v8, v[16:19] offset:28672
    ds_write_b128 v8, v[20:23] offset:32768
    ds_write_b128 v8, v[24:27] offset:36864
    ds_write_b128 v8, v[28:31] offset:40960
    s_waitcnt lgkmcnt(0)
    s_barrier
    ds_read_b128 v[56:59], v5 offset:28672
    ds_read_b128 v[60:63], v5 offset:29696
    ds_read_b128 v[64:67], v5 offset:30720
    ds_read_b128 v[68:71], v5 offset:31744
    s_waitcnt lgkmcnt(3)
    ds_read_b128 v[72:75], v5 offset:32768
    v_mfma_f32_16x16x32_bf16 v[48:51], v[56:59], a[0:3], 0
    v_mfma_f32_16x16x32_bf16 v[52:55], v[56:59], a[4:7], 0
    s_waitcnt lgkmcnt(3)
    ds_read_b128 v[76:79], v5 offset:33792
    v_mfma_f32_16x16x32_bf16 v[48:51], v[60:63], a[8:11], v[48:51]
    v_mfma_f32_16x16x32_bf16 v[52:55], v[60:63], a[12:15], v[52:55]
    s_waitcnt lgkmcnt(3)
    ds_read_b128 v[56:59], v5 offset:34816
    v_mfma_f32_16x16x32_bf16 v[48:51], v[64:67], a[16:19], v[48:51]
    v_mfma_f32_16x16x32_bf16 v[52:55], v[64:67], a[20:23], v[52:55]
    s_waitcnt lgkmcnt(3)
    ds_read_b128 v[60:63], v5 offset:35840
    v_mfma_f32_16x16x32_bf16 v[48:51], v[68:71], a[24:27], v[48:51]
    v_mfma_f32_16x16x32_bf16 v[52:55], v[68:71], a[28:31], v[52:55]
    s_waitcnt lgkmcnt(3)
    ds_read_b128 v[64:67], v5 offset:36864
    v_mfma_f32_16x16x32_bf16 v[48:51], v[72:75], a[32:35], v[48:51]
    v_mfma_f32_16x16x32_bf16 v[52:55], v[72:75], a[36:39], v[52:55]
    s_waitcnt lgkmcnt(3)
    ds_read_b128 v[68:71], v5 offset:37888
    v_mfma_f32_16x16x32_bf16 v[48:51], v[76:79], a[40:43], v[48:51]
    v_mfma_f32_16x16x32_bf16 v[52:55], v[76:79], a[44:47], v[52:55]
    s_waitcnt lgkmcnt(3)
    ds_read_b128 v[72:75], v5 offset:38912
    v_mfma_f32_16x16x32_bf16 v[48:51], v[56:59], a[48:51], v[48:51]
    v_mfma_f32_16x16x32_bf16 v[52:55], v[56:59], a[52:55], v[52:55]
    s_waitcnt lgkmcnt(3)
    ds_read_b128 v[76:79], v5 offset:39936
    v_mfma_f32_16x16x32_bf16 v[48:51], v[60:63], a[56:59], v[48:51]
    v_mfma_f32_16x16x32_bf16 v[52:55], v[60:63], a[60:63], v[52:55]
    s_waitcnt lgkmcnt(3)
    ds_read_b128 v[56:59], v5 offset:40960
    v_mfma_f32_16x16x32_bf16 v[48:51], v[64:67], a[64:67], v[48:51]
    v_mfma_f32_16x16x32_bf16 v[52:55], v[64:67], a[68:71], v[52:55]
    s_waitcnt lgkmcnt(3)
    ds_read_b128 v[60:63], v5 offset:41984
    v_mfma_f32_16x16x32_bf16 v[48:51], v[68:71], a[72:75], v[48:51]
    v_mfma_f32_16x16x32_bf16 v[52:55], v[68:71], a[76:79], v[52:55]
    s_waitcnt lgkmcnt(3)
    v_mfma_f32_16x16x32_bf16 v[48:51], v[72:75], a[80:83], v[48:51]
    v_mfma_f32_16x16x32_bf16 v[52:55], v[72:75], a[84:87], v[52:55]
    s_waitcnt lgkmcnt(2)
    v_mfma_f32_16x16x32_bf16 v[48:51], v[76:79], a[88:91], v[48:51]
    v_mfma_f32_16x16x32_bf16 v[52:55], v[76:79], a[92:95], v[52:55]
    s_waitcnt lgkmcnt(1)
    v_mfma_f32_16x16x32_bf16 v[48:51], v[56:59], a[96:99], v[48:51]
    v_mfma_f32_16x16x32_bf16 v[52:55], v[56:59], a[100:103], v[52:55]
    s_waitcnt lgkmcnt(0)
    v_mfma_f32_16x16x32_bf16 v[48:51], v[60:63], a[104:107], v[48:51]
    v_mfma_f32_16x16x32_bf16 v[52:55], v[60:63], a[108:111], v[52:55]
    s_nop 7
    s_nop 1
    v_and_b32 v6, 15, v1
    v_lshrrev_b32 v7, 4, v1
    v_lshlrev_b32 v7, 2, v7
    s_mov_b32 s31, 0xff7fffff
    s_mov_b32 s32, 0x3fb8aa3b
    v_mov_b32 v15, s31
    v_add_u32 v9, 0, v7
    v_cmp_gt_u32 vcc, v9, v6
    s_nop 1
    v_cndmask_b32 v32, v32, v15, vcc
    v_add_u32 v9, 1, v7
    v_cmp_gt_u32 vcc, v9, v6
    s_nop 1
    v_cndmask_b32 v33, v33, v15, vcc
    v_add_u32 v9, 2, v7
    v_cmp_gt_u32 vcc, v9, v6
    s_nop 1
    v_cndmask_b32 v34, v34, v15, vcc
    v_add_u32 v9, 3, v7
    v_cmp_gt_u32 vcc, v9, v6
    s_nop 1
    v_cndmask_b32 v35, v35, v15, vcc
    v_mov_b32 v40, v15
    v_mov_b32 v41, v15
    v_mov_b32 v42, v15
    v_mov_b32 v43, v15
    v_add_u32 v9, 0, v7
    v_cmp_gt_u32 vcc, v9, v6
    s_nop 1
    v_cndmask_b32 v44, v44, v15, vcc
    v_add_u32 v9, 1, v7
    v_cmp_gt_u32 vcc, v9, v6
    s_nop 1
    v_cndmask_b32 v45, v45, v15, vcc
    v_add_u32 v9, 2, v7
    v_cmp_gt_u32 vcc, v9, v6
    s_nop 1
    v_cndmask_b32 v46, v46, v15, vcc
    v_add_u32 v9, 3, v7
    v_cmp_gt_u32 vcc, v9, v6
    s_nop 1
    v_cndmask_b32 v47, v47, v15, vcc
    v_max3_f32 v10, v32, v33, v34
    v_max3_f32 v10, v10, v35, v40
    v_max3_f32 v10, v10, v41, v42
    v_max3_f32 v10, v10, v43, v48
    v_max3_f32 v10, v10, v49, v50
    v_max_f32 v10, v10, v51
    v_mov_b32 v11, v10
    s_nop 1
    v_permlane16_swap_b32 v10, v11
    s_nop 1
    v_max_f32 v10, v10, v11
    v_mov_b32 v11, v10
    s_nop 1
    v_permlane32_swap_b32 v10, v11
    s_nop 1
    v_max_f32 v10, v10, v11
    v_mul_f32 v10, s32, v10
    v_fma_f32 v32, v32, s32, -v10
    v_fma_f32 v33, v33, s32, -v10
    v_fma_f32 v34, v34, s32, -v10
    v_fma_f32 v35, v35, s32, -v10
    v_fma_f32 v40, v40, s32, -v10
    v_fma_f32 v41, v41, s32, -v10
    v_fma_f32 v42, v42, s32, -v10
    v_fma_f32 v43, v43, s32, -v10
    v_fma_f32 v48, v48, s32, -v10
    v_fma_f32 v49, v49, s32, -v10
    v_fma_f32 v50, v50, s32, -v10
    v_fma_f32 v51, v51, s32, -v10
    v_exp_f32 v32, v32
    v_exp_f32 v33, v33
    v_exp_f32 v34, v34
    v_exp_f32 v35, v35
    v_exp_f32 v40, v40
    v_exp_f32 v41, v41
    v_exp_f32 v42, v42
    v_exp_f32 v43, v43
    v_exp_f32 v48, v48
    v_exp_f32 v49, v49
    v_exp_f32 v50, v50
    v_exp_f32 v51, v51
    s_nop 0
    v_add_f32 v12, v48, v49
    v_add_f32 v11, v50, v51
    v_add_f32 v12, v12, v11
    v_mul_f32 v12, 0.5, v12
    v_add_f32 v12, v12, v32
    v_add_f32 v12, v12, v33
    v_add_f32 v12, v12, v34
    v_add_f32 v12, v12, v35
    v_add_f32 v12, v12, v40
    v_add_f32 v12, v12, v41
    v_add_f32 v12, v12, v42
    v_add_f32 v12, v12, v43
    v_mov_b32 v11, v12
    s_nop 1
    v_permlane16_swap_b32 v12, v11
    s_nop 1
    v_add_f32 v12, v12, v11
    v_mov_b32 v11, v12
    s_nop 1
    v_permlane32_swap_b32 v12, v11
    s_nop 1
    v_add_f32 v12, v12, v11
    v_rcp_f32 v12, v12
    s_nop 0
    v_mul_f32 v32, v32, v12
    v_mul_f32 v33, v33, v12
    v_mul_f32 v34, v34, v12
    v_mul_f32 v35, v35, v12
    v_mul_f32 v40, v40, v12
    v_mul_f32 v41, v41, v12
    v_mul_f32 v42, v42, v12
    v_mul_f32 v43, v43, v12
    v_mul_f32 v48, v48, v12
    v_mul_f32 v49, v49, v12
    v_mul_f32 v50, v50, v12
    v_mul_f32 v51, v51, v12
    v_cvt_pk_bf16_f32 v84, v32, v33
    v_cvt_pk_bf16_f32 v85, v34, v35
    v_cvt_pk_bf16_f32 v86, v40, v41
    v_cvt_pk_bf16_f32 v87, v42, v43
    v_cvt_pk_bf16_f32 v88, v48, v49
    v_cvt_pk_bf16_f32 v89, v50, v51
    s_lshl_b32 s33, s29, 11
    s_add_u32 s33, s33, 94371840
    s_lshl_b32 s34, s29, 10
    s_add_u32 s34, s34, 96468992
    buffer_store_dwordx4 v[84:87], v5, s[8:11], s33 offen sc1
    v_lshlrev_b32 v9, 3, v1
    buffer_store_dwordx2 v[88:89], v9, s[8:11], s34 offen sc1
    v_max3_f32 v10, v36, v37, v38
    v_max3_f32 v10, v10, v39, v44
    v_max3_f32 v10, v10, v45, v46
    v_max3_f32 v10, v10, v47, v52
    v_max3_f32 v10, v10, v53, v54
    v_max_f32 v10, v10, v55
    v_mov_b32 v11, v10
    s_nop 1
    v_permlane16_swap_b32 v10, v11
    s_nop 1
    v_max_f32 v10, v10, v11
    v_mov_b32 v11, v10
    s_nop 1
    v_permlane32_swap_b32 v10, v11
    s_nop 1
    v_max_f32 v10, v10, v11
    v_mul_f32 v10, s32, v10
    v_fma_f32 v36, v36, s32, -v10
    v_fma_f32 v37, v37, s32, -v10
    v_fma_f32 v38, v38, s32, -v10
    v_fma_f32 v39, v39, s32, -v10
    v_fma_f32 v44, v44, s32, -v10
    v_fma_f32 v45, v45, s32, -v10
    v_fma_f32 v46, v46, s32, -v10
    v_fma_f32 v47, v47, s32, -v10
    v_fma_f32 v52, v52, s32, -v10
    v_fma_f32 v53, v53, s32, -v10
    v_fma_f32 v54, v54, s32, -v10
    v_fma_f32 v55, v55, s32, -v10
    v_exp_f32 v36, v36
    v_exp_f32 v37, v37
    v_exp_f32 v38, v38
    v_exp_f32 v39, v39
    v_exp_f32 v44, v44
    v_exp_f32 v45, v45
    v_exp_f32 v46, v46
    v_exp_f32 v47, v47
    v_exp_f32 v52, v52
    v_exp_f32 v53, v53
    v_exp_f32 v54, v54
    v_exp_f32 v55, v55
    s_nop 0
    v_add_f32 v12, v52, v53
    v_add_f32 v11, v54, v55
    v_add_f32 v12, v12, v11
    v_mul_f32 v12, 0.5, v12
    v_add_f32 v12, v12, v36
    v_add_f32 v12, v12, v37
    v_add_f32 v12, v12, v38
    v_add_f32 v12, v12, v39
    v_add_f32 v12, v12, v44
    v_add_f32 v12, v12, v45
    v_add_f32 v12, v12, v46
    v_add_f32 v12, v12, v47
    v_mov_b32 v11, v12
    s_nop 1
    v_permlane16_swap_b32 v12, v11
    s_nop 1
    v_add_f32 v12, v12, v11
    v_mov_b32 v11, v12
    s_nop 1
    v_permlane32_swap_b32 v12, v11
    s_nop 1
    v_add_f32 v12, v12, v11
    v_rcp_f32 v12, v12
    s_nop 0
    v_mul_f32 v36, v36, v12
    v_mul_f32 v37, v37, v12
    v_mul_f32 v38, v38, v12
    v_mul_f32 v39, v39, v12
    v_mul_f32 v44, v44, v12
    v_mul_f32 v45, v45, v12
    v_mul_f32 v46, v46, v12
    v_mul_f32 v47, v47, v12
    v_mul_f32 v52, v52, v12
    v_mul_f32 v53, v53, v12
    v_mul_f32 v54, v54, v12
    v_mul_f32 v55, v55, v12
    v_cvt_pk_bf16_f32 v92, v36, v37
    v_cvt_pk_bf16_f32 v93, v38, v39
    v_cvt_pk_bf16_f32 v94, v44, v45
    v_cvt_pk_bf16_f32 v95, v46, v47
    v_cvt_pk_bf16_f32 v96, v52, v53
    v_cvt_pk_bf16_f32 v97, v54, v55
    s_lshl_b32 s33, s29, 11
    s_add_u32 s33, s33, 94372864
    s_lshl_b32 s34, s29, 10
    s_add_u32 s34, s34, 96469504
    buffer_store_dwordx4 v[92:95], v5, s[8:11], s33 offen sc1
    v_lshlrev_b32 v9, 3, v1
    buffer_store_dwordx2 v[96:97], v9, s[8:11], s34 offen sc1
    s_lshl_b32 s37, s22, 6
    s_lshl_b32 s38, s23, 2
    s_add_u32 s37, s37, s38
    s_add_u32 s37, s37, 94191616
    s_waitcnt vmcnt(0)
    s_barrier
    s_cmp_eq_u32 s20, 0
    s_cbranch_scc0 L_sf_16
    v_mov_b32 v12, 1
    v_mov_b32 v13, 0
    s_mov_b64 exec, 1
    buffer_store_dword v12, v13, s[8:11], s37 offen sc1
    s_mov_b64 exec, -1
L_sf_16:
    s_branch K3_TASK
K3_PO:
    s_sub_u32 s23, s23, 4
    s_cmp_lt_u32 s22, 64
    s_cbranch_scc0 K3_TASK
    s_load_dwordx2 s[12:13], s[0:1], 0
    v_lshlrev_b32 v2, 3, v1
    s_waitcnt lgkmcnt(0)
    s_and_b32 s13, s13, 0xffff
    s_mov_b32 s14, 1835008
    s_mov_b32 s15, 0x00020000
    s_lshl_b32 s24, s20, 2
    s_add_u32 s24, s24, 0
    s_lshl_b32 s25, s22, 4
    s_add_u32 s25, s25, s24
    s_mul_i32 s26, s25, 28
    s_mul_i32 s27, s23, 7
    s_add_u32 s26, s26, s27
    s_lshl_b32 s28, s26, 10
    s_add_u32 s28, s28, 47185920
    buffer_load_dwordx4 a[0:3], v5, s[8:11], s28 offen offset:0 sc1
    buffer_load_dwordx4 a[4:7], v5, s[8:11], s28 offen offset:1024 sc1
    buffer_load_dwordx4 a[8:11], v5, s[8:11], s28 offen offset:2048 sc1
    buffer_load_dwordx4 a[12:15], v5, s[8:11], s28 offen offset:3072 sc1
    s_add_u32 s28, s28, 4096
    buffer_load_dwordx4 a[16:19], v5, s[8:11], s28 offen offset:0 sc1
    buffer_load_dwordx4 a[20:23], v5, s[8:11], s28 offen offset:1024 sc1
    buffer_load_dwordx4 a[24:27], v5, s[8:11], s28 offen offset:2048 sc1
    s_lshl_b32 s24, s20, 2
    s_add_u32 s24, s24, 1
    s_lshl_b32 s25, s22, 4
    s_add_u32 s25, s25, s24
    s_mul_i32 s26, s25, 28
    s_mul_i32 s27, s23, 7
    s_add_u32 s26, s26, s27
    s_lshl_b32 s28, s26, 10
    s_add_u32 s28, s28, 47185920
    buffer_load_dwordx4 a[28:31], v5, s[8:11], s28 offen offset:0 sc1
    buffer_load_dwordx4 a[32:35], v5, s[8:11], s28 offen offset:1024 sc1
    buffer_load_dwordx4 a[36:39], v5, s[8:11], s28 offen offset:2048 sc1
    buffer_load_dwordx4 a[40:43], v5, s[8:11], s28 offen offset:3072 sc1
    s_add_u32 s28, s28, 4096
    buffer_load_dwordx4 a[44:47], v5, s[8:11], s28 offen offset:0 sc1
    buffer_load_dwordx4 a[48:51], v5, s[8:11], s28 offen offset:1024 sc1
    buffer_load_dwordx4 a[52:55], v5, s[8:11], s28 offen offset:2048 sc1
    s_lshl_b32 s24, s20, 2
    s_add_u32 s24, s24, 2
    s_lshl_b32 s25, s22, 4
    s_add_u32 s25, s25, s24
    s_mul_i32 s26, s25, 28
    s_mul_i32 s27, s23, 7
    s_add_u32 s26, s26, s27
    s_lshl_b32 s28, s26, 10
    s_add_u32 s28, s28, 47185920
    buffer_load_dwordx4 a[56:59], v5, s[8:11], s28 offen offset:0 sc1
    buffer_load_dwordx4 a[60:63], v5, s[8:11], s28 offen offset:1024 sc1
    buffer_load_dwordx4 a[64:67], v5, s[8:11], s28 offen offset:2048 sc1
    buffer_load_dwordx4 a[68:71], v5, s[8:11], s28 offen offset:3072 sc1
    s_add_u32 s28, s28, 4096
    buffer_load_dwordx4 a[72:75], v5, s[8:11], s28 offen offset:0 sc1
    buffer_load_dwordx4 a[76:79], v5, s[8:11], s28 offen offset:1024 sc1
    buffer_load_dwordx4 a[80:83], v5, s[8:11], s28 offen offset:2048 sc1
    s_lshl_b32 s24, s20, 2
    s_add_u32 s24, s24, 3
    s_lshl_b32 s25, s22, 4
    s_add_u32 s25, s25, s24
    s_mul_i32 s26, s25, 28
    s_mul_i32 s27, s23, 7
    s_add_u32 s26, s26, s27
    s_lshl_b32 s28, s26, 10
    s_add_u32 s28, s28, 47185920
    buffer_load_dwordx4 a[84:87], v5, s[8:11], s28 offen offset:0 sc1
    buffer_load_dwordx4 a[88:91], v5, s[8:11], s28 offen offset:1024 sc1
    buffer_load_dwordx4 a[92:95], v5, s[8:11], s28 offen offset:2048 sc1
    buffer_load_dwordx4 a[96:99], v5, s[8:11], s28 offen offset:3072 sc1
    s_add_u32 s28, s28, 4096
    buffer_load_dwordx4 a[100:103], v5, s[8:11], s28 offen offset:0 sc1
    buffer_load_dwordx4 a[104:107], v5, s[8:11], s28 offen offset:1024 sc1
    buffer_load_dwordx4 a[108:111], v5, s[8:11], s28 offen offset:2048 sc1
    v_and_b32 v7, 15, v1
    v_lshrrev_b32 v8, 4, v1
    v_mul_u32_u24 v9, 896, v7
    v_lshl_add_u32 v9, v8, 3, v9
    s_add_u32 s25, s20, 0
    s_min_u32 s25, s25, 13
    s_lshr_b32 s26, s25, 1
    s_and_b32 s27, s25, 1
    s_mul_i32 s28, s23, 7
    s_add_u32 s28, s28, s26
    s_lshl_b32 s28, s28, 5
    s_lshl_b32 s29, s22, 1
    s_add_u32 s29, s29, s27
    s_mul_i32 s29, s29, 14336
    s_add_u32 s40, s29, s28
    buffer_load_dwordx2 v[72:73], v9, s[12:15], s40 offen
    s_add_u32 s25, s20, 4
    s_min_u32 s25, s25, 13
    s_lshr_b32 s26, s25, 1
    s_and_b32 s27, s25, 1
    s_mul_i32 s28, s23, 7
    s_add_u32 s28, s28, s26
    s_lshl_b32 s28, s28, 5
    s_lshl_b32 s29, s22, 1
    s_add_u32 s29, s29, s27
    s_mul_i32 s29, s29, 14336
    s_add_u32 s41, s29, s28
    buffer_load_dwordx2 v[74:75], v9, s[12:15], s41 offen
    s_add_u32 s25, s20, 8
    s_min_u32 s25, s25, 13
    s_lshr_b32 s26, s25, 1
    s_and_b32 s27, s25, 1
    s_mul_i32 s28, s23, 7
    s_add_u32 s28, s28, s26
    s_lshl_b32 s28, s28, 5
    s_lshl_b32 s29, s22, 1
    s_add_u32 s29, s29, s27
    s_mul_i32 s29, s29, 14336
    s_add_u32 s42, s29, s28
    buffer_load_dwordx2 v[76:77], v9, s[12:15], s42 offen
    s_add_u32 s25, s20, 12
    s_min_u32 s25, s25, 13
    s_lshr_b32 s26, s25, 1
    s_and_b32 s27, s25, 1
    s_mul_i32 s28, s23, 7
    s_add_u32 s28, s28, s26
    s_lshl_b32 s28, s28, 5
    s_lshl_b32 s29, s22, 1
    s_add_u32 s29, s29, s27
    s_mul_i32 s29, s29, 14336
    s_add_u32 s43, s29, s28
    buffer_load_dwordx2 v[78:79], v9, s[12:15], s43 offen
    s_lshl_b32 s37, s22, 6
    s_add_u32 s37, s37, 94191616
    s_cmp_eq_u32 s20, 0
    s_cbranch_scc0 L_wfop_17_b
    v_min_u32 v12, 3, v1
    v_mul_u32_u24 v12, 1, v12
    v_add_u32 v12, 0, v12
    v_lshlrev_b32 v12, 2, v12
    s_mov_b32 s60, 0
L_wfop_17:
    buffer_load_dword v13, v12, s[8:11], s37 offen sc1
    s_add_u32 s60, s60, 1
    s_waitcnt vmcnt(0)
    v_cmp_eq_u32 vcc, 0, v13
    s_cbranch_vccz L_wfop_17_b
    s_sleep 2
    s_cmp_lt_u32 s60, 65536
    s_cbranch_scc1 L_wfop_17
L_wfop_17_b:
    s_barrier
    s_lshl_b32 s37, s22, 8
    s_lshr_b32 s38, s23, 1
    s_lshl_b32 s38, s38, 2
    s_add_u32 s37, s37, s38
    s_add_u32 s37, s37, 94175232
    s_cmp_eq_u32 s20, 0
    s_cbranch_scc0 L_wfot_18_b
    v_min_u32 v12, 15, v1
    v_mul_u32_u24 v12, 2, v12
    v_add_u32 v12, 0, v12
    v_lshlrev_b32 v12, 2, v12
    s_mov_b32 s60, 0
L_wfot_18:
    buffer_load_dword v13, v12, s[8:11], s37 offen sc1
    s_add_u32 s60, s60, 1
    s_waitcnt vmcnt(0)
    v_cmp_eq_u32 vcc, 0, v13
    s_cbranch_vccz L_wfot_18_b
    s_sleep 2
    s_cmp_lt_u32 s60, 65536
    s_cbranch_scc1 L_wfot_18
L_wfot_18_b:
    s_barrier
    s_lshl_b32 s24, s20, 2
    s_add_u32 s24, s24, 0
    s_lshl_b32 s25, s22, 4
    s_add_u32 s25, s25, s24
    s_lshl_b32 s28, s25, 11
    s_add_u32 s28, s28, 94371840
    buffer_load_dwordx4 v[128:131], v5, s[8:11], s28 offen offset:0 sc1
    buffer_load_dwordx4 v[132:135], v5, s[8:11], s28 offen offset:1024 sc1
    s_lshl_b32 s28, s25, 10
    s_add_u32 s28, s28, 96468992
    buffer_load_dwordx2 v[160:161], v2, s[8:11], s28 offen offset:0 sc1
    buffer_load_dwordx2 v[162:163], v2, s[8:11], s28 offen offset:512 sc1
    s_mul_i32 s26, s25, 28
    s_mul_i32 s27, s23, 7
    s_add_u32 s26, s26, s27
    s_lshl_b32 s28, s26, 9
    s_add_u32 s28, s28, 76546048
    buffer_load_dwordx2 a[112:113], v2, s[8:11], s28 offen offset:0 sc1
    buffer_load_dwordx2 a[114:115], v2, s[8:11], s28 offen offset:512 sc1
    buffer_load_dwordx2 a[116:117], v2, s[8:11], s28 offen offset:1024 sc1
    buffer_load_dwordx2 a[118:119], v2, s[8:11], s28 offen offset:1536 sc1
    buffer_load_dwordx2 a[120:121], v2, s[8:11], s28 offen offset:2048 sc1
    buffer_load_dwordx2 a[122:123], v2, s[8:11], s28 offen offset:2560 sc1
    buffer_load_dwordx2 a[124:125], v2, s[8:11], s28 offen offset:3072 sc1
    s_lshl_b32 s24, s20, 2
    s_add_u32 s24, s24, 1
    s_lshl_b32 s25, s22, 4
    s_add_u32 s25, s25, s24
    s_lshl_b32 s28, s25, 11
    s_add_u32 s28, s28, 94371840
    buffer_load_dwordx4 v[136:139], v5, s[8:11], s28 offen offset:0 sc1
    buffer_load_dwordx4 v[140:143], v5, s[8:11], s28 offen offset:1024 sc1
    s_lshl_b32 s28, s25, 10
    s_add_u32 s28, s28, 96468992
    buffer_load_dwordx2 v[164:165], v2, s[8:11], s28 offen offset:0 sc1
    buffer_load_dwordx2 v[166:167], v2, s[8:11], s28 offen offset:512 sc1
    s_mul_i32 s26, s25, 28
    s_mul_i32 s27, s23, 7
    s_add_u32 s26, s26, s27
    s_lshl_b32 s28, s26, 9
    s_add_u32 s28, s28, 76546048
    buffer_load_dwordx2 a[126:127], v2, s[8:11], s28 offen offset:0 sc1
    buffer_load_dwordx2 a[128:129], v2, s[8:11], s28 offen offset:512 sc1
    buffer_load_dwordx2 a[130:131], v2, s[8:11], s28 offen offset:1024 sc1
    buffer_load_dwordx2 a[132:133], v2, s[8:11], s28 offen offset:1536 sc1
    buffer_load_dwordx2 a[134:135], v2, s[8:11], s28 offen offset:2048 sc1
    buffer_load_dwordx2 a[136:137], v2, s[8:11], s28 offen offset:2560 sc1
    buffer_load_dwordx2 a[138:139], v2, s[8:11], s28 offen offset:3072 sc1
    s_lshl_b32 s24, s20, 2
    s_add_u32 s24, s24, 2
    s_lshl_b32 s25, s22, 4
    s_add_u32 s25, s25, s24
    s_lshl_b32 s28, s25, 11
    s_add_u32 s28, s28, 94371840
    buffer_load_dwordx4 v[144:147], v5, s[8:11], s28 offen offset:0 sc1
    buffer_load_dwordx4 v[148:151], v5, s[8:11], s28 offen offset:1024 sc1
    s_lshl_b32 s28, s25, 10
    s_add_u32 s28, s28, 96468992
    buffer_load_dwordx2 v[168:169], v2, s[8:11], s28 offen offset:0 sc1
    buffer_load_dwordx2 v[170:171], v2, s[8:11], s28 offen offset:512 sc1
    s_mul_i32 s26, s25, 28
    s_mul_i32 s27, s23, 7
    s_add_u32 s26, s26, s27
    s_lshl_b32 s28, s26, 9
    s_add_u32 s28, s28, 76546048
    buffer_load_dwordx2 a[140:141], v2, s[8:11], s28 offen offset:0 sc1
    buffer_load_dwordx2 a[142:143], v2, s[8:11], s28 offen offset:512 sc1
    buffer_load_dwordx2 a[144:145], v2, s[8:11], s28 offen offset:1024 sc1
    buffer_load_dwordx2 a[146:147], v2, s[8:11], s28 offen offset:1536 sc1
    buffer_load_dwordx2 a[148:149], v2, s[8:11], s28 offen offset:2048 sc1
    buffer_load_dwordx2 a[150:151], v2, s[8:11], s28 offen offset:2560 sc1
    buffer_load_dwordx2 a[152:153], v2, s[8:11], s28 offen offset:3072 sc1
    s_lshl_b32 s24, s20, 2
    s_add_u32 s24, s24, 3
    s_lshl_b32 s25, s22, 4
    s_add_u32 s25, s25, s24
    s_lshl_b32 s28, s25, 11
    s_add_u32 s28, s28, 94371840
    buffer_load_dwordx4 v[152:155], v5, s[8:11], s28 offen offset:0 sc1
    buffer_load_dwordx4 v[156:159], v5, s[8:11], s28 offen offset:1024 sc1
    s_lshl_b32 s28, s25, 10
    s_add_u32 s28, s28, 96468992
    buffer_load_dwordx2 v[172:173], v2, s[8:11], s28 offen offset:0 sc1
    buffer_load_dwordx2 v[174:175], v2, s[8:11], s28 offen offset:512 sc1
    s_mul_i32 s26, s25, 28
    s_mul_i32 s27, s23, 7
    s_add_u32 s26, s26, s27
    s_lshl_b32 s28, s26, 9
    s_add_u32 s28, s28, 76546048
    buffer_load_dwordx2 a[154:155], v2, s[8:11], s28 offen offset:0 sc1
    buffer_load_dwordx2 a[156:157], v2, s[8:11], s28 offen offset:512 sc1
    buffer_load_dwordx2 a[158:159], v2, s[8:11], s28 offen offset:1024 sc1
    buffer_load_dwordx2 a[160:161], v2, s[8:11], s28 offen offset:1536 sc1
    buffer_load_dwordx2 a[162:163], v2, s[8:11], s28 offen offset:2048 sc1
    buffer_load_dwordx2 a[164:165], v2, s[8:11], s28 offen offset:2560 sc1
    buffer_load_dwordx2 a[166:167], v2, s[8:11], s28 offen offset:3072 sc1
    s_waitcnt vmcnt(33)
    v_mfma_f32_16x16x32_bf16 v[16:19], a[0:3], v[128:131], 0
    v_mfma_f32_16x16x32_bf16 v[20:23], a[0:3], v[132:135], 0
    v_mfma_f32_16x16x32_bf16 v[24:27], a[4:7], v[128:131], 0
    v_mfma_f32_16x16x32_bf16 v[28:31], a[4:7], v[132:135], 0
    v_mfma_f32_16x16x32_bf16 v[32:35], a[8:11], v[128:131], 0
    v_mfma_f32_16x16x32_bf16 v[36:39], a[8:11], v[132:135], 0
    v_mfma_f32_16x16x32_bf16 v[40:43], a[12:15], v[128:131], 0
    v_mfma_f32_16x16x32_bf16 v[44:47], a[12:15], v[132:135], 0
    v_mfma_f32_16x16x32_bf16 v[48:51], a[16:19], v[128:131], 0
    v_mfma_f32_16x16x32_bf16 v[52:55], a[16:19], v[132:135], 0
    v_mfma_f32_16x16x32_bf16 v[56:59], a[20:23], v[128:131], 0
    v_mfma_f32_16x16x32_bf16 v[60:63], a[20:23], v[132:135], 0
    v_mfma_f32_16x16x32_bf16 v[64:67], a[24:27], v[128:131], 0
    v_mfma_f32_16x16x32_bf16 v[68:71], a[24:27], v[132:135], 0
    v_mfma_f32_16x16x16_bf16 v[16:19], a[112:113], v[160:161], v[16:19]
    v_mfma_f32_16x16x16_bf16 v[20:23], a[112:113], v[162:163], v[20:23]
    v_mfma_f32_16x16x16_bf16 v[24:27], a[114:115], v[160:161], v[24:27]
    v_mfma_f32_16x16x16_bf16 v[28:31], a[114:115], v[162:163], v[28:31]
    v_mfma_f32_16x16x16_bf16 v[32:35], a[116:117], v[160:161], v[32:35]
    v_mfma_f32_16x16x16_bf16 v[36:39], a[116:117], v[162:163], v[36:39]
    v_mfma_f32_16x16x16_bf16 v[40:43], a[118:119], v[160:161], v[40:43]
    v_mfma_f32_16x16x16_bf16 v[44:47], a[118:119], v[162:163], v[44:47]
    v_mfma_f32_16x16x16_bf16 v[48:51], a[120:121], v[160:161], v[48:51]
    v_mfma_f32_16x16x16_bf16 v[52:55], a[120:121], v[162:163], v[52:55]
    v_mfma_f32_16x16x16_bf16 v[56:59], a[122:123], v[160:161], v[56:59]
    v_mfma_f32_16x16x16_bf16 v[60:63], a[122:123], v[162:163], v[60:63]
    v_mfma_f32_16x16x16_bf16 v[64:67], a[124:125], v[160:161], v[64:67]
    v_mfma_f32_16x16x16_bf16 v[68:71], a[124:125], v[162:163], v[68:71]
    s_waitcnt vmcnt(22)
    v_mfma_f32_16x16x32_bf16 v[16:19], a[28:31], v[136:139], v[16:19]
    v_mfma_f32_16x16x32_bf16 v[20:23], a[28:31], v[140:143], v[20:23]
    v_mfma_f32_16x16x32_bf16 v[24:27], a[32:35], v[136:139], v[24:27]
    v_mfma_f32_16x16x32_bf16 v[28:31], a[32:35], v[140:143], v[28:31]
    v_mfma_f32_16x16x32_bf16 v[32:35], a[36:39], v[136:139], v[32:35]
    v_mfma_f32_16x16x32_bf16 v[36:39], a[36:39], v[140:143], v[36:39]
    v_mfma_f32_16x16x32_bf16 v[40:43], a[40:43], v[136:139], v[40:43]
    v_mfma_f32_16x16x32_bf16 v[44:47], a[40:43], v[140:143], v[44:47]
    v_mfma_f32_16x16x32_bf16 v[48:51], a[44:47], v[136:139], v[48:51]
    v_mfma_f32_16x16x32_bf16 v[52:55], a[44:47], v[140:143], v[52:55]
    v_mfma_f32_16x16x32_bf16 v[56:59], a[48:51], v[136:139], v[56:59]
    v_mfma_f32_16x16x32_bf16 v[60:63], a[48:51], v[140:143], v[60:63]
    v_mfma_f32_16x16x32_bf16 v[64:67], a[52:55], v[136:139], v[64:67]
    v_mfma_f32_16x16x32_bf16 v[68:71], a[52:55], v[140:143], v[68:71]
    v_mfma_f32_16x16x16_bf16 v[16:19], a[126:127], v[164:165], v[16:19]
    v_mfma_f32_16x16x16_bf16 v[20:23], a[126:127], v[166:167], v[20:23]
    v_mfma_f32_16x16x16_bf16 v[24:27], a[128:129], v[164:165], v[24:27]
    v_mfma_f32_16x16x16_bf16 v[28:31], a[128:129], v[166:167], v[28:31]
    v_mfma_f32_16x16x16_bf16 v[32:35], a[130:131], v[164:165], v[32:35]
    v_mfma_f32_16x16x16_bf16 v[36:39], a[130:131], v[166:167], v[36:39]
    v_mfma_f32_16x16x16_bf16 v[40:43], a[132:133], v[164:165], v[40:43]
    v_mfma_f32_16x16x16_bf16 v[44:47], a[132:133], v[166:167], v[44:47]
    v_mfma_f32_16x16x16_bf16 v[48:51], a[134:135], v[164:165], v[48:51]
    v_mfma_f32_16x16x16_bf16 v[52:55], a[134:135], v[166:167], v[52:55]
    v_mfma_f32_16x16x16_bf16 v[56:59], a[136:137], v[164:165], v[56:59]
    v_mfma_f32_16x16x16_bf16 v[60:63], a[136:137], v[166:167], v[60:63]
    v_mfma_f32_16x16x16_bf16 v[64:67], a[138:139], v[164:165], v[64:67]
    v_mfma_f32_16x16x16_bf16 v[68:71], a[138:139], v[166:167], v[68:71]
    s_waitcnt vmcnt(11)
    v_mfma_f32_16x16x32_bf16 v[16:19], a[56:59], v[144:147], v[16:19]
    v_mfma_f32_16x16x32_bf16 v[20:23], a[56:59], v[148:151], v[20:23]
    v_mfma_f32_16x16x32_bf16 v[24:27], a[60:63], v[144:147], v[24:27]
    v_mfma_f32_16x16x32_bf16 v[28:31], a[60:63], v[148:151], v[28:31]
    v_mfma_f32_16x16x32_bf16 v[32:35], a[64:67], v[144:147], v[32:35]
    v_mfma_f32_16x16x32_bf16 v[36:39], a[64:67], v[148:151], v[36:39]
    v_mfma_f32_16x16x32_bf16 v[40:43], a[68:71], v[144:147], v[40:43]
    v_mfma_f32_16x16x32_bf16 v[44:47], a[68:71], v[148:151], v[44:47]
    v_mfma_f32_16x16x32_bf16 v[48:51], a[72:75], v[144:147], v[48:51]
    v_mfma_f32_16x16x32_bf16 v[52:55], a[72:75], v[148:151], v[52:55]
    v_mfma_f32_16x16x32_bf16 v[56:59], a[76:79], v[144:147], v[56:59]
    v_mfma_f32_16x16x32_bf16 v[60:63], a[76:79], v[148:151], v[60:63]
    v_mfma_f32_16x16x32_bf16 v[64:67], a[80:83], v[144:147], v[64:67]
    v_mfma_f32_16x16x32_bf16 v[68:71], a[80:83], v[148:151], v[68:71]
    v_mfma_f32_16x16x16_bf16 v[16:19], a[140:141], v[168:169], v[16:19]
    v_mfma_f32_16x16x16_bf16 v[20:23], a[140:141], v[170:171], v[20:23]
    v_mfma_f32_16x16x16_bf16 v[24:27], a[142:143], v[168:169], v[24:27]
    v_mfma_f32_16x16x16_bf16 v[28:31], a[142:143], v[170:171], v[28:31]
    v_mfma_f32_16x16x16_bf16 v[32:35], a[144:145], v[168:169], v[32:35]
    v_mfma_f32_16x16x16_bf16 v[36:39], a[144:145], v[170:171], v[36:39]
    v_mfma_f32_16x16x16_bf16 v[40:43], a[146:147], v[168:169], v[40:43]
    v_mfma_f32_16x16x16_bf16 v[44:47], a[146:147], v[170:171], v[44:47]
    v_mfma_f32_16x16x16_bf16 v[48:51], a[148:149], v[168:169], v[48:51]
    v_mfma_f32_16x16x16_bf16 v[52:55], a[148:149], v[170:171], v[52:55]
    v_mfma_f32_16x16x16_bf16 v[56:59], a[150:151], v[168:169], v[56:59]
    v_mfma_f32_16x16x16_bf16 v[60:63], a[150:151], v[170:171], v[60:63]
    v_mfma_f32_16x16x16_bf16 v[64:67], a[152:153], v[168:169], v[64:67]
    v_mfma_f32_16x16x16_bf16 v[68:71], a[152:153], v[170:171], v[68:71]
    s_waitcnt vmcnt(0)
    v_mfma_f32_16x16x32_bf16 v[16:19], a[84:87], v[152:155], v[16:19]
    v_mfma_f32_16x16x32_bf16 v[20:23], a[84:87], v[156:159], v[20:23]
    v_mfma_f32_16x16x32_bf16 v[24:27], a[88:91], v[152:155], v[24:27]
    v_mfma_f32_16x16x32_bf16 v[28:31], a[88:91], v[156:159], v[28:31]
    v_mfma_f32_16x16x32_bf16 v[32:35], a[92:95], v[152:155], v[32:35]
    v_mfma_f32_16x16x32_bf16 v[36:39], a[92:95], v[156:159], v[36:39]
    v_mfma_f32_16x16x32_bf16 v[40:43], a[96:99], v[152:155], v[40:43]
    v_mfma_f32_16x16x32_bf16 v[44:47], a[96:99], v[156:159], v[44:47]
    v_mfma_f32_16x16x32_bf16 v[48:51], a[100:103], v[152:155], v[48:51]
    v_mfma_f32_16x16x32_bf16 v[52:55], a[100:103], v[156:159], v[52:55]
    v_mfma_f32_16x16x32_bf16 v[56:59], a[104:107], v[152:155], v[56:59]
    v_mfma_f32_16x16x32_bf16 v[60:63], a[104:107], v[156:159], v[60:63]
    v_mfma_f32_16x16x32_bf16 v[64:67], a[108:111], v[152:155], v[64:67]
    v_mfma_f32_16x16x32_bf16 v[68:71], a[108:111], v[156:159], v[68:71]
    v_mfma_f32_16x16x16_bf16 v[16:19], a[154:155], v[172:173], v[16:19]
    v_mfma_f32_16x16x16_bf16 v[20:23], a[154:155], v[174:175], v[20:23]
    v_mfma_f32_16x16x16_bf16 v[24:27], a[156:157], v[172:173], v[24:27]
    v_mfma_f32_16x16x16_bf16 v[28:31], a[156:157], v[174:175], v[28:31]
    v_mfma_f32_16x16x16_bf16 v[32:35], a[158:159], v[172:173], v[32:35]
    v_mfma_f32_16x16x16_bf16 v[36:39], a[158:159], v[174:175], v[36:39]
    v_mfma_f32_16x16x16_bf16 v[40:43], a[160:161], v[172:173], v[40:43]
    v_mfma_f32_16x16x16_bf16 v[44:47], a[160:161], v[174:175], v[44:47]
    v_mfma_f32_16x16x16_bf16 v[48:51], a[162:163], v[172:173], v[48:51]
    v_mfma_f32_16x16x16_bf16 v[52:55], a[162:163], v[174:175], v[52:55]
    v_mfma_f32_16x16x16_bf16 v[56:59], a[164:165], v[172:173], v[56:59]
    v_mfma_f32_16x16x16_bf16 v[60:63], a[164:165], v[174:175], v[60:63]
    v_mfma_f32_16x16x16_bf16 v[64:67], a[166:167], v[172:173], v[64:67]
    v_mfma_f32_16x16x16_bf16 v[68:71], a[166:167], v[174:175], v[68:71]
    s_nop 7
    s_nop 1
    s_mul_i32 s24, s20, 14336
    v_add_u32 v6, s24, v5
    ds_write_b128 v6, v[16:19] offset:0
    ds_write_b128 v6, v[20:23] offset:1024
    ds_write_b128 v6, v[24:27] offset:2048
    ds_write_b128 v6, v[28:31] offset:3072
    ds_write_b128 v6, v[32:35] offset:4096
    ds_write_b128 v6, v[36:39] offset:5120
    ds_write_b128 v6, v[40:43] offset:6144
    ds_write_b128 v6, v[44:47] offset:7168
    ds_write_b128 v6, v[48:51] offset:8192
    ds_write_b128 v6, v[52:55] offset:9216
    ds_write_b128 v6, v[56:59] offset:10240
    ds_write_b128 v6, v[60:63] offset:11264
    ds_write_b128 v6, v[64:67] offset:12288
    ds_write_b128 v6, v[68:71] offset:13312
    s_waitcnt lgkmcnt(0)
    s_barrier
    s_lshl_b32 s24, s20, 10
    v_add_u32 v6, s24, v5
    ds_read_b128 v[80:83], v6 offset:0
    ds_read_b128 v[84:87], v6 offset:14336
    ds_read_b128 v[88:91], v6 offset:28672
    ds_read_b128 v[92:95], v6 offset:43008
    s_waitcnt lgkmcnt(0)
    v_add_f32 v80, v80, v84
    v_add_f32 v88, v88, v92
    v_add_f32 v80, v80, v88
    v_add_f32 v81, v81, v85
    v_add_f32 v89, v89, v93
    v_add_f32 v81, v81, v89
    v_add_f32 v82, v82, v86
    v_add_f32 v90, v90, v94
    v_add_f32 v82, v82, v90
    v_add_f32 v83, v83, v87
    v_add_f32 v91, v91, v95
    v_add_f32 v83, v83, v91
    v_cvt_pk_bf16_f32 v96, v80, v81
    v_cvt_pk_bf16_f32 v97, v82, v83
    v_lshlrev_b32 v80, 16, v96
    v_and_b32 v81, 0xffff0000, v96
    v_lshlrev_b32 v82, 16, v97
    v_and_b32 v83, 0xffff0000, v97
    v_lshlrev_b32 v84, 16, v72
    v_and_b32 v85, 0xffff0000, v72
    v_lshlrev_b32 v86, 16, v73
    v_and_b32 v87, 0xffff0000, v73
    v_add_f32 v80, v80, v84
    v_add_f32 v81, v81, v85
    v_add_f32 v82, v82, v86
    v_add_f32 v83, v83, v87
    v_cvt_pk_bf16_f32 v98, v80, v81
    v_cvt_pk_bf16_f32 v99, v82, v83
    s_add_u32 s29, s40, 97517568
    buffer_store_dwordx2 v[98:99], v9, s[8:11], s29 offen sc1
    ds_read_b128 v[80:83], v6 offset:4096
    ds_read_b128 v[84:87], v6 offset:18432
    ds_read_b128 v[88:91], v6 offset:32768
    ds_read_b128 v[92:95], v6 offset:47104
    s_waitcnt lgkmcnt(0)
    v_add_f32 v80, v80, v84
    v_add_f32 v88, v88, v92
    v_add_f32 v80, v80, v88
    v_add_f32 v81, v81, v85
    v_add_f32 v89, v89, v93
    v_add_f32 v81, v81, v89
    v_add_f32 v82, v82, v86
    v_add_f32 v90, v90, v94
    v_add_f32 v82, v82, v90
    v_add_f32 v83, v83, v87
    v_add_f32 v91, v91, v95
    v_add_f32 v83, v83, v91
    v_cvt_pk_bf16_f32 v96, v80, v81
    v_cvt_pk_bf16_f32 v97, v82, v83
    v_lshlrev_b32 v80, 16, v96
    v_and_b32 v81, 0xffff0000, v96
    v_lshlrev_b32 v82, 16, v97
    v_and_b32 v83, 0xffff0000, v97
    v_lshlrev_b32 v84, 16, v74
    v_and_b32 v85, 0xffff0000, v74
    v_lshlrev_b32 v86, 16, v75
    v_and_b32 v87, 0xffff0000, v75
    v_add_f32 v80, v80, v84
    v_add_f32 v81, v81, v85
    v_add_f32 v82, v82, v86
    v_add_f32 v83, v83, v87
    v_cvt_pk_bf16_f32 v100, v80, v81
    v_cvt_pk_bf16_f32 v101, v82, v83
    s_add_u32 s29, s41, 97517568
    buffer_store_dwordx2 v[100:101], v9, s[8:11], s29 offen sc1
    ds_read_b128 v[80:83], v6 offset:8192
    ds_read_b128 v[84:87], v6 offset:22528
    ds_read_b128 v[88:91], v6 offset:36864
    ds_read_b128 v[92:95], v6 offset:51200
    s_waitcnt lgkmcnt(0)
    v_add_f32 v80, v80, v84
    v_add_f32 v88, v88, v92
    v_add_f32 v80, v80, v88
    v_add_f32 v81, v81, v85
    v_add_f32 v89, v89, v93
    v_add_f32 v81, v81, v89
    v_add_f32 v82, v82, v86
    v_add_f32 v90, v90, v94
    v_add_f32 v82, v82, v90
    v_add_f32 v83, v83, v87
    v_add_f32 v91, v91, v95
    v_add_f32 v83, v83, v91
    v_cvt_pk_bf16_f32 v96, v80, v81
    v_cvt_pk_bf16_f32 v97, v82, v83
    v_lshlrev_b32 v80, 16, v96
    v_and_b32 v81, 0xffff0000, v96
    v_lshlrev_b32 v82, 16, v97
    v_and_b32 v83, 0xffff0000, v97
    v_lshlrev_b32 v84, 16, v76
    v_and_b32 v85, 0xffff0000, v76
    v_lshlrev_b32 v86, 16, v77
    v_and_b32 v87, 0xffff0000, v77
    v_add_f32 v80, v80, v84
    v_add_f32 v81, v81, v85
    v_add_f32 v82, v82, v86
    v_add_f32 v83, v83, v87
    v_cvt_pk_bf16_f32 v102, v80, v81
    v_cvt_pk_bf16_f32 v103, v82, v83
    s_add_u32 s29, s42, 97517568
    buffer_store_dwordx2 v[102:103], v9, s[8:11], s29 offen sc1
    s_cmp_ge_u32 s20, 2
    s_cbranch_scc1 L_oskip_22
    ds_read_b128 v[80:83], v6 offset:12288
    ds_read_b128 v[84:87], v6 offset:26624
    ds_read_b128 v[88:91], v6 offset:40960
    ds_read_b128 v[92:95], v6 offset:55296
    s_waitcnt lgkmcnt(0)
    v_add_f32 v80, v80, v84
    v_add_f32 v88, v88, v92
    v_add_f32 v80, v80, v88
    v_add_f32 v81, v81, v85
    v_add_f32 v89, v89, v93
    v_add_f32 v81, v81, v89
    v_add_f32 v82, v82, v86
    v_add_f32 v90, v90, v94
    v_add_f32 v82, v82, v90
    v_add_f32 v83, v83, v87
    v_add_f32 v91, v91, v95
    v_add_f32 v83, v83, v91
    v_cvt_pk_bf16_f32 v96, v80, v81
    v_cvt_pk_bf16_f32 v97, v82, v83
    v_lshlrev_b32 v80, 16, v96
    v_and_b32 v81, 0xffff0000, v96
    v_lshlrev_b32 v82, 16, v97
    v_and_b32 v83, 0xffff0000, v97
    v_lshlrev_b32 v84, 16, v78
    v_and_b32 v85, 0xffff0000, v78
    v_lshlrev_b32 v86, 16, v79
    v_and_b32 v87, 0xffff0000, v79
    v_add_f32 v80, v80, v84
    v_add_f32 v81, v81, v85
    v_add_f32 v82, v82, v86
    v_add_f32 v83, v83, v87
    v_cvt_pk_bf16_f32 v104, v80, v81
    v_cvt_pk_bf16_f32 v105, v82, v83
    s_add_u32 s29, s43, 97517568
    buffer_store_dwordx2 v[104:105], v9, s[8:11], s29 offen sc1
L_oskip_22:
    s_lshl_b32 s37, s22, 6
    s_lshl_b32 s38, s23, 2
    s_add_u32 s37, s37, s38
    s_add_u32 s37, s37, 94191632
    s_waitcnt vmcnt(0)
    s_barrier
    s_cmp_eq_u32 s20, 0
    s_cbranch_scc0 L_sf_23
    v_mov_b32 v12, 1
    v_mov_b32 v13, 0
    s_mov_b64 exec, 1
    buffer_store_dword v12, v13, s[8:11], s37 offen sc1
    s_mov_b64 exec, -1
L_sf_23:
    s_branch K3_TASK
K3_PM1:
    s_sub_u32 s23, s23, 8
    s_cmp_lt_u32 s22, 64
    s_cbranch_scc0 K3_TASK
    s_lshl_b32 s26, s23, 4
    s_lshl_b32 s25, s20, 2
    s_add_u32 s24, s26, s25
    s_mul_i32 s26, s24, 14336
    s_add_u32 s26, s26, 101711872
    buffer_load_dwordx4 a[0:3], v5, s[8:11], s26 offen offset:0 sc1
    buffer_load_dwordx4 a[4:7], v5, s[8:11], s26 offen offset:1024 sc1
    buffer_load_dwordx4 a[8:11], v5, s[8:11], s26 offen offset:2048 sc1
    buffer_load_dwordx4 a[12:15], v5, s[8:11], s26 offen offset:3072 sc1
    s_add_u32 s26, s26, 4096
    buffer_load_dwordx4 a[16:19], v5, s[8:11], s26 offen offset:0 sc1
    buffer_load_dwordx4 a[20:23], v5, s[8:11], s26 offen offset:1024 sc1
    buffer_load_dwordx4 a[24:27], v5, s[8:11], s26 offen offset:2048 sc1
    buffer_load_dwordx4 a[28:31], v5, s[8:11], s26 offen offset:3072 sc1
    s_add_u32 s26, s26, 4096
    buffer_load_dwordx4 a[32:35], v5, s[8:11], s26 offen offset:0 sc1
    buffer_load_dwordx4 a[36:39], v5, s[8:11], s26 offen offset:1024 sc1
    buffer_load_dwordx4 a[40:43], v5, s[8:11], s26 offen offset:2048 sc1
    buffer_load_dwordx4 a[44:47], v5, s[8:11], s26 offen offset:3072 sc1
    s_add_u32 s26, s26, 4096
    buffer_load_dwordx4 a[48:51], v5, s[8:11], s26 offen offset:0 sc1
    buffer_load_dwordx4 a[52:55], v5, s[8:11], s26 offen offset:1024 sc1
    buffer_load_dwordx4 a[56:59], v5, s[8:11], s26 offen offset:2048 sc1
    buffer_load_dwordx4 a[60:63], v5, s[8:11], s26 offen offset:3072 sc1
    s_add_u32 s26, s26, 4096
    buffer_load_dwordx4 a[64:67], v5, s[8:11], s26 offen offset:0 sc1
    buffer_load_dwordx4 a[68:71], v5, s[8:11], s26 offen offset:1024 sc1
    buffer_load_dwordx4 a[72:75], v5, s[8:11], s26 offen offset:2048 sc1
    buffer_load_dwordx4 a[76:79], v5, s[8:11], s26 offen offset:3072 sc1
    s_add_u32 s26, s26, 4096
    buffer_load_dwordx4 a[80:83], v5, s[8:11], s26 offen offset:0 sc1
    buffer_load_dwordx4 a[84:87], v5, s[8:11], s26 offen offset:1024 sc1
    buffer_load_dwordx4 a[88:91], v5, s[8:11], s26 offen offset:2048 sc1
    buffer_load_dwordx4 a[92:95], v5, s[8:11], s26 offen offset:3072 sc1
    s_add_u32 s26, s26, 4096
    buffer_load_dwordx4 a[96:99], v5, s[8:11], s26 offen offset:0 sc1
    buffer_load_dwordx4 a[100:103], v5, s[8:11], s26 offen offset:1024 sc1
    buffer_load_dwordx4 a[104:107], v5, s[8:11], s26 offen offset:2048 sc1
    buffer_load_dwordx4 a[108:111], v5, s[8:11], s26 offen offset:3072 sc1
    s_add_u32 s26, s26, 4096
    buffer_load_dwordx4 a[112:115], v5, s[8:11], s26 offen offset:0 sc1
    buffer_load_dwordx4 a[116:119], v5, s[8:11], s26 offen offset:1024 sc1
    buffer_load_dwordx4 a[120:123], v5, s[8:11], s26 offen offset:2048 sc1
    buffer_load_dwordx4 a[124:127], v5, s[8:11], s26 offen offset:3072 sc1
    s_add_u32 s26, s26, 4096
    buffer_load_dwordx4 a[128:131], v5, s[8:11], s26 offen offset:0 sc1
    buffer_load_dwordx4 a[132:135], v5, s[8:11], s26 offen offset:1024 sc1
    buffer_load_dwordx4 a[136:139], v5, s[8:11], s26 offen offset:2048 sc1
    buffer_load_dwordx4 a[140:143], v5, s[8:11], s26 offen offset:3072 sc1
    s_add_u32 s26, s26, 4096
    buffer_load_dwordx4 a[144:147], v5, s[8:11], s26 offen offset:0 sc1
    buffer_load_dwordx4 a[148:151], v5, s[8:11], s26 offen offset:1024 sc1
    buffer_load_dwordx4 a[152:155], v5, s[8:11], s26 offen offset:2048 sc1
    buffer_load_dwordx4 a[156:159], v5, s[8:11], s26 offen offset:3072 sc1
    s_add_u32 s26, s26, 4096
    buffer_load_dwordx4 a[160:163], v5, s[8:11], s26 offen offset:0 sc1
    buffer_load_dwordx4 a[164:167], v5, s[8:11], s26 offen offset:1024 sc1
    buffer_load_dwordx4 a[168:171], v5, s[8:11], s26 offen offset:2048 sc1
    buffer_load_dwordx4 a[172:175], v5, s[8:11], s26 offen offset:3072 sc1
    s_add_u32 s26, s26, 4096
    buffer_load_dwordx4 a[176:179], v5, s[8:11], s26 offen offset:0 sc1
    buffer_load_dwordx4 a[180:183], v5, s[8:11], s26 offen offset:1024 sc1
    buffer_load_dwordx4 a[184:187], v5, s[8:11], s26 offen offset:2048 sc1
    buffer_load_dwordx4 a[188:191], v5, s[8:11], s26 offen offset:3072 sc1
    s_add_u32 s26, s26, 4096
    buffer_load_dwordx4 a[192:195], v5, s[8:11], s26 offen offset:0 sc1
    buffer_load_dwordx4 a[196:199], v5, s[8:11], s26 offen offset:1024 sc1
    buffer_load_dwordx4 a[200:203], v5, s[8:11], s26 offen offset:2048 sc1
    buffer_load_dwordx4 a[204:207], v5, s[8:11], s26 offen offset:3072 sc1
    s_add_u32 s26, s26, 4096
    buffer_load_dwordx4 a[208:211], v5, s[8:11], s26 offen offset:0 sc1
    buffer_load_dwordx4 a[212:215], v5, s[8:11], s26 offen offset:1024 sc1
    buffer_load_dwordx4 a[216:219], v5, s[8:11], s26 offen offset:2048 sc1
    buffer_load_dwordx4 a[220:223], v5, s[8:11], s26 offen offset:3072 sc1
    v_lshrrev_b32 v8, 4, v1
    v_lshlrev_b32 v6, 4, v8
    v_and_b32 v7, 15, v1
    s_lshl_b32 s30, s24, 6
    s_add_u32 s30, s30, 105906176
    buffer_load_dwordx4 v[200:203], v6, s[8:11], s30 offen offset:0 sc1
    buffer_load_dwordx4 v[204:207], v6, s[8:11], s30 offen offset:64 sc1
    buffer_load_dwordx4 v[208:211], v6, s[8:11], s30 offen offset:128 sc1
    buffer_load_dwordx4 v[212:215], v6, s[8:11], s30 offen offset:192 sc1
    s_lshl_b32 s37, s22, 6
    s_add_u32 s37, s37, 94191616
    s_cmp_eq_u32 s20, 0
    s_cbranch_scc0 L_wfm1_24_b
    v_min_u32 v12, 3, v1
    v_mul_u32_u24 v12, 1, v12
    v_add_u32 v12, 4, v12
    v_lshlrev_b32 v12, 2, v12
    s_mov_b32 s60, 0
L_wfm1_24:
    buffer_load_dword v13, v12, s[8:11], s37 offen sc1
    s_add_u32 s60, s60, 1
    s_waitcnt vmcnt(0)
    v_cmp_eq_u32 vcc, 0, v13
    s_cbranch_vccz L_wfm1_24_b
    s_sleep 2
    s_cmp_lt_u32 s60, 65536
    s_cbranch_scc1 L_wfm1_24
L_wfm1_24_b:
    s_barrier
    s_lshr_b32 s27, s20, 1
    s_and_b32 s28, s20, 1
    s_lshl_b32 s29, s22, 1
    s_add_u32 s29, s29, s27
    s_mul_i32 s29, s29, 14336
    s_mul_i32 s31, s28, 448
    s_add_u32 s29, s29, s31
    s_add_u32 s29, s29, 97517568
    v_mul_u32_u24 v9, 896, v7
    v_lshl_add_u32 v9, v8, 4, v9
    buffer_load_dwordx4 v[16:19], v9, s[8:11], s29 offen offset:0 sc1
    buffer_load_dwordx4 v[20:23], v9, s[8:11], s29 offen offset:64 sc1
    buffer_load_dwordx4 v[24:27], v9, s[8:11], s29 offen offset:128 sc1
    buffer_load_dwordx4 v[28:31], v9, s[8:11], s29 offen offset:192 sc1
    buffer_load_dwordx4 v[32:35], v9, s[8:11], s29 offen offset:256 sc1
    buffer_load_dwordx4 v[36:39], v9, s[8:11], s29 offen offset:320 sc1
    buffer_load_dwordx4 v[40:43], v9, s[8:11], s29 offen offset:384 sc1
    s_mov_b32 s38, 0x3727c5ac
    s_mov_b32 s39, 0x3b124925
    s_waitcnt vmcnt(0)
    v_lshlrev_b32 v48, 16, v16
    v_and_b32 v49, 0xffff0000, v16
    v_lshlrev_b32 v50, 16, v17
    v_and_b32 v51, 0xffff0000, v17
    v_lshlrev_b32 v52, 16, v18
    v_and_b32 v53, 0xffff0000, v18
    v_lshlrev_b32 v54, 16, v19
    v_and_b32 v55, 0xffff0000, v19
    v_lshlrev_b32 v56, 16, v20
    v_and_b32 v57, 0xffff0000, v20
    v_lshlrev_b32 v58, 16, v21
    v_and_b32 v59, 0xffff0000, v21
    v_lshlrev_b32 v60, 16, v22
    v_and_b32 v61, 0xffff0000, v22
    v_lshlrev_b32 v62, 16, v23
    v_and_b32 v63, 0xffff0000, v23
    v_lshlrev_b32 v64, 16, v24
    v_and_b32 v65, 0xffff0000, v24
    v_lshlrev_b32 v66, 16, v25
    v_and_b32 v67, 0xffff0000, v25
    v_lshlrev_b32 v68, 16, v26
    v_and_b32 v69, 0xffff0000, v26
    v_lshlrev_b32 v70, 16, v27
    v_and_b32 v71, 0xffff0000, v27
    v_lshlrev_b32 v72, 16, v28
    v_and_b32 v73, 0xffff0000, v28
    v_lshlrev_b32 v74, 16, v29
    v_and_b32 v75, 0xffff0000, v29
    v_lshlrev_b32 v76, 16, v30
    v_and_b32 v77, 0xffff0000, v30
    v_lshlrev_b32 v78, 16, v31
    v_and_b32 v79, 0xffff0000, v31
    v_lshlrev_b32 v80, 16, v32
    v_and_b32 v81, 0xffff0000, v32
    v_lshlrev_b32 v82, 16, v33
    v_and_b32 v83, 0xffff0000, v33
    v_lshlrev_b32 v84, 16, v34
    v_and_b32 v85, 0xffff0000, v34
    v_lshlrev_b32 v86, 16, v35
    v_and_b32 v87, 0xffff0000, v35
    v_lshlrev_b32 v88, 16, v36
    v_and_b32 v89, 0xffff0000, v36
    v_lshlrev_b32 v90, 16, v37
    v_and_b32 v91, 0xffff0000, v37
    v_lshlrev_b32 v92, 16, v38
    v_and_b32 v93, 0xffff0000, v38
    v_lshlrev_b32 v94, 16, v39
    v_and_b32 v95, 0xffff0000, v39
    v_lshlrev_b32 v96, 16, v40
    v_and_b32 v97, 0xffff0000, v40
    v_lshlrev_b32 v98, 16, v41
    v_and_b32 v99, 0xffff0000, v41
    v_lshlrev_b32 v100, 16, v42
    v_and_b32 v101, 0xffff0000, v42
    v_lshlrev_b32 v102, 16, v43
    v_and_b32 v103, 0xffff0000, v43
    v_add_f32 v116, v48, v52
    v_add_f32 v117, v49, v53
    v_add_f32 v118, v50, v54
    v_add_f32 v119, v51, v55
    v_add_f32 v116, v116, v56
    v_add_f32 v117, v117, v57
    v_add_f32 v118, v118, v58
    v_add_f32 v119, v119, v59
    v_add_f32 v116, v116, v60
    v_add_f32 v117, v117, v61
    v_add_f32 v118, v118, v62
    v_add_f32 v119, v119, v63
    v_add_f32 v116, v116, v64
    v_add_f32 v117, v117, v65
    v_add_f32 v118, v118, v66
    v_add_f32 v119, v119, v67
    v_add_f32 v116, v116, v68
    v_add_f32 v117, v117, v69
    v_add_f32 v118, v118, v70
    v_add_f32 v119, v119, v71
    v_add_f32 v116, v116, v72
    v_add_f32 v117, v117, v73
    v_add_f32 v118, v118, v74
    v_add_f32 v119, v119, v75
    v_add_f32 v116, v116, v76
    v_add_f32 v117, v117, v77
    v_add_f32 v118, v118, v78
    v_add_f32 v119, v119, v79
    v_add_f32 v116, v116, v80
    v_add_f32 v117, v117, v81
    v_add_f32 v118, v118, v82
    v_add_f32 v119, v119, v83
    v_add_f32 v116, v116, v84
    v_add_f32 v117, v117, v85
    v_add_f32 v118, v118, v86
    v_add_f32 v119, v119, v87
    v_add_f32 v116, v116, v88
    v_add_f32 v117, v117, v89
    v_add_f32 v118, v118, v90
    v_add_f32 v119, v119, v91
    v_add_f32 v116, v116, v92
    v_add_f32 v117, v117, v93
    v_add_f32 v118, v118, v94
    v_add_f32 v119, v119, v95
    v_add_f32 v116, v116, v96
    v_add_f32 v117, v117, v97
    v_add_f32 v118, v118, v98
    v_add_f32 v119, v119, v99
    v_add_f32 v116, v116, v100
    v_add_f32 v117, v117, v101
    v_add_f32 v118, v118, v102
    v_add_f32 v119, v119, v103
    v_add_f32 v116, v116, v117
    v_add_f32 v118, v118, v119
    v_add_f32 v112, v116, v118
    v_mov_b32 v113, v112
    s_nop 1
    v_permlane16_swap_b32 v112, v113
    s_nop 1
    v_add_f32 v112, v112, v113
    v_mov_b32 v113, v112
    s_nop 1
    v_permlane32_swap_b32 v112, v113
    s_nop 1
    v_add_f32 v112, v112, v113
    s_lshl_b32 s31, s20, 6
    v_lshl_add_u32 v11, v7, 2, s31
    ds_write_b32 v11, v112 offset:28672
    s_waitcnt lgkmcnt(0)
    s_barrier
    s_xor_b32 s31, s20, 1
    s_lshl_b32 s31, s31, 6
    v_lshl_add_u32 v11, v7, 2, s31
    ds_read_b32 v113, v11 offset:28672
    s_waitcnt lgkmcnt(0)
    v_add_f32 v112, v112, v113
    v_mul_f32 v114, s39, v112
    v_sub_f32 v48, v48, v114
    v_sub_f32 v49, v49, v114
    v_sub_f32 v50, v50, v114
    v_sub_f32 v51, v51, v114
    v_sub_f32 v52, v52, v114
    v_sub_f32 v53, v53, v114
    v_sub_f32 v54, v54, v114
    v_sub_f32 v55, v55, v114
    v_sub_f32 v56, v56, v114
    v_sub_f32 v57, v57, v114
    v_sub_f32 v58, v58, v114
    v_sub_f32 v59, v59, v114
    v_sub_f32 v60, v60, v114
    v_sub_f32 v61, v61, v114
    v_sub_f32 v62, v62, v114
    v_sub_f32 v63, v63, v114
    v_sub_f32 v64, v64, v114
    v_sub_f32 v65, v65, v114
    v_sub_f32 v66, v66, v114
    v_sub_f32 v67, v67, v114
    v_sub_f32 v68, v68, v114
    v_sub_f32 v69, v69, v114
    v_sub_f32 v70, v70, v114
    v_sub_f32 v71, v71, v114
    v_sub_f32 v72, v72, v114
    v_sub_f32 v73, v73, v114
    v_sub_f32 v74, v74, v114
    v_sub_f32 v75, v75, v114
    v_sub_f32 v76, v76, v114
    v_sub_f32 v77, v77, v114
    v_sub_f32 v78, v78, v114
    v_sub_f32 v79, v79, v114
    v_sub_f32 v80, v80, v114
    v_sub_f32 v81, v81, v114
    v_sub_f32 v82, v82, v114
    v_sub_f32 v83, v83, v114
    v_sub_f32 v84, v84, v114
    v_sub_f32 v85, v85, v114
    v_sub_f32 v86, v86, v114
    v_sub_f32 v87, v87, v114
    v_sub_f32 v88, v88, v114
    v_sub_f32 v89, v89, v114
    v_sub_f32 v90, v90, v114
    v_sub_f32 v91, v91, v114
    v_sub_f32 v92, v92, v114
    v_sub_f32 v93, v93, v114
    v_sub_f32 v94, v94, v114
    v_sub_f32 v95, v95, v114
    v_sub_f32 v96, v96, v114
    v_sub_f32 v97, v97, v114
    v_sub_f32 v98, v98, v114
    v_sub_f32 v99, v99, v114
    v_sub_f32 v100, v100, v114
    v_sub_f32 v101, v101, v114
    v_sub_f32 v102, v102, v114
    v_sub_f32 v103, v103, v114
    v_mul_f32 v116, v48, v48
    v_mul_f32 v117, v49, v49
    v_mul_f32 v118, v50, v50
    v_mul_f32 v119, v51, v51
    v_fmac_f32 v116, v52, v52
    v_fmac_f32 v117, v53, v53
    v_fmac_f32 v118, v54, v54
    v_fmac_f32 v119, v55, v55
    v_fmac_f32 v116, v56, v56
    v_fmac_f32 v117, v57, v57
    v_fmac_f32 v118, v58, v58
    v_fmac_f32 v119, v59, v59
    v_fmac_f32 v116, v60, v60
    v_fmac_f32 v117, v61, v61
    v_fmac_f32 v118, v62, v62
    v_fmac_f32 v119, v63, v63
    v_fmac_f32 v116, v64, v64
    v_fmac_f32 v117, v65, v65
    v_fmac_f32 v118, v66, v66
    v_fmac_f32 v119, v67, v67
    v_fmac_f32 v116, v68, v68
    v_fmac_f32 v117, v69, v69
    v_fmac_f32 v118, v70, v70
    v_fmac_f32 v119, v71, v71
    v_fmac_f32 v116, v72, v72
    v_fmac_f32 v117, v73, v73
    v_fmac_f32 v118, v74, v74
    v_fmac_f32 v119, v75, v75
    v_fmac_f32 v116, v76, v76
    v_fmac_f32 v117, v77, v77
    v_fmac_f32 v118, v78, v78
    v_fmac_f32 v119, v79, v79
    v_fmac_f32 v116, v80, v80
    v_fmac_f32 v117, v81, v81
    v_fmac_f32 v118, v82, v82
    v_fmac_f32 v119, v83, v83
    v_fmac_f32 v116, v84, v84
    v_fmac_f32 v117, v85, v85
    v_fmac_f32 v118, v86, v86
    v_fmac_f32 v119, v87, v87
    v_fmac_f32 v116, v88, v88
    v_fmac_f32 v117, v89, v89
    v_fmac_f32 v118, v90, v90
    v_fmac_f32 v119, v91, v91
    v_fmac_f32 v116, v92, v92
    v_fmac_f32 v117, v93, v93
    v_fmac_f32 v118, v94, v94
    v_fmac_f32 v119, v95, v95
    v_fmac_f32 v116, v96, v96
    v_fmac_f32 v117, v97, v97
    v_fmac_f32 v118, v98, v98
    v_fmac_f32 v119, v99, v99
    v_fmac_f32 v116, v100, v100
    v_fmac_f32 v117, v101, v101
    v_fmac_f32 v118, v102, v102
    v_fmac_f32 v119, v103, v103
    v_add_f32 v116, v116, v117
    v_add_f32 v118, v118, v119
    v_add_f32 v112, v116, v118
    v_mov_b32 v113, v112
    s_nop 1
    v_permlane16_swap_b32 v112, v113
    s_nop 1
    v_add_f32 v112, v112, v113
    v_mov_b32 v113, v112
    s_nop 1
    v_permlane32_swap_b32 v112, v113
    s_nop 1
    v_add_f32 v112, v112, v113
    s_lshl_b32 s31, s20, 6
    v_lshl_add_u32 v11, v7, 2, s31
    ds_write_b32 v11, v112 offset:28928
    s_waitcnt lgkmcnt(0)
    s_barrier
    s_xor_b32 s31, s20, 1
    s_lshl_b32 s31, s31, 6
    v_lshl_add_u32 v11, v7, 2, s31
    ds_read_b32 v113, v11 offset:28928
    s_waitcnt lgkmcnt(0)
    v_add_f32 v112, v112, v113
    v_mov_b32 v115, s38
    v_fmac_f32 v115, s39, v112
    v_rsq_f32 v115, v115
    s_nop 0
    v_mul_f32 v48, v48, v115
    v_mul_f32 v49, v49, v115
    v_mul_f32 v50, v50, v115
    v_mul_f32 v51, v51, v115
    v_mul_f32 v52, v52, v115
    v_mul_f32 v53, v53, v115
    v_mul_f32 v54, v54, v115
    v_mul_f32 v55, v55, v115
    v_mul_f32 v56, v56, v115
    v_mul_f32 v57, v57, v115
    v_mul_f32 v58, v58, v115
    v_mul_f32 v59, v59, v115
    v_mul_f32 v60, v60, v115
    v_mul_f32 v61, v61, v115
    v_mul_f32 v62, v62, v115
    v_mul_f32 v63, v63, v115
    v_mul_f32 v64, v64, v115
    v_mul_f32 v65, v65, v115
    v_mul_f32 v66, v66, v115
    v_mul_f32 v67, v67, v115
    v_mul_f32 v68, v68, v115
    v_mul_f32 v69, v69, v115
    v_mul_f32 v70, v70, v115
    v_mul_f32 v71, v71, v115
    v_mul_f32 v72, v72, v115
    v_mul_f32 v73, v73, v115
    v_mul_f32 v74, v74, v115
    v_mul_f32 v75, v75, v115
    v_mul_f32 v76, v76, v115
    v_mul_f32 v77, v77, v115
    v_mul_f32 v78, v78, v115
    v_mul_f32 v79, v79, v115
    v_mul_f32 v80, v80, v115
    v_mul_f32 v81, v81, v115
    v_mul_f32 v82, v82, v115
    v_mul_f32 v83, v83, v115
    v_mul_f32 v84, v84, v115
    v_mul_f32 v85, v85, v115
    v_mul_f32 v86, v86, v115
    v_mul_f32 v87, v87, v115
    v_mul_f32 v88, v88, v115
    v_mul_f32 v89, v89, v115
    v_mul_f32 v90, v90, v115
    v_mul_f32 v91, v91, v115
    v_mul_f32 v92, v92, v115
    v_mul_f32 v93, v93, v115
    v_mul_f32 v94, v94, v115
    v_mul_f32 v95, v95, v115
    v_mul_f32 v96, v96, v115
    v_mul_f32 v97, v97, v115
    v_mul_f32 v98, v98, v115
    v_mul_f32 v99, v99, v115
    v_mul_f32 v100, v100, v115
    v_mul_f32 v101, v101, v115
    v_mul_f32 v102, v102, v115
    v_mul_f32 v103, v103, v115
    v_cvt_pk_bf16_f32 v16, v48, v49
    v_cvt_pk_bf16_f32 v17, v50, v51
    v_cvt_pk_bf16_f32 v18, v52, v53
    v_cvt_pk_bf16_f32 v19, v54, v55
    v_cvt_pk_bf16_f32 v20, v56, v57
    v_cvt_pk_bf16_f32 v21, v58, v59
    v_cvt_pk_bf16_f32 v22, v60, v61
    v_cvt_pk_bf16_f32 v23, v62, v63
    v_cvt_pk_bf16_f32 v24, v64, v65
    v_cvt_pk_bf16_f32 v25, v66, v67
    v_cvt_pk_bf16_f32 v26, v68, v69
    v_cvt_pk_bf16_f32 v27, v70, v71
    v_cvt_pk_bf16_f32 v28, v72, v73
    v_cvt_pk_bf16_f32 v29, v74, v75
    v_cvt_pk_bf16_f32 v30, v76, v77
    v_cvt_pk_bf16_f32 v31, v78, v79
    v_cvt_pk_bf16_f32 v32, v80, v81
    v_cvt_pk_bf16_f32 v33, v82, v83
    v_cvt_pk_bf16_f32 v34, v84, v85
    v_cvt_pk_bf16_f32 v35, v86, v87
    v_cvt_pk_bf16_f32 v36, v88, v89
    v_cvt_pk_bf16_f32 v37, v90, v91
    v_cvt_pk_bf16_f32 v38, v92, v93
    v_cvt_pk_bf16_f32 v39, v94, v95
    v_cvt_pk_bf16_f32 v40, v96, v97
    v_cvt_pk_bf16_f32 v41, v98, v99
    v_cvt_pk_bf16_f32 v42, v100, v101
    v_cvt_pk_bf16_f32 v43, v102, v103
    s_mul_i32 s31, s20, 7168
    v_add_u32 v11, s31, v5
    ds_write_b128 v11, v[16:19] offset:0
    ds_write_b128 v11, v[20:23] offset:1024
    ds_write_b128 v11, v[24:27] offset:2048
    ds_write_b128 v11, v[28:31] offset:3072
    ds_write_b128 v11, v[32:35] offset:4096
    ds_write_b128 v11, v[36:39] offset:5120
    ds_write_b128 v11, v[40:43] offset:6144
    s_waitcnt lgkmcnt(0)
    s_barrier
    ds_read_b128 v[16:19], v5 offset:0
    ds_read_b128 v[20:23], v5 offset:1024
    ds_read_b128 v[24:27], v5 offset:2048
    ds_read_b128 v[28:31], v5 offset:3072
    ds_read_b128 v[32:35], v5 offset:4096
    ds_read_b128 v[36:39], v5 offset:5120
    ds_read_b128 v[40:43], v5 offset:6144
    ds_read_b128 v[44:47], v5 offset:7168
    ds_read_b128 v[48:51], v5 offset:8192
    ds_read_b128 v[52:55], v5 offset:9216
    ds_read_b128 v[56:59], v5 offset:10240
    ds_read_b128 v[60:63], v5 offset:11264
    ds_read_b128 v[64:67], v5 offset:12288
    ds_read_b128 v[68:71], v5 offset:13312
    ds_read_b128 v[72:75], v5 offset:14336
    ds_read_b128 v[76:79], v5 offset:15360
    ds_read_b128 v[80:83], v5 offset:16384
    ds_read_b128 v[84:87], v5 offset:17408
    ds_read_b128 v[88:91], v5 offset:18432
    ds_read_b128 v[92:95], v5 offset:19456
    ds_read_b128 v[96:99], v5 offset:20480
    ds_read_b128 v[100:103], v5 offset:21504
    ds_read_b128 v[104:107], v5 offset:22528
    ds_read_b128 v[108:111], v5 offset:23552
    ds_read_b128 v[112:115], v5 offset:24576
    ds_read_b128 v[116:119], v5 offset:25600
    ds_read_b128 v[120:123], v5 offset:26624
    ds_read_b128 v[124:127], v5 offset:27648
    s_waitcnt lgkmcnt(0)
    v_mfma_f32_16x16x32_bf16 v[128:131], a[0:3], v[16:19], v[200:203]
    v_mfma_f32_16x16x32_bf16 v[132:135], a[0:3], v[72:75], v[200:203]
    v_mfma_f32_16x16x32_bf16 v[136:139], a[56:59], v[16:19], v[204:207]
    v_mfma_f32_16x16x32_bf16 v[140:143], a[56:59], v[72:75], v[204:207]
    v_mfma_f32_16x16x32_bf16 v[144:147], a[112:115], v[16:19], v[208:211]
    v_mfma_f32_16x16x32_bf16 v[148:151], a[112:115], v[72:75], v[208:211]
    v_mfma_f32_16x16x32_bf16 v[152:155], a[168:171], v[16:19], v[212:215]
    v_mfma_f32_16x16x32_bf16 v[156:159], a[168:171], v[72:75], v[212:215]
    v_mfma_f32_16x16x32_bf16 v[128:131], a[4:7], v[20:23], v[128:131]
    v_mfma_f32_16x16x32_bf16 v[132:135], a[4:7], v[76:79], v[132:135]
    v_mfma_f32_16x16x32_bf16 v[136:139], a[60:63], v[20:23], v[136:139]
    v_mfma_f32_16x16x32_bf16 v[140:143], a[60:63], v[76:79], v[140:143]
    v_mfma_f32_16x16x32_bf16 v[144:147], a[116:119], v[20:23], v[144:147]
    v_mfma_f32_16x16x32_bf16 v[148:151], a[116:119], v[76:79], v[148:151]
    v_mfma_f32_16x16x32_bf16 v[152:155], a[172:175], v[20:23], v[152:155]
    v_mfma_f32_16x16x32_bf16 v[156:159], a[172:175], v[76:79], v[156:159]
    v_mfma_f32_16x16x32_bf16 v[128:131], a[8:11], v[24:27], v[128:131]
    v_mfma_f32_16x16x32_bf16 v[132:135], a[8:11], v[80:83], v[132:135]
    v_mfma_f32_16x16x32_bf16 v[136:139], a[64:67], v[24:27], v[136:139]
    v_mfma_f32_16x16x32_bf16 v[140:143], a[64:67], v[80:83], v[140:143]
    v_mfma_f32_16x16x32_bf16 v[144:147], a[120:123], v[24:27], v[144:147]
    v_mfma_f32_16x16x32_bf16 v[148:151], a[120:123], v[80:83], v[148:151]
    v_mfma_f32_16x16x32_bf16 v[152:155], a[176:179], v[24:27], v[152:155]
    v_mfma_f32_16x16x32_bf16 v[156:159], a[176:179], v[80:83], v[156:159]
    v_mfma_f32_16x16x32_bf16 v[128:131], a[12:15], v[28:31], v[128:131]
    v_mfma_f32_16x16x32_bf16 v[132:135], a[12:15], v[84:87], v[132:135]
    v_mfma_f32_16x16x32_bf16 v[136:139], a[68:71], v[28:31], v[136:139]
    v_mfma_f32_16x16x32_bf16 v[140:143], a[68:71], v[84:87], v[140:143]
    v_mfma_f32_16x16x32_bf16 v[144:147], a[124:127], v[28:31], v[144:147]
    v_mfma_f32_16x16x32_bf16 v[148:151], a[124:127], v[84:87], v[148:151]
    v_mfma_f32_16x16x32_bf16 v[152:155], a[180:183], v[28:31], v[152:155]
    v_mfma_f32_16x16x32_bf16 v[156:159], a[180:183], v[84:87], v[156:159]
    v_mfma_f32_16x16x32_bf16 v[128:131], a[16:19], v[32:35], v[128:131]
    v_mfma_f32_16x16x32_bf16 v[132:135], a[16:19], v[88:91], v[132:135]
    v_mfma_f32_16x16x32_bf16 v[136:139], a[72:75], v[32:35], v[136:139]
    v_mfma_f32_16x16x32_bf16 v[140:143], a[72:75], v[88:91], v[140:143]
    v_mfma_f32_16x16x32_bf16 v[144:147], a[128:131], v[32:35], v[144:147]
    v_mfma_f32_16x16x32_bf16 v[148:151], a[128:131], v[88:91], v[148:151]
    v_mfma_f32_16x16x32_bf16 v[152:155], a[184:187], v[32:35], v[152:155]
    v_mfma_f32_16x16x32_bf16 v[156:159], a[184:187], v[88:91], v[156:159]
    v_mfma_f32_16x16x32_bf16 v[128:131], a[20:23], v[36:39], v[128:131]
    v_mfma_f32_16x16x32_bf16 v[132:135], a[20:23], v[92:95], v[132:135]
    v_mfma_f32_16x16x32_bf16 v[136:139], a[76:79], v[36:39], v[136:139]
    v_mfma_f32_16x16x32_bf16 v[140:143], a[76:79], v[92:95], v[140:143]
    v_mfma_f32_16x16x32_bf16 v[144:147], a[132:135], v[36:39], v[144:147]
    v_mfma_f32_16x16x32_bf16 v[148:151], a[132:135], v[92:95], v[148:151]
    v_mfma_f32_16x16x32_bf16 v[152:155], a[188:191], v[36:39], v[152:155]
    v_mfma_f32_16x16x32_bf16 v[156:159], a[188:191], v[92:95], v[156:159]
    v_mfma_f32_16x16x32_bf16 v[128:131], a[24:27], v[40:43], v[128:131]
    v_mfma_f32_16x16x32_bf16 v[132:135], a[24:27], v[96:99], v[132:135]
    v_mfma_f32_16x16x32_bf16 v[136:139], a[80:83], v[40:43], v[136:139]
    v_mfma_f32_16x16x32_bf16 v[140:143], a[80:83], v[96:99], v[140:143]
    v_mfma_f32_16x16x32_bf16 v[144:147], a[136:139], v[40:43], v[144:147]
    v_mfma_f32_16x16x32_bf16 v[148:151], a[136:139], v[96:99], v[148:151]
    v_mfma_f32_16x16x32_bf16 v[152:155], a[192:195], v[40:43], v[152:155]
    v_mfma_f32_16x16x32_bf16 v[156:159], a[192:195], v[96:99], v[156:159]
    v_mfma_f32_16x16x32_bf16 v[128:131], a[28:31], v[44:47], v[128:131]
    v_mfma_f32_16x16x32_bf16 v[132:135], a[28:31], v[100:103], v[132:135]
    v_mfma_f32_16x16x32_bf16 v[136:139], a[84:87], v[44:47], v[136:139]
    v_mfma_f32_16x16x32_bf16 v[140:143], a[84:87], v[100:103], v[140:143]
    v_mfma_f32_16x16x32_bf16 v[144:147], a[140:143], v[44:47], v[144:147]
    v_mfma_f32_16x16x32_bf16 v[148:151], a[140:143], v[100:103], v[148:151]
    v_mfma_f32_16x16x32_bf16 v[152:155], a[196:199], v[44:47], v[152:155]
    v_mfma_f32_16x16x32_bf16 v[156:159], a[196:199], v[100:103], v[156:159]
    v_mfma_f32_16x16x32_bf16 v[128:131], a[32:35], v[48:51], v[128:131]
    v_mfma_f32_16x16x32_bf16 v[132:135], a[32:35], v[104:107], v[132:135]
    v_mfma_f32_16x16x32_bf16 v[136:139], a[88:91], v[48:51], v[136:139]
    v_mfma_f32_16x16x32_bf16 v[140:143], a[88:91], v[104:107], v[140:143]
    v_mfma_f32_16x16x32_bf16 v[144:147], a[144:147], v[48:51], v[144:147]
    v_mfma_f32_16x16x32_bf16 v[148:151], a[144:147], v[104:107], v[148:151]
    v_mfma_f32_16x16x32_bf16 v[152:155], a[200:203], v[48:51], v[152:155]
    v_mfma_f32_16x16x32_bf16 v[156:159], a[200:203], v[104:107], v[156:159]
    v_mfma_f32_16x16x32_bf16 v[128:131], a[36:39], v[52:55], v[128:131]
    v_mfma_f32_16x16x32_bf16 v[132:135], a[36:39], v[108:111], v[132:135]
    v_mfma_f32_16x16x32_bf16 v[136:139], a[92:95], v[52:55], v[136:139]
    v_mfma_f32_16x16x32_bf16 v[140:143], a[92:95], v[108:111], v[140:143]
    v_mfma_f32_16x16x32_bf16 v[144:147], a[148:151], v[52:55], v[144:147]
    v_mfma_f32_16x16x32_bf16 v[148:151], a[148:151], v[108:111], v[148:151]
    v_mfma_f32_16x16x32_bf16 v[152:155], a[204:207], v[52:55], v[152:155]
    v_mfma_f32_16x16x32_bf16 v[156:159], a[204:207], v[108:111], v[156:159]
    v_mfma_f32_16x16x32_bf16 v[128:131], a[40:43], v[56:59], v[128:131]
    v_mfma_f32_16x16x32_bf16 v[132:135], a[40:43], v[112:115], v[132:135]
    v_mfma_f32_16x16x32_bf16 v[136:139], a[96:99], v[56:59], v[136:139]
    v_mfma_f32_16x16x32_bf16 v[140:143], a[96:99], v[112:115], v[140:143]
    v_mfma_f32_16x16x32_bf16 v[144:147], a[152:155], v[56:59], v[144:147]
    v_mfma_f32_16x16x32_bf16 v[148:151], a[152:155], v[112:115], v[148:151]
    v_mfma_f32_16x16x32_bf16 v[152:155], a[208:211], v[56:59], v[152:155]
    v_mfma_f32_16x16x32_bf16 v[156:159], a[208:211], v[112:115], v[156:159]
    v_mfma_f32_16x16x32_bf16 v[128:131], a[44:47], v[60:63], v[128:131]
    v_mfma_f32_16x16x32_bf16 v[132:135], a[44:47], v[116:119], v[132:135]
    v_mfma_f32_16x16x32_bf16 v[136:139], a[100:103], v[60:63], v[136:139]
    v_mfma_f32_16x16x32_bf16 v[140:143], a[100:103], v[116:119], v[140:143]
    v_mfma_f32_16x16x32_bf16 v[144:147], a[156:159], v[60:63], v[144:147]
    v_mfma_f32_16x16x32_bf16 v[148:151], a[156:159], v[116:119], v[148:151]
    v_mfma_f32_16x16x32_bf16 v[152:155], a[212:215], v[60:63], v[152:155]
    v_mfma_f32_16x16x32_bf16 v[156:159], a[212:215], v[116:119], v[156:159]
    v_mfma_f32_16x16x32_bf16 v[128:131], a[48:51], v[64:67], v[128:131]
    v_mfma_f32_16x16x32_bf16 v[132:135], a[48:51], v[120:123], v[132:135]
    v_mfma_f32_16x16x32_bf16 v[136:139], a[104:107], v[64:67], v[136:139]
    v_mfma_f32_16x16x32_bf16 v[140:143], a[104:107], v[120:123], v[140:143]
    v_mfma_f32_16x16x32_bf16 v[144:147], a[160:163], v[64:67], v[144:147]
    v_mfma_f32_16x16x32_bf16 v[148:151], a[160:163], v[120:123], v[148:151]
    v_mfma_f32_16x16x32_bf16 v[152:155], a[216:219], v[64:67], v[152:155]
    v_mfma_f32_16x16x32_bf16 v[156:159], a[216:219], v[120:123], v[156:159]
    v_mfma_f32_16x16x32_bf16 v[128:131], a[52:55], v[68:71], v[128:131]
    v_mfma_f32_16x16x32_bf16 v[132:135], a[52:55], v[124:127], v[132:135]
    v_mfma_f32_16x16x32_bf16 v[136:139], a[108:111], v[68:71], v[136:139]
    v_mfma_f32_16x16x32_bf16 v[140:143], a[108:111], v[124:127], v[140:143]
    v_mfma_f32_16x16x32_bf16 v[144:147], a[164:167], v[68:71], v[144:147]
    v_mfma_f32_16x16x32_bf16 v[148:151], a[164:167], v[124:127], v[148:151]
    v_mfma_f32_16x16x32_bf16 v[152:155], a[220:223], v[68:71], v[152:155]
    v_mfma_f32_16x16x32_bf16 v[156:159], a[220:223], v[124:127], v[156:159]
    s_nop 7
    s_nop 1
    v_max_f32 v128, 0, v128
    v_max_f32 v129, 0, v129
    v_max_f32 v130, 0, v130
    v_max_f32 v131, 0, v131
    v_mul_f32 v128, v128, v128
    v_mul_f32 v129, v129, v129
    v_mul_f32 v130, v130, v130
    v_mul_f32 v131, v131, v131
    v_cvt_pk_bf16_f32 v160, v128, v129
    v_cvt_pk_bf16_f32 v161, v130, v131
    v_max_f32 v136, 0, v136
    v_max_f32 v137, 0, v137
    v_max_f32 v138, 0, v138
    v_max_f32 v139, 0, v139
    v_mul_f32 v136, v136, v136
    v_mul_f32 v137, v137, v137
    v_mul_f32 v138, v138, v138
    v_mul_f32 v139, v139, v139
    v_cvt_pk_bf16_f32 v162, v136, v137
    v_cvt_pk_bf16_f32 v163, v138, v139
    s_lshr_b32 s32, s24, 1
    s_add_u32 s32, s32, 0
    s_lshl_b32 s34, s22, 1
    s_add_u32 s34, s34, 0
    s_mul_i32 s34, s34, 56
    s_add_u32 s34, s34, s32
    s_lshl_b32 s34, s34, 10
    s_add_u32 s34, s34, 106954752
    buffer_store_dwordx4 v[160:163], v5, s[8:11], s34 offen sc1
    v_max_f32 v132, 0, v132
    v_max_f32 v133, 0, v133
    v_max_f32 v134, 0, v134
    v_max_f32 v135, 0, v135
    v_mul_f32 v132, v132, v132
    v_mul_f32 v133, v133, v133
    v_mul_f32 v134, v134, v134
    v_mul_f32 v135, v135, v135
    v_cvt_pk_bf16_f32 v164, v132, v133
    v_cvt_pk_bf16_f32 v165, v134, v135
    v_max_f32 v140, 0, v140
    v_max_f32 v141, 0, v141
    v_max_f32 v142, 0, v142
    v_max_f32 v143, 0, v143
    v_mul_f32 v140, v140, v140
    v_mul_f32 v141, v141, v141
    v_mul_f32 v142, v142, v142
    v_mul_f32 v143, v143, v143
    v_cvt_pk_bf16_f32 v166, v140, v141
    v_cvt_pk_bf16_f32 v167, v142, v143
    s_lshr_b32 s32, s24, 1
    s_add_u32 s32, s32, 0
    s_lshl_b32 s34, s22, 1
    s_add_u32 s34, s34, 1
    s_mul_i32 s34, s34, 56
    s_add_u32 s34, s34, s32
    s_lshl_b32 s34, s34, 10
    s_add_u32 s34, s34, 106954752
    buffer_store_dwordx4 v[164:167], v5, s[8:11], s34 offen sc1
    v_max_f32 v144, 0, v144
    v_max_f32 v145, 0, v145
    v_max_f32 v146, 0, v146
    v_max_f32 v147, 0, v147
    v_mul_f32 v144, v144, v144
    v_mul_f32 v145, v145, v145
    v_mul_f32 v146, v146, v146
    v_mul_f32 v147, v147, v147
    v_cvt_pk_bf16_f32 v168, v144, v145
    v_cvt_pk_bf16_f32 v169, v146, v147
    v_max_f32 v152, 0, v152
    v_max_f32 v153, 0, v153
    v_max_f32 v154, 0, v154
    v_max_f32 v155, 0, v155
    v_mul_f32 v152, v152, v152
    v_mul_f32 v153, v153, v153
    v_mul_f32 v154, v154, v154
    v_mul_f32 v155, v155, v155
    v_cvt_pk_bf16_f32 v170, v152, v153
    v_cvt_pk_bf16_f32 v171, v154, v155
    s_lshr_b32 s32, s24, 1
    s_add_u32 s32, s32, 1
    s_lshl_b32 s34, s22, 1
    s_add_u32 s34, s34, 0
    s_mul_i32 s34, s34, 56
    s_add_u32 s34, s34, s32
    s_lshl_b32 s34, s34, 10
    s_add_u32 s34, s34, 106954752
    buffer_store_dwordx4 v[168:171], v5, s[8:11], s34 offen sc1
    v_max_f32 v148, 0, v148
    v_max_f32 v149, 0, v149
    v_max_f32 v150, 0, v150
    v_max_f32 v151, 0, v151
    v_mul_f32 v148, v148, v148
    v_mul_f32 v149, v149, v149
    v_mul_f32 v150, v150, v150
    v_mul_f32 v151, v151, v151
    v_cvt_pk_bf16_f32 v172, v148, v149
    v_cvt_pk_bf16_f32 v173, v150, v151
    v_max_f32 v156, 0, v156
    v_max_f32 v157, 0, v157
    v_max_f32 v158, 0, v158
    v_max_f32 v159, 0, v159
    v_mul_f32 v156, v156, v156
    v_mul_f32 v157, v157, v157
    v_mul_f32 v158, v158, v158
    v_mul_f32 v159, v159, v159
    v_cvt_pk_bf16_f32 v174, v156, v157
    v_cvt_pk_bf16_f32 v175, v158, v159
    s_lshr_b32 s32, s24, 1
    s_add_u32 s32, s32, 1
    s_lshl_b32 s34, s22, 1
    s_add_u32 s34, s34, 1
    s_mul_i32 s34, s34, 56
    s_add_u32 s34, s34, s32
    s_lshl_b32 s34, s34, 10
    s_add_u32 s34, s34, 106954752
    buffer_store_dwordx4 v[172:175], v5, s[8:11], s34 offen sc1
    s_lshl_b32 s37, s22, 6
    s_lshl_b32 s38, s23, 2
    s_add_u32 s37, s37, s38
    s_add_u32 s37, s37, 94191648
    s_waitcnt vmcnt(0)
    s_barrier
    s_cmp_eq_u32 s20, 0
    s_cbranch_scc0 L_sf_25
    v_mov_b32 v12, 1
    v_mov_b32 v13, 0
    s_mov_b64 exec, 1
    buffer_store_dword v12, v13, s[8:11], s37 offen sc1
    s_mov_b64 exec, -1
L_sf_25:
    s_branch K3_TASK
K3_TEND:
K3_END:
    s_endpgm
.section .rodata,"a"
.p2align 6
.amdhsa_kernel k1_prep_kernel
  .amdhsa_next_free_vgpr 192
  .amdhsa_next_free_sgpr 102
  .amdhsa_accum_offset 192
  .amdhsa_group_segment_fixed_size 0
  .amdhsa_kernarg_size 120
  .amdhsa_user_sgpr_count 2
  .amdhsa_user_sgpr_kernarg_segment_ptr 1
  .amdhsa_system_sgpr_workgroup_id_x 1
.end_amdhsa_kernel
.p2align 6
.amdhsa_kernel k3_chain_kernel
  .amdhsa_next_free_vgpr 512
  .amdhsa_next_free_sgpr 102
  .amdhsa_accum_offset 256
  .amdhsa_group_segment_fixed_size 0
  .amdhsa_kernarg_size 120
  .amdhsa_user_sgpr_count 2
  .amdhsa_user_sgpr_kernarg_segment_ptr 1
  .amdhsa_system_sgpr_workgroup_id_x 1
.end_amdhsa_kernel
```
